```python
import torch

def _softmax(x, axis=-1):
    return torch.softmax(x, dim=axis)
def _gelu(x):
    return torch.nn.functional.gelu(x, approximate="tanh")
def _silu(x):
    return torch.nn.functional.silu(x)
def _sigmoid(x):
    return torch.sigmoid(x)
def _layernorm(x, axis=-1, eps=1e-5):
    m = x.mean(dim=axis, keepdim=True)
    v = x.var(dim=axis, keepdim=True, unbiased=False)
    return (x - m) / torch.sqrt(v + eps)
def _scatter_add(tgt, idx, src, axis=0):
    return tgt.clone().index_add_(axis, idx, src)
def _segment_sum(src, seg, n):
    out = torch.zeros((n,) + src.shape[1:], dtype=src.dtype)
    return out.index_add_(0, seg, src)
def _pad(x, pw):
    flat = tuple(v for pair in reversed(pw) for v in pair)
    return torch.nn.functional.pad(x, flat)

kernel_name = 'interleave_layers__ssm_conv_s4d__glu_gated_geglu__prompt'

def setup_inputs():

    _w = (lambda a: (lambda t: t.to(torch.bfloat16) if t.is_floating_point() else t)(torch.as_tensor(a)))
    def _A_setup():
        Bsz, L, D, N = 1, 2048, 512, 128
        return {
            "u": _w((lambda *s: torch.randn(*s, dtype=torch.bfloat16) * 0.05)(Bsz, L, D)),
            "log_A_real": _w((lambda *s: torch.randn(*s, dtype=torch.bfloat16) * 3.2)(D, N) * 0.5),
            "A_imag": _w((lambda *s: torch.randn(*s, dtype=torch.bfloat16) * 0.05)(D, N) * 3.14),
            "C_real": _w((lambda *s: torch.randn(*s, dtype=torch.bfloat16) * 0.05)(D, N) / N ** 0.5),
            "C_imag": _w((lambda *s: torch.randn(*s, dtype=torch.bfloat16) * 0.05)(D, N) / N ** 0.5),
            "log_dt": _w((lambda *s: torch.randn(*s, dtype=torch.bfloat16) * 0.05)(D) * 0.5 - 4.0),
            "D_skip": _w((lambda *s: torch.randn(*s, dtype=torch.bfloat16) * 0.05)(D)),
        }
    _A_in = _A_setup()

    def _B_setup():
        B, S, Dm, Df = 1, 2048, 512, 1376
        return {
            "x": _w((lambda *s: torch.randn(*s, dtype=torch.bfloat16) * 0.05)(B, S, Dm)),
            "w_gate": _w((lambda *s: torch.randn(*s, dtype=torch.bfloat16) * 0.8)(Dm, Df) * (Dm ** -0.5)),
            "w_up": _w((lambda *s: torch.randn(*s, dtype=torch.bfloat16) * 0.8)(Dm, Df) * (Dm ** -0.5)),
            "w_down": _w((lambda *s: torch.randn(*s, dtype=torch.bfloat16) * 0.8)(Df, Dm) * (Df ** -0.5)),
        }
    _B_in = _B_setup()

    return {
        "A_u": _A_in["u"],
        "A_log_A_real": _A_in["log_A_real"],
        "A_A_imag": _A_in["A_imag"],
        "A_C_real": _A_in["C_real"],
        "A_C_imag": _A_in["C_imag"],
        "A_log_dt": _A_in["log_dt"],
        "A_D_skip": _A_in["D_skip"],
        "B_x": _B_in["x"],
        "B_w_gate": _B_in["w_gate"],
        "B_w_up": _B_in["w_up"],
        "B_w_down": _B_in["w_down"],
    }

def reference(A_u, A_log_A_real, A_A_imag, A_C_real, A_C_imag, A_log_dt, A_D_skip, B_x, B_w_gate, B_w_up, B_w_down):
    def _A_ref(u, log_A_real, A_imag, C_real, C_imag, log_dt, D_skip):
        L = u.shape[1]
        dt = torch.exp(log_dt)
        A = -torch.exp(log_A_real) + 1j * A_imag
        C = (C_real + 1j * C_imag) * dt[:, None]
        pos = (lambda x, dt: x.to(dt))(torch.arange(L), log_dt.dtype)
        P = torch.exp((A * dt[:, None])[:, :, None] * pos[None, None, :])
        K = 2.0 * torch.einsum("dn,dnl->dl", C, P).real
        L2 = 2 * L
        u_t = (lambda x, *d: x.permute(*d))(u, 0, 2, 1)
        Kf = (lambda x, *a, **k: torch.fft.rfft(x.float(), *a, **k))(K, L2)
        Uf = (lambda x, *a, **k: torch.fft.rfft(x.float(), *a, **k))(u_t, L2)
        y = (lambda x, *a, **k: torch.fft.irfft(x, *a, **k).to(torch.bfloat16))(Uf * Kf[None, :, :], L2)[:, :, :L]
        y = (lambda x, *d: x.permute(*d))(y, 0, 2, 1)
        return y + u * D_skip[None, None, :]

    def _B_ref(x, w_gate, w_up, w_down):
        g = torch.einsum("bsd,df->bsf", x, w_gate)
        u = torch.einsum("bsd,df->bsf", x, w_up)
        h = _gelu(g) * u
        return torch.einsum("bsf,fd->bsd", h, w_down)

    x = A_u
    x = x + _A_ref(_layernorm(x, axis=-1), A_log_A_real, A_A_imag, A_C_real, A_C_imag, A_log_dt, A_D_skip)
    x = x + _B_ref(_layernorm(x, axis=-1), B_w_gate, B_w_up, B_w_down)
    x = x + _A_ref(_layernorm(x, axis=-1), A_log_A_real, A_A_imag, A_C_real, A_C_imag, A_log_dt, A_D_skip)
    x = x + _B_ref(_layernorm(x, axis=-1), B_w_gate, B_w_up, B_w_down)
    return x
```

```asm
; @launch grid=(256,1,1) block=(256,1,1) lds=158208
.amdgcn_target "amdgcn-amd-amdhsa--gfx950"
.text
.globl interleave_layers__ssm_conv_s4d__glu_gated_geglu__prompt_kernel
.p2align 8
.type interleave_layers__ssm_conv_s4d__glu_gated_geglu__prompt_kernel,@function
interleave_layers__ssm_conv_s4d__glu_gated_geglu__prompt_kernel:
    s_cmp_ge_u32 s2, 256
    s_cbranch_scc1 M_END
    s_load_dwordx2 s[4:5], s[0:1], 104
    s_load_dwordx16 s[84:99], s[0:1], 0
    s_load_dwordx8 s[56:63], s[0:1], 64
    s_getpc_b64 s[8:9]
M_PC:
    v_lshlrev_b32 v2, 7, v0
    s_mov_b32 s10, M_END-M_PC
    v_min_u32 v2, s10, v2
    global_load_dword v43, v2, s[8:9]
    v_add_u32 v2, 0x8000, v2
    v_min_u32 v2, s10, v2
    global_load_dword v43, v2, s[8:9]
    v_lshrrev_b32 v7, 6, v0
    s_nop 0
    v_readfirstlane_b32 s20, v7
    s_and_b32 s23, s2, 7
    s_lshl_b32 s23, s23, 5
    s_lshr_b32 s3, s2, 3
    s_add_u32 s23, s23, s3
    v_and_b32 v7, 63, v0
    v_lshlrev_b32 v5, 4, v7
    s_lshl_b32 s3, s23, 9
    v_lshl_add_u32 v44, v0, 1, s3
    v_lshrrev_b32 v45, 7, v0
    s_lshl_b32 s33, s23, 2
    v_lshl_add_u32 v45, v45, 1, s33
    s_waitcnt lgkmcnt(0)
    global_load_ushort v50, v45, s[94:95]
    global_load_ushort v46, v44, s[86:87]
    global_load_ushort v47, v44, s[88:89]
    global_load_ushort v48, v44, s[90:91]
    global_load_ushort v49, v44, s[92:93]
    s_cmp_ge_u32 s20, 2
    s_cbranch_scc1 P_LW
    s_lshl_b32 s34, s2, 13
    s_lshl_b32 s35, s20, 12
    s_add_u32 s34, s34, s35
    s_mul_i32 s35, s20, 4352
    s_mov_b32 s8, s84
    s_mov_b32 s9, s85
    s_mov_b32 s10, 2097152
    s_mov_b32 s11, 0x20000
    s_add_u32 m0, s35, 128000
    s_nop 0
    buffer_load_dwordx4 v5, s[8:11], s34 offen offset:0 lds
    s_add_u32 m0, s35, 128064
    s_nop 0
    buffer_load_dwordx4 v5, s[8:11], s34 offen offset:1024 lds
    s_add_u32 m0, s35, 128128
    s_nop 0
    buffer_load_dwordx4 v5, s[8:11], s34 offen offset:2048 lds
    s_add_u32 m0, s35, 128192
    s_nop 0
    buffer_load_dwordx4 v5, s[8:11], s34 offen offset:3072 lds
    s_branch P_LC
P_LW:
    s_cmp_lt_u32 s2, 176
    s_cbranch_scc1 P_G1
    s_sub_u32 s37, s2, 176
    s_sub_u32 s36, s20, 2
    s_mul_i32 s34, s37, 24576
    s_mul_i32 s35, s36, 12288
    s_add_u32 s34, s34, s35
    s_mul_i32 s35, s36, 13056
    s_add_u32 s35, s35, 93696
    v_add_u32 v7, s34, v5
    v_add_u32 v8, 4096, v7
    v_add_u32 v9, 8192, v7
    s_mov_b32 s8, s60
    s_mov_b32 s9, s61
    s_mov_b32 s10, 1409024
    s_mov_b32 s11, 0x20000
    s_add_u32 m0, s35, 0
    s_nop 0
    buffer_load_dwordx4 v7, s[8:11], 0 offen offset:0 lds
    s_add_u32 m0, s35, 64
    s_nop 0
    buffer_load_dwordx4 v7, s[8:11], 0 offen offset:1024 lds
    s_add_u32 m0, s35, 128
    s_nop 0
    buffer_load_dwordx4 v7, s[8:11], 0 offen offset:2048 lds
    s_add_u32 m0, s35, 192
    s_nop 0
    buffer_load_dwordx4 v7, s[8:11], 0 offen offset:3072 lds
    s_add_u32 m0, s35, 4352
    s_nop 0
    buffer_load_dwordx4 v8, s[8:11], 0 offen offset:0 lds
    s_add_u32 m0, s35, 4416
    s_nop 0
    buffer_load_dwordx4 v8, s[8:11], 0 offen offset:1024 lds
    s_add_u32 m0, s35, 4480
    s_nop 0
    buffer_load_dwordx4 v8, s[8:11], 0 offen offset:2048 lds
    s_add_u32 m0, s35, 4544
    s_nop 0
    buffer_load_dwordx4 v8, s[8:11], 0 offen offset:3072 lds
    s_add_u32 m0, s35, 8704
    s_nop 0
    buffer_load_dwordx4 v9, s[8:11], 0 offen offset:0 lds
    s_add_u32 m0, s35, 8768
    s_nop 0
    buffer_load_dwordx4 v9, s[8:11], 0 offen offset:1024 lds
    s_add_u32 m0, s35, 8832
    s_nop 0
    buffer_load_dwordx4 v9, s[8:11], 0 offen offset:2048 lds
    s_add_u32 m0, s35, 8896
    s_nop 0
    buffer_load_dwordx4 v9, s[8:11], 0 offen offset:3072 lds
    s_branch P_LC
P_G1:
    v_bfe_u32 v7, v0, 4, 3
    v_mul_u32_u24 v9, 2752, v7
    v_and_b32 v7, 15, v0
    v_lshl_add_u32 v9, v7, 4, v9
    s_lshr_b32 s34, s2, 4
    s_lshl_b32 s34, s34, 8
    s_and_b32 s35, s2, 15
    s_mul_i32 s35, s35, 88064
    s_add_u32 s34, s34, s35
    v_add_u32 v9, s34, v9
    s_mov_b32 s8, s56
    s_mov_b32 s9, s57
    s_mov_b32 s10, 1409024
    s_mov_b32 s11, 0x20000
    s_mov_b32 s12, s58
    s_mov_b32 s13, s59
    s_mov_b32 s14, 1409024
    s_mov_b32 s15, 0x20000
    buffer_load_dwordx4 v[52:55], v9, s[8:11], 0 offen
    buffer_load_dwordx4 v[56:59], v9, s[12:15], 0 offen
    v_add_u32 v9, 22016, v9
    buffer_load_dwordx4 v[60:63], v9, s[8:11], 0 offen
    buffer_load_dwordx4 v[64:67], v9, s[12:15], 0 offen
    v_add_u32 v9, 22016, v9
    buffer_load_dwordx4 v[68:71], v9, s[8:11], 0 offen
    buffer_load_dwordx4 v[72:75], v9, s[12:15], 0 offen
    v_add_u32 v9, 22016, v9
    buffer_load_dwordx4 v[76:79], v9, s[8:11], 0 offen
    buffer_load_dwordx4 v[80:83], v9, s[12:15], 0 offen
    v_mov_b32 v7, 0x7fff0000
    buffer_load_dword v51, v7, s[8:11], 0 offen
    buffer_load_dword v51, v7, s[8:11], 0 offen
    buffer_load_dword v51, v7, s[8:11], 0 offen
    buffer_load_dword v51, v7, s[8:11], 0 offen
P_LC:
    s_load_dword s27, s[96:97], s33
    s_mov_b32 s3, 25755648
    s_load_dwordx2 s[66:67], s[4:5], s3
    s_mov_b32 s6, s62
    s_mov_b32 s7, s63
    s_add_u32 s40, s4, 25427968
    s_addc_u32 s41, s5, 0
    s_mov_b32 s42, 360448
    s_mov_b32 s43, 0x20000
    v_bfe_u32 v7, v0, 4, 3
    v_mul_u32_u24 v176, 1088, v7
    v_and_b32 v8, 15, v0
    v_lshl_add_u32 v176, v8, 4, v176
    v_add_u32 v176, 128000, v176
    s_lshl_b32 s3, s2, 5
    v_lshl_add_u32 v178, v7, 2, s3
    v_lshl_add_u32 v178, v8, 24, v178
    v_bfe_u32 v8, v0, 2, 2
    v_mul_u32_u24 v177, 1088, v8
    v_and_b32 v8, 3, v0
    v_lshl_add_u32 v177, v8, 3, v177
    v_bfe_u32 v8, v0, 4, 2
    v_lshl_add_u32 v177, v8, 5, v177
    s_lshl_b32 s3, s20, 9
    s_add_u32 s3, s3, 128000
    v_add_u32 v177, s3, v177
    s_add_u32 s12, s4, 0
    s_addc_u32 s13, s5, 0
    s_mov_b32 s14, 2097152
    s_mov_b32 s15, 0x20000
    s_add_u32 s16, s4, 25231360
    s_addc_u32 s17, s5, 0
    s_mov_b32 s18, 131072
    s_mov_b32 s19, 0x20000
    s_and_b32 s21, s2, 1
    s_lshl_b32 s21, s21, 3
    s_bfe_u32 s22, s2, 0x30003
    s_add_u32 s21, s21, s22
    s_and_b32 s22, s2, 7
    s_lshr_b32 s22, s22, 1
    s_lshl_b32 s22, s22, 2
    s_lshr_b32 s3, s2, 6
    s_add_u32 s22, s22, s3
    s_mul_i32 s24, s22, 43
    s_add_u32 s25, s24, 43
    s_lshr_b32 s24, s24, 2
    s_lshr_b32 s25, s25, 2
    s_mul_i32 s3, s20, 3
    s_add_u32 s24, s24, s3
    s_sub_u32 s3, s25, 2
    s_min_u32 s24, s24, s3
    s_sub_u32 s25, s3, s24
    s_min_u32 s25, s25, 3
    s_max_u32 s25, s25, 2
    v_and_b32 v7, 15, v0
    s_and_b32 s3, s2, 15
    s_lshl_b32 s3, s3, 7
    v_lshl_add_u32 v2, v7, 11, s3
    v_and_b32 v8, 0xf0, v0
    v_lshl_add_u32 v2, v8, 22, v2
    s_lshr_b32 s3, s2, 4
    s_lshl_b32 s3, s3, 11
    v_lshl_add_u32 v3, v7, 7, s3
    v_and_b32 v8, 0xc0, v0
    v_lshl_add_u32 v3, v8, 22, v3
    v_bfe_u32 v7, v0, 2, 3
    v_mul_u32_u24 v7, 4160, v7
    v_and_b32 v8, 3, v0
    v_lshl_add_u32 v7, v8, 3, v7
    v_add_u32 v7, 4096, v7
    v_mov_b32 v8, 0
    ds_write2_b32 v7, v8, v8 offset0:0 offset1:1
    s_mov_b32 s30, 33280
    s_cmp_eq_u32 s20, 3
    s_cselect_b32 s100, 0xffff, 0
    s_mov_b32 s101, 0
    v_mov_b32 v4, 1
    v_and_b32 v7, 0xcf, v0
    v_cmp_lt_u32 vcc, 0xc0, v7
    v_mov_b32 v8, 0x7fff0000
    s_nop 0
    v_cndmask_b32 v6, v5, v8, vcc
    v_lshlrev_b32 v35, 4, v0
    v_lshrrev_b32 v7, 7, v0
    v_mul_u32_u24 v7, 28160, v7
    v_and_b32 v8, 127, v0
    v_lshl_add_u32 v175, v8, 2, v7
    v_add_u32 v175, 33280, v175
    v_lshlrev_b32 v10, 3, v0
    v_sub_u32 v10, 2047, v10
    s_mov_b32 s34, 55552
    s_movk_i32 s35, 128
    s_mov_b32 s38, 93696
    v_subrev_u32 v7, 0, v10
    v_cvt_f32_i32 v164, v7
    v_cmp_gt_i32 vcc, s35, v7
    v_cvt_pk_bf16_f32 v164, v164, v164
    v_lshlrev_b32 v8, 1, v7
    v_and_b32 v164, 0xffff, v164
    v_add_u32 v8, 89600, v8
    v_lshl_add_u32 v164, v164, 1, s34
    v_cndmask_b32 v164, v164, v8, vcc
    v_subrev_u32 v7, 1, v10
    v_cvt_f32_i32 v165, v7
    v_cmp_gt_i32 vcc, s35, v7
    v_cvt_pk_bf16_f32 v165, v165, v165
    v_lshlrev_b32 v8, 1, v7
    v_and_b32 v165, 0xffff, v165
    v_add_u32 v8, 89600, v8
    v_lshl_add_u32 v165, v165, 1, s34
    v_cndmask_b32 v165, v165, v8, vcc
    v_subrev_u32 v7, 2, v10
    v_cvt_f32_i32 v166, v7
    v_cmp_gt_i32 vcc, s35, v7
    v_cvt_pk_bf16_f32 v166, v166, v166
    v_lshlrev_b32 v8, 1, v7
    v_and_b32 v166, 0xffff, v166
    v_add_u32 v8, 89600, v8
    v_lshl_add_u32 v166, v166, 1, s34
    v_cndmask_b32 v166, v166, v8, vcc
    v_subrev_u32 v7, 3, v10
    v_cvt_f32_i32 v167, v7
    v_cmp_gt_i32 vcc, s35, v7
    v_cvt_pk_bf16_f32 v167, v167, v167
    v_lshlrev_b32 v8, 1, v7
    v_and_b32 v167, 0xffff, v167
    v_add_u32 v8, 89600, v8
    v_lshl_add_u32 v167, v167, 1, s34
    v_cndmask_b32 v167, v167, v8, vcc
    v_subrev_u32 v7, 4, v10
    v_cvt_f32_i32 v168, v7
    v_cmp_gt_i32 vcc, s35, v7
    v_cvt_pk_bf16_f32 v168, v168, v168
    v_lshlrev_b32 v8, 1, v7
    v_and_b32 v168, 0xffff, v168
    v_add_u32 v8, 89600, v8
    v_lshl_add_u32 v168, v168, 1, s34
    v_cndmask_b32 v168, v168, v8, vcc
    v_subrev_u32 v7, 5, v10
    v_cvt_f32_i32 v169, v7
    v_cmp_gt_i32 vcc, s35, v7
    v_cvt_pk_bf16_f32 v169, v169, v169
    v_lshlrev_b32 v8, 1, v7
    v_and_b32 v169, 0xffff, v169
    v_add_u32 v8, 89600, v8
    v_lshl_add_u32 v169, v169, 1, s34
    v_cndmask_b32 v169, v169, v8, vcc
    v_subrev_u32 v7, 6, v10
    v_cvt_f32_i32 v170, v7
    v_cmp_gt_i32 vcc, s35, v7
    v_cvt_pk_bf16_f32 v170, v170, v170
    v_lshlrev_b32 v8, 1, v7
    v_and_b32 v170, 0xffff, v170
    v_add_u32 v8, 89600, v8
    v_lshl_add_u32 v170, v170, 1, s34
    v_cndmask_b32 v170, v170, v8, vcc
    v_subrev_u32 v7, 7, v10
    v_cvt_f32_i32 v171, v7
    v_cmp_gt_i32 vcc, s35, v7
    v_cvt_pk_bf16_f32 v171, v171, v171
    v_lshlrev_b32 v8, 1, v7
    v_and_b32 v171, 0xffff, v171
    v_add_u32 v8, 89600, v8
    v_lshl_add_u32 v171, v171, 1, s34
    v_cndmask_b32 v171, v171, v8, vcc
    v_subrev_u32 v7, 8, v10
    v_cvt_f32_i32 v172, v7
    v_cmp_gt_i32 vcc, s35, v7
    v_cvt_pk_bf16_f32 v172, v172, v172
    v_lshlrev_b32 v8, 1, v7
    v_and_b32 v172, 0xffff, v172
    v_add_u32 v8, 89600, v8
    v_lshl_add_u32 v172, v172, 1, s34
    v_cndmask_b32 v172, v172, v8, vcc
    v_subrev_u32 v7, 9, v10
    v_cvt_f32_i32 v173, v7
    v_cmp_gt_i32 vcc, s35, v7
    v_cvt_pk_bf16_f32 v173, v173, v173
    v_lshlrev_b32 v8, 1, v7
    v_and_b32 v173, 0xffff, v173
    v_add_u32 v8, 89600, v8
    v_lshl_add_u32 v173, v173, 1, s34
    v_cndmask_b32 v173, v173, v8, vcc
    v_subrev_u32 v7, 10, v10
    v_cvt_f32_i32 v174, v7
    v_cmp_gt_i32 vcc, s35, v7
    v_cvt_pk_bf16_f32 v174, v174, v174
    v_lshlrev_b32 v8, 1, v7
    v_and_b32 v174, 0xffff, v174
    v_add_u32 v8, 89600, v8
    v_lshl_add_u32 v174, v174, 1, s34
    v_cndmask_b32 v174, v174, v8, vcc
    v_mov_b32 v8, 0
    v_mov_b32 v9, 89592
    v_mov_b32 v7, 0
    ds_write2_b32 v9, v8, v8 offset0:0 offset1:1
    v_and_b32 v7, 15, v0
    v_mul_u32_u24 v7, 528, v7
    v_and_b32 v8, 0x30, v0
    v_add_u32 v7, v7, v8
    v_lshrrev_b32 v8, 7, v0
    v_mul_u32_u24 v8, 28160, v8
    v_add_u32 v179, v7, v8
    v_add_u32 v179, 33280, v179
    v_bfe_u32 v8, v0, 6, 1
    v_mul_u32_u24 v8, 8448, v8
    v_add_u32 v180, v179, v8
    v_bfe_u32 v181, v0, 4, 2
    v_bfe_u32 v182, v0, 6, 1
    v_and_b32 v7, 15, v0
    v_lshl_add_u32 v182, v182, 4, v7
    v_lshrrev_b32 v8, 7, v0
    v_lshlrev_b32 v8, 11, v8
    v_add_u32 v8, 89600, v8
    v_lshlrev_b32 v183, 3, v181
    v_lshl_add_u32 v183, v182, 4, v183
    v_lshlrev_b32 v7, 3, v182
    v_add_u32 v7, 512, v7
    v_cmp_eq_u32 vcc, 2, v181
    s_nop 1
    v_cndmask_b32 v183, v183, v7, vcc
    v_add_u32 v184, 4, v183
    v_lshlrev_b32 v7, 2, v182
    v_add_u32 v7, 768, v7
    v_cmp_eq_u32 vcc, 3, v181
    s_nop 1
    v_cndmask_b32 v183, v183, v7, vcc
    v_add_u32 v7, 128, v7
    v_cndmask_b32 v184, v184, v7, vcc
    v_add_u32 v183, v183, v8
    v_add_u32 v184, v184, v8
    v_min_u32 v181, 2, v181
    v_lshlrev_b32 v185, 8, v181
    v_lshl_add_u32 v185, v182, 1, v185
    v_add_u32 v185, v185, v8
    v_mov_b32 v9, 91640
    v_mov_b32 v8, 0
    ds_write2_b32 v9, v8, v8 offset0:0 offset1:1
    v_lshlrev_b32 v33, 22, v0
    v_and_b32 v32, 0xc0, v0
    v_lshlrev_b32 v32, 22, v32
    s_mov_b32 s97, 0x100000
    s_mov_b32 s96, 49152
    s_movk_i32 s98, 0x4000
    s_mov_b32 s99, 32768
    s_lshl_b32 s33, s24, 14
    s_add_u32 s33, s33, 16777216
    s_add_u32 s34, s33, 16384
    s_add_u32 s35, s33, 32768
    s_cmp_eq_u32 s25, 3
    s_cselect_b32 s36, 16384, 0
    s_cmp_eq_u32 s20, 3
    s_cselect_b32 s35, 19595264, s35
    s_cselect_b32 s36, 16384, s36
    s_mov_b32 s68, 0
    s_mov_b32 s69, 4096
    s_mov_b32 s70, 8192
    s_mov_b32 s71, 12288
    s_add_u32 s44, s4, s33
    s_addc_u32 s45, s5, 0
    s_mov_b32 s46, 16384
    s_mov_b32 s47, 0x20000
    s_add_u32 s48, s4, s34
    s_addc_u32 s49, s5, 0
    s_mov_b32 s50, 16384
    s_mov_b32 s51, 0x20000
    s_add_u32 s52, s4, s35
    s_addc_u32 s53, s5, 0
    s_mov_b32 s54, s36
    s_mov_b32 s55, 0x20000
    s_lshl_b32 s33, s24, 10
    s_add_u32 s33, s33, 25952256
    s_lshl_b32 s34, s25, 10
    s_add_u32 s60, s4, s33
    s_addc_u32 s61, s5, 0
    s_mov_b32 s62, s34
    s_mov_b32 s63, 0x20000
    s_add_u32 s72, s4, 20971520
    s_addc_u32 s73, s5, 0
    s_mov_b32 s74, 1409024
    s_mov_b32 s75, 0x20000
    s_add_u32 s88, s4, 4194304
    s_addc_u32 s89, s5, 0
    s_mov_b32 s90, 2097152
    s_mov_b32 s91, 0x20000
    v_lshrrev_b32 v7, 2, v0
    v_lshlrev_b32 v36, 14, v7
    v_and_b32 v7, 3, v0
    v_lshl_add_u32 v36, v7, 3, v36
    v_sub_u32 v7, 3, v7
    v_mul_u32_u24 v39, 4160, v7
    v_bfe_u32 v7, v0, 2, 2
    v_lshlrev_b32 v7, 3, v7
    v_sub_u32 v39, v39, v7
    v_and_b32 v8, 0x30, v0
    v_add_u32 v39, v39, v8
    v_bfe_u32 v7, v0, 6, 1
    v_lshlrev_b32 v7, 8, v7
    v_sub_u32 v39, v39, v7
    v_lshrrev_b32 v9, 7, v0
    v_mul_u32_u24 v40, 16640, v9
    v_add_u32 v39, v39, v40
    v_add_u32 v39, 280, v39
    v_mul_u32_u24 v40, 4608, v9
    v_sub_u32 v40, v40, v7
    v_add_u32 v40, v40, v8
    v_and_b32 v7, 15, v0
    v_lshl_add_u32 v40, v7, 5, v40
    v_add_u32 v40, 33568, v40
    v_lshrrev_b32 v9, 6, v0
    v_mul_u32_u24 v41, 5120, v9
    v_lshl_add_u32 v41, v7, 4, v41
    v_mul_u32_u24 v8, 20, v8
    v_add_u32 v41, v41, v8
    v_mul_u32_u24 v42, 1280, v9
    v_and_b32 v8, 3, v0
    v_mul_u32_u24 v8, 320, v8
    v_add_u32 v42, v42, v8
    v_bfe_u32 v8, v0, 2, 4
    v_lshl_add_u32 v42, v8, 4, v42
    v_lshlrev_b32 v37, 3, v0
    v_lshrrev_b32 v9, 4, v0
    v_lshlrev_b32 v38, 16, v9
    v_lshl_add_u32 v38, v7, 3, v38
    s_cmp_lt_u32 s20, 2
    s_cbranch_scc0 P_PW
    s_waitcnt vmcnt(4)
P_PW:
    s_waitcnt vmcnt(12) lgkmcnt(0)
    v_lshlrev_b32 v50, 16, v50
    v_lshlrev_b32 v46, 16, v46
    v_lshlrev_b32 v47, 16, v47
    v_lshlrev_b32 v48, 16, v48
    v_lshlrev_b32 v49, 16, v49
    v_mul_f32 v50, 0x3fb8aa3b, v50
    v_mul_f32 v46, 0x3fb8aa3b, v46
    v_exp_f32 v50, v50
    v_exp_f32 v46, v46
    v_cvt_pk_bf16_f32 v50, v50, v50
    v_lshlrev_b32 v50, 16, v50
    v_cvt_pk_bf16_f32 v46, v46, v46
    v_lshlrev_b32 v46, 16, v46
    v_mul_f32 v46, v46, v50
    v_mul_f32 v47, v47, v50
    v_mul_f32 v46, 0xbfb8aa3b, v46
    v_mul_f32 v47, 0x3e22f983, v47
    v_add_f32 v50, v50, v50
    v_mul_f32 v186, v48, v50
    v_mul_f32 v187, v49, v50
    v_mul_f32 v194, 0x41000000, v46
    v_mul_f32 v198, 0x3f800000, v46
    v_mul_f32 v202, 0x43800000, v46
    v_mul_f32 v195, 0x41000000, v47
    v_mul_f32 v199, 0x3f800000, v47
    v_mul_f32 v203, 0x43800000, v47
    v_exp_f32 v194, v194
    v_exp_f32 v198, v198
    v_exp_f32 v202, v202
    v_fract_f32 v195, v195
    v_fract_f32 v199, v199
    v_fract_f32 v203, v203
    v_cos_f32 v196, v195
    v_cos_f32 v200, v199
    v_cos_f32 v204, v203
    v_sin_f32 v197, v195
    v_sin_f32 v201, v199
    v_sin_f32 v205, v203
    v_mul_f32 v190, v194, v196
    v_mul_f32 v188, v198, v200
    v_mul_f32 v192, v202, v204
    v_mul_f32 v191, v194, v197
    v_mul_f32 v189, v198, v201
    v_mul_f32 v193, v202, v205
    v_mov_b32 v224, 1.0
    v_mov_b32 v225, 0
    v_mov_b32 v226, v190
    v_mov_b32 v227, v191
    v_cvt_pk_bf16_f32 v206, v224, v225
    ds_write_b32 v175, v206 offset:11088
    v_cvt_pk_bf16_f32 v207, v226, v227
    ds_write_b32 v175, v207 offset:11616
    v_cvt_pk_bf16_f32 v208, v186, -v187
    ds_write_b32 v175, v208 offset:0
    v_pk_mul_f32 v[228:229], v[190:191], v[190:191] op_sel:[0,0] op_sel_hi:[0,1]
    v_pk_fma_f32 v[228:229], v[190:191], v[190:191], v[228:229] op_sel:[1,1,0] op_sel_hi:[1,0,1] neg_lo:[1,0,0]
    v_cvt_pk_bf16_f32 v209, v228, v229
    ds_write_b32 v175, v209 offset:12144
    v_pk_mul_f32 v[230:231], v[228:229], v[190:191] op_sel:[0,0] op_sel_hi:[0,1]
    v_pk_fma_f32 v[230:231], v[228:229], v[190:191], v[230:231] op_sel:[1,1,0] op_sel_hi:[1,0,1] neg_lo:[1,0,0]
    v_cvt_pk_bf16_f32 v206, v230, v231
    ds_write_b32 v175, v206 offset:12672
    v_pk_mul_f32 v[210:211], v[186:187], v[188:189] op_sel:[0,0] op_sel_hi:[0,1]
    v_pk_fma_f32 v[210:211], v[186:187], v[188:189], v[210:211] op_sel:[1,1,0] op_sel_hi:[1,0,1] neg_lo:[1,0,0]
    v_cvt_pk_bf16_f32 v207, v210, -v211
    ds_write_b32 v175, v207 offset:528
    v_pk_mul_f32 v[232:233], v[228:229], v[228:229] op_sel:[0,0] op_sel_hi:[0,1]
    v_pk_fma_f32 v[232:233], v[228:229], v[228:229], v[232:233] op_sel:[1,1,0] op_sel_hi:[1,0,1] neg_lo:[1,0,0]
    v_pk_mul_f32 v[236:237], v[224:225], v[232:233] op_sel:[0,0] op_sel_hi:[0,1]
    v_pk_fma_f32 v[224:225], v[224:225], v[232:233], v[236:237] op_sel:[1,1,0] op_sel_hi:[1,0,1] neg_lo:[1,0,0]
    v_cvt_pk_bf16_f32 v208, v224, v225
    ds_write_b32 v175, v208 offset:13200
    v_pk_mul_f32 v[212:213], v[210:211], v[188:189] op_sel:[0,0] op_sel_hi:[0,1]
    v_pk_fma_f32 v[212:213], v[210:211], v[188:189], v[212:213] op_sel:[1,1,0] op_sel_hi:[1,0,1] neg_lo:[1,0,0]
    v_cvt_pk_bf16_f32 v209, v212, -v213
    ds_write_b32 v175, v209 offset:1056
    v_pk_mul_f32 v[236:237], v[226:227], v[232:233] op_sel:[0,0] op_sel_hi:[0,1]
    v_pk_fma_f32 v[226:227], v[226:227], v[232:233], v[236:237] op_sel:[1,1,0] op_sel_hi:[1,0,1] neg_lo:[1,0,0]
    v_cvt_pk_bf16_f32 v206, v226, v227
    ds_write_b32 v175, v206 offset:13728
    s_cmp_lt_u32 s20, 2
    s_cbranch_scc1 P_X8
    s_barrier
    s_branch P_KG
P_X8:
    s_waitcnt vmcnt(0)
    s_barrier
    ds_read_b64_tr_b16 v[52:53], v177 offset:0
    ds_read_b64_tr_b16 v[54:55], v177 offset:4352
    ds_read_b64_tr_b16 v[56:57], v177 offset:128
    ds_read_b64_tr_b16 v[58:59], v177 offset:4480
    ds_read_b64_tr_b16 v[60:61], v177 offset:256
    ds_read_b64_tr_b16 v[62:63], v177 offset:4608
    ds_read_b64_tr_b16 v[64:65], v177 offset:384
    ds_read_b64_tr_b16 v[66:67], v177 offset:4736
    ds_read_b128 v[68:71], v176 offset:0
    ds_read_b128 v[72:75], v176 offset:256
    ds_read_b128 v[76:79], v176 offset:512
    ds_read_b128 v[80:83], v176 offset:768
    v_mov_b32 v156, 0
    v_mov_b32 v158, 0
    v_mov_b32 v159, 0x3f803f80
    v_mov_b32 v8, 0
    s_mov_b32 s35, 65536
    s_mov_b32 s36, 73728
    buffer_store_dword v8, v178, s[16:19], s35 offen sc1
    buffer_store_dword v8, v178, s[16:19], s36 offen sc1
    v_lshlrev_b32 v7, 7, v0
    v_and_b32 v9, 0xf8, v0
    v_lshl_add_u32 v7, v9, 22, v7
    s_lshl_b32 s3, s2, 10
    buffer_store_dword v8, v7, s[40:43], s3 offen sc1
    s_add_u32 s8, s4, 19595264
    s_addc_u32 s9, s5, 0
    s_mov_b32 s10, 16384
    s_mov_b32 s11, 0x20000
    v_lshlrev_b32 v7, 2, v0
    v_and_b32 v9, 0xf0, v0
    v_lshl_add_u32 v7, v9, 22, v7
    s_lshl_b32 s34, s2, 6
    buffer_store_dword v159, v7, s[8:11], s34 offen sc1
    s_lshl_b32 s34, s2, 13
    s_lshl_b32 s35, s20, 12
    s_add_u32 s34, s34, s35
    s_waitcnt lgkmcnt(0)
    buffer_store_dwordx4 v[52:55], v5, s[12:15], s34 offen offset:0 sc1
    v_dot2c_f32_bf16 v156, v68, v159
    v_dot2c_f32_bf16 v158, v68, v68
    v_dot2c_f32_bf16 v156, v69, v159
    v_dot2c_f32_bf16 v158, v69, v69
    v_dot2c_f32_bf16 v156, v70, v159
    v_dot2c_f32_bf16 v158, v70, v70
    v_dot2c_f32_bf16 v156, v71, v159
    v_dot2c_f32_bf16 v158, v71, v71
    buffer_store_dwordx4 v[56:59], v5, s[12:15], s34 offen offset:1024 sc1
    v_dot2c_f32_bf16 v156, v72, v159
    v_dot2c_f32_bf16 v158, v72, v72
    v_dot2c_f32_bf16 v156, v73, v159
    v_dot2c_f32_bf16 v158, v73, v73
    v_dot2c_f32_bf16 v156, v74, v159
    v_dot2c_f32_bf16 v158, v74, v74
    v_dot2c_f32_bf16 v156, v75, v159
    v_dot2c_f32_bf16 v158, v75, v75
    buffer_store_dwordx4 v[60:63], v5, s[12:15], s34 offen offset:2048 sc1
    v_dot2c_f32_bf16 v156, v76, v159
    v_dot2c_f32_bf16 v158, v76, v76
    v_dot2c_f32_bf16 v156, v77, v159
    v_dot2c_f32_bf16 v158, v77, v77
    v_dot2c_f32_bf16 v156, v78, v159
    v_dot2c_f32_bf16 v158, v78, v78
    v_dot2c_f32_bf16 v156, v79, v159
    v_dot2c_f32_bf16 v158, v79, v79
    buffer_store_dwordx4 v[64:67], v5, s[12:15], s34 offen offset:3072 sc1
    v_dot2c_f32_bf16 v156, v80, v159
    v_dot2c_f32_bf16 v158, v80, v80
    v_dot2c_f32_bf16 v156, v81, v159
    v_dot2c_f32_bf16 v158, v81, v81
    v_dot2c_f32_bf16 v156, v82, v159
    v_dot2c_f32_bf16 v158, v82, v82
    v_dot2c_f32_bf16 v156, v83, v159
    v_dot2c_f32_bf16 v158, v83, v83
    s_nop 1
    v_add_f32_dpp v156, v156, v156 quad_perm:[1,0,3,2] row_mask:0xf bank_mask:0xf
    v_add_f32_dpp v158, v158, v158 quad_perm:[1,0,3,2] row_mask:0xf bank_mask:0xf
    s_nop 0
    v_add_f32_dpp v156, v156, v156 quad_perm:[2,3,0,1] row_mask:0xf bank_mask:0xf
    v_add_f32_dpp v158, v158, v158 quad_perm:[2,3,0,1] row_mask:0xf bank_mask:0xf
    s_nop 0
    v_add_f32_dpp v156, v156, v156 row_half_mirror row_mask:0xf bank_mask:0xf
    v_add_f32_dpp v158, v158, v158 row_half_mirror row_mask:0xf bank_mask:0xf
    s_nop 0
    v_add_f32_dpp v156, v156, v156 row_mirror row_mask:0xf bank_mask:0xf
    v_add_f32_dpp v158, v158, v158 row_mirror row_mask:0xf bank_mask:0xf
    s_movk_i32 s34, 0x2000
    buffer_store_dword v156, v178, s[16:19], 0 offen sc1
    buffer_store_dword v158, v178, s[16:19], s34 offen sc1
P_KG:
    v_pk_mul_f32 v[236:237], v[228:229], v[232:233] op_sel:[0,0] op_sel_hi:[0,1]
    v_pk_fma_f32 v[228:229], v[228:229], v[232:233], v[236:237] op_sel:[1,1,0] op_sel_hi:[1,0,1] neg_lo:[1,0,0]
    v_cvt_pk_bf16_f32 v207, v228, v229
    ds_write_b32 v175, v207 offset:14256
    v_pk_mul_f32 v[214:215], v[212:213], v[188:189] op_sel:[0,0] op_sel_hi:[0,1]
    v_pk_fma_f32 v[214:215], v[212:213], v[188:189], v[214:215] op_sel:[1,1,0] op_sel_hi:[1,0,1] neg_lo:[1,0,0]
    v_cvt_pk_bf16_f32 v208, v214, -v215
    ds_write_b32 v175, v208 offset:1584
    v_pk_mul_f32 v[236:237], v[230:231], v[232:233] op_sel:[0,0] op_sel_hi:[0,1]
    v_pk_fma_f32 v[230:231], v[230:231], v[232:233], v[236:237] op_sel:[1,1,0] op_sel_hi:[1,0,1] neg_lo:[1,0,0]
    v_cvt_pk_bf16_f32 v209, v230, v231
    ds_write_b32 v175, v209 offset:14784
    v_pk_mul_f32 v[236:237], v[224:225], v[232:233] op_sel:[0,0] op_sel_hi:[0,1]
    v_pk_fma_f32 v[224:225], v[224:225], v[232:233], v[236:237] op_sel:[1,1,0] op_sel_hi:[1,0,1] neg_lo:[1,0,0]
    v_cvt_pk_bf16_f32 v206, v224, v225
    ds_write_b32 v175, v206 offset:15312
    v_pk_mul_f32 v[216:217], v[214:215], v[188:189] op_sel:[0,0] op_sel_hi:[0,1]
    v_pk_fma_f32 v[216:217], v[214:215], v[188:189], v[216:217] op_sel:[1,1,0] op_sel_hi:[1,0,1] neg_lo:[1,0,0]
    v_cvt_pk_bf16_f32 v207, v216, -v217
    ds_write_b32 v175, v207 offset:2112
    v_pk_mul_f32 v[236:237], v[226:227], v[232:233] op_sel:[0,0] op_sel_hi:[0,1]
    v_pk_fma_f32 v[226:227], v[226:227], v[232:233], v[236:237] op_sel:[1,1,0] op_sel_hi:[1,0,1] neg_lo:[1,0,0]
    v_cvt_pk_bf16_f32 v208, v226, v227
    ds_write_b32 v175, v208 offset:15840
    v_pk_mul_f32 v[236:237], v[228:229], v[232:233] op_sel:[0,0] op_sel_hi:[0,1]
    v_pk_fma_f32 v[228:229], v[228:229], v[232:233], v[236:237] op_sel:[1,1,0] op_sel_hi:[1,0,1] neg_lo:[1,0,0]
    v_cvt_pk_bf16_f32 v209, v228, v229
    ds_write_b32 v175, v209 offset:16368
    v_pk_mul_f32 v[218:219], v[216:217], v[188:189] op_sel:[0,0] op_sel_hi:[0,1]
    v_pk_fma_f32 v[218:219], v[216:217], v[188:189], v[218:219] op_sel:[1,1,0] op_sel_hi:[1,0,1] neg_lo:[1,0,0]
    v_cvt_pk_bf16_f32 v206, v218, -v219
    ds_write_b32 v175, v206 offset:2640
    v_pk_mul_f32 v[236:237], v[230:231], v[232:233] op_sel:[0,0] op_sel_hi:[0,1]
    v_pk_fma_f32 v[230:231], v[230:231], v[232:233], v[236:237] op_sel:[1,1,0] op_sel_hi:[1,0,1] neg_lo:[1,0,0]
    v_cvt_pk_bf16_f32 v207, v230, v231
    ds_write_b32 v175, v207 offset:16896
    v_pk_mul_f32 v[236:237], v[224:225], v[232:233] op_sel:[0,0] op_sel_hi:[0,1]
    v_pk_fma_f32 v[224:225], v[224:225], v[232:233], v[236:237] op_sel:[1,1,0] op_sel_hi:[1,0,1] neg_lo:[1,0,0]
    v_cvt_pk_bf16_f32 v208, v224, v225
    ds_write_b32 v175, v208 offset:17424
    v_pk_mul_f32 v[220:221], v[218:219], v[188:189] op_sel:[0,0] op_sel_hi:[0,1]
    v_pk_fma_f32 v[220:221], v[218:219], v[188:189], v[220:221] op_sel:[1,1,0] op_sel_hi:[1,0,1] neg_lo:[1,0,0]
    v_cvt_pk_bf16_f32 v209, v220, -v221
    ds_write_b32 v175, v209 offset:3168
    v_pk_mul_f32 v[236:237], v[226:227], v[232:233] op_sel:[0,0] op_sel_hi:[0,1]
    v_pk_fma_f32 v[226:227], v[226:227], v[232:233], v[236:237] op_sel:[1,1,0] op_sel_hi:[1,0,1] neg_lo:[1,0,0]
    v_cvt_pk_bf16_f32 v206, v226, v227
    ds_write_b32 v175, v206 offset:17952
    v_pk_mul_f32 v[236:237], v[228:229], v[232:233] op_sel:[0,0] op_sel_hi:[0,1]
    v_pk_fma_f32 v[228:229], v[228:229], v[232:233], v[236:237] op_sel:[1,1,0] op_sel_hi:[1,0,1] neg_lo:[1,0,0]
    v_cvt_pk_bf16_f32 v207, v228, v229
    ds_write_b32 v175, v207 offset:18480
    v_pk_mul_f32 v[222:223], v[220:221], v[188:189] op_sel:[0,0] op_sel_hi:[0,1]
    v_pk_fma_f32 v[222:223], v[220:221], v[188:189], v[222:223] op_sel:[1,1,0] op_sel_hi:[1,0,1] neg_lo:[1,0,0]
    v_cvt_pk_bf16_f32 v208, v222, -v223
    ds_write_b32 v175, v208 offset:3696
    v_pk_mul_f32 v[236:237], v[230:231], v[232:233] op_sel:[0,0] op_sel_hi:[0,1]
    v_pk_fma_f32 v[230:231], v[230:231], v[232:233], v[236:237] op_sel:[1,1,0] op_sel_hi:[1,0,1] neg_lo:[1,0,0]
    v_cvt_pk_bf16_f32 v209, v230, v231
    ds_write_b32 v175, v209 offset:19008
    v_pk_mul_f32 v[236:237], v[224:225], v[232:233] op_sel:[0,0] op_sel_hi:[0,1]
    v_pk_fma_f32 v[224:225], v[224:225], v[232:233], v[236:237] op_sel:[1,1,0] op_sel_hi:[1,0,1] neg_lo:[1,0,0]
    v_cvt_pk_bf16_f32 v206, v224, v225
    ds_write_b32 v175, v206 offset:19536
    v_pk_mul_f32 v[234:235], v[186:187], v[192:193] op_sel:[0,0] op_sel_hi:[0,1]
    v_pk_fma_f32 v[186:187], v[186:187], v[192:193], v[234:235] op_sel:[1,1,0] op_sel_hi:[1,0,1] neg_lo:[1,0,0]
    v_cvt_pk_bf16_f32 v207, v186, -v187
    ds_write_b32 v175, v207 offset:4224
    v_pk_mul_f32 v[236:237], v[226:227], v[232:233] op_sel:[0,0] op_sel_hi:[0,1]
    v_pk_fma_f32 v[226:227], v[226:227], v[232:233], v[236:237] op_sel:[1,1,0] op_sel_hi:[1,0,1] neg_lo:[1,0,0]
    v_cvt_pk_bf16_f32 v208, v226, v227
    ds_write_b32 v175, v208 offset:20064
    v_pk_mul_f32 v[236:237], v[228:229], v[232:233] op_sel:[0,0] op_sel_hi:[0,1]
    v_pk_fma_f32 v[228:229], v[228:229], v[232:233], v[236:237] op_sel:[1,1,0] op_sel_hi:[1,0,1] neg_lo:[1,0,0]
    v_cvt_pk_bf16_f32 v209, v228, v229
    ds_write_b32 v175, v209 offset:20592
    v_pk_mul_f32 v[234:235], v[212:213], v[192:193] op_sel:[0,0] op_sel_hi:[0,1]
    v_pk_fma_f32 v[212:213], v[212:213], v[192:193], v[234:235] op_sel:[1,1,0] op_sel_hi:[1,0,1] neg_lo:[1,0,0]
    v_cvt_pk_bf16_f32 v206, v212, -v213
    ds_write_b32 v175, v206 offset:4752
    v_pk_mul_f32 v[236:237], v[230:231], v[232:233] op_sel:[0,0] op_sel_hi:[0,1]
    v_pk_fma_f32 v[230:231], v[230:231], v[232:233], v[236:237] op_sel:[1,1,0] op_sel_hi:[1,0,1] neg_lo:[1,0,0]
    v_cvt_pk_bf16_f32 v207, v230, v231
    ds_write_b32 v175, v207 offset:21120
    v_pk_mul_f32 v[236:237], v[224:225], v[232:233] op_sel:[0,0] op_sel_hi:[0,1]
    v_pk_fma_f32 v[224:225], v[224:225], v[232:233], v[236:237] op_sel:[1,1,0] op_sel_hi:[1,0,1] neg_lo:[1,0,0]
    v_cvt_pk_bf16_f32 v208, v224, v225
    ds_write_b32 v175, v208 offset:21648
    v_pk_mul_f32 v[234:235], v[216:217], v[192:193] op_sel:[0,0] op_sel_hi:[0,1]
    v_pk_fma_f32 v[216:217], v[216:217], v[192:193], v[234:235] op_sel:[1,1,0] op_sel_hi:[1,0,1] neg_lo:[1,0,0]
    v_cvt_pk_bf16_f32 v209, v216, -v217
    ds_write_b32 v175, v209 offset:5280
    v_pk_mul_f32 v[236:237], v[226:227], v[232:233] op_sel:[0,0] op_sel_hi:[0,1]
    v_pk_fma_f32 v[226:227], v[226:227], v[232:233], v[236:237] op_sel:[1,1,0] op_sel_hi:[1,0,1] neg_lo:[1,0,0]
    v_cvt_pk_bf16_f32 v206, v226, v227
    ds_write_b32 v175, v206 offset:22176
    v_pk_mul_f32 v[236:237], v[228:229], v[232:233] op_sel:[0,0] op_sel_hi:[0,1]
    v_pk_fma_f32 v[228:229], v[228:229], v[232:233], v[236:237] op_sel:[1,1,0] op_sel_hi:[1,0,1] neg_lo:[1,0,0]
    v_cvt_pk_bf16_f32 v207, v228, v229
    ds_write_b32 v175, v207 offset:22704
    v_pk_mul_f32 v[234:235], v[220:221], v[192:193] op_sel:[0,0] op_sel_hi:[0,1]
    v_pk_fma_f32 v[220:221], v[220:221], v[192:193], v[234:235] op_sel:[1,1,0] op_sel_hi:[1,0,1] neg_lo:[1,0,0]
    v_cvt_pk_bf16_f32 v208, v220, -v221
    ds_write_b32 v175, v208 offset:5808
    v_pk_mul_f32 v[236:237], v[230:231], v[232:233] op_sel:[0,0] op_sel_hi:[0,1]
    v_pk_fma_f32 v[230:231], v[230:231], v[232:233], v[236:237] op_sel:[1,1,0] op_sel_hi:[1,0,1] neg_lo:[1,0,0]
    v_cvt_pk_bf16_f32 v209, v230, v231
    ds_write_b32 v175, v209 offset:23232
    v_pk_mul_f32 v[234:235], v[186:187], v[192:193] op_sel:[0,0] op_sel_hi:[0,1]
    v_pk_fma_f32 v[186:187], v[186:187], v[192:193], v[234:235] op_sel:[1,1,0] op_sel_hi:[1,0,1] neg_lo:[1,0,0]
    v_cvt_pk_bf16_f32 v206, v186, -v187
    ds_write_b32 v175, v206 offset:6336
    v_pk_mul_f32 v[236:237], v[224:225], v[232:233] op_sel:[0,0] op_sel_hi:[0,1]
    v_pk_fma_f32 v[224:225], v[224:225], v[232:233], v[236:237] op_sel:[1,1,0] op_sel_hi:[1,0,1] neg_lo:[1,0,0]
    v_cvt_pk_bf16_f32 v207, v224, v225
    ds_write_b32 v175, v207 offset:23760
    v_pk_mul_f32 v[234:235], v[216:217], v[192:193] op_sel:[0,0] op_sel_hi:[0,1]
    v_pk_fma_f32 v[216:217], v[216:217], v[192:193], v[234:235] op_sel:[1,1,0] op_sel_hi:[1,0,1] neg_lo:[1,0,0]
    v_cvt_pk_bf16_f32 v208, v216, -v217
    ds_write_b32 v175, v208 offset:6864
    v_pk_mul_f32 v[236:237], v[226:227], v[232:233] op_sel:[0,0] op_sel_hi:[0,1]
    v_pk_fma_f32 v[226:227], v[226:227], v[232:233], v[236:237] op_sel:[1,1,0] op_sel_hi:[1,0,1] neg_lo:[1,0,0]
    v_cvt_pk_bf16_f32 v209, v226, v227
    ds_write_b32 v175, v209 offset:24288
    v_pk_mul_f32 v[234:235], v[186:187], v[192:193] op_sel:[0,0] op_sel_hi:[0,1]
    v_pk_fma_f32 v[186:187], v[186:187], v[192:193], v[234:235] op_sel:[1,1,0] op_sel_hi:[1,0,1] neg_lo:[1,0,0]
    v_cvt_pk_bf16_f32 v206, v186, -v187
    ds_write_b32 v175, v206 offset:7392
    v_pk_mul_f32 v[236:237], v[228:229], v[232:233] op_sel:[0,0] op_sel_hi:[0,1]
    v_pk_fma_f32 v[228:229], v[228:229], v[232:233], v[236:237] op_sel:[1,1,0] op_sel_hi:[1,0,1] neg_lo:[1,0,0]
    v_cvt_pk_bf16_f32 v207, v228, v229
    ds_write_b32 v175, v207 offset:24816
    v_pk_mul_f32 v[234:235], v[216:217], v[192:193] op_sel:[0,0] op_sel_hi:[0,1]
    v_pk_fma_f32 v[216:217], v[216:217], v[192:193], v[234:235] op_sel:[1,1,0] op_sel_hi:[1,0,1] neg_lo:[1,0,0]
    v_cvt_pk_bf16_f32 v208, v216, -v217
    ds_write_b32 v175, v208 offset:7920
    v_pk_mul_f32 v[236:237], v[230:231], v[232:233] op_sel:[0,0] op_sel_hi:[0,1]
    v_pk_fma_f32 v[230:231], v[230:231], v[232:233], v[236:237] op_sel:[1,1,0] op_sel_hi:[1,0,1] neg_lo:[1,0,0]
    v_cvt_pk_bf16_f32 v209, v230, v231
    ds_write_b32 v175, v209 offset:25344
    v_pk_mul_f32 v[234:235], v[186:187], v[192:193] op_sel:[0,0] op_sel_hi:[0,1]
    v_pk_fma_f32 v[186:187], v[186:187], v[192:193], v[234:235] op_sel:[1,1,0] op_sel_hi:[1,0,1] neg_lo:[1,0,0]
    v_cvt_pk_bf16_f32 v206, v186, -v187
    ds_write_b32 v175, v206 offset:8448
    v_pk_mul_f32 v[236:237], v[224:225], v[232:233] op_sel:[0,0] op_sel_hi:[0,1]
    v_pk_fma_f32 v[224:225], v[224:225], v[232:233], v[236:237] op_sel:[1,1,0] op_sel_hi:[1,0,1] neg_lo:[1,0,0]
    v_cvt_pk_bf16_f32 v207, v224, v225
    ds_write_b32 v175, v207 offset:25872
    v_pk_mul_f32 v[234:235], v[186:187], v[192:193] op_sel:[0,0] op_sel_hi:[0,1]
    v_pk_fma_f32 v[186:187], v[186:187], v[192:193], v[234:235] op_sel:[1,1,0] op_sel_hi:[1,0,1] neg_lo:[1,0,0]
    v_cvt_pk_bf16_f32 v208, v186, -v187
    ds_write_b32 v175, v208 offset:8976
    v_pk_mul_f32 v[236:237], v[226:227], v[232:233] op_sel:[0,0] op_sel_hi:[0,1]
    v_pk_fma_f32 v[226:227], v[226:227], v[232:233], v[236:237] op_sel:[1,1,0] op_sel_hi:[1,0,1] neg_lo:[1,0,0]
    v_cvt_pk_bf16_f32 v209, v226, v227
    ds_write_b32 v175, v209 offset:26400
    v_pk_mul_f32 v[234:235], v[186:187], v[192:193] op_sel:[0,0] op_sel_hi:[0,1]
    v_pk_fma_f32 v[186:187], v[186:187], v[192:193], v[234:235] op_sel:[1,1,0] op_sel_hi:[1,0,1] neg_lo:[1,0,0]
    v_cvt_pk_bf16_f32 v206, v186, -v187
    ds_write_b32 v175, v206 offset:9504
    v_pk_mul_f32 v[236:237], v[228:229], v[232:233] op_sel:[0,0] op_sel_hi:[0,1]
    v_pk_fma_f32 v[228:229], v[228:229], v[232:233], v[236:237] op_sel:[1,1,0] op_sel_hi:[1,0,1] neg_lo:[1,0,0]
    v_cvt_pk_bf16_f32 v207, v228, v229
    ds_write_b32 v175, v207 offset:26928
    v_pk_mul_f32 v[234:235], v[186:187], v[192:193] op_sel:[0,0] op_sel_hi:[0,1]
    v_pk_fma_f32 v[186:187], v[186:187], v[192:193], v[234:235] op_sel:[1,1,0] op_sel_hi:[1,0,1] neg_lo:[1,0,0]
    v_cvt_pk_bf16_f32 v208, v186, -v187
    ds_write_b32 v175, v208 offset:10032
    s_cmp_ge_u32 s20, 2
    s_cbranch_scc1 P_PB
    s_waitcnt vmcnt(0)
P_PB:
    s_barrier
    s_add_u32 s66, s66, 0x9e3779b9
    s_add_u32 s67, s67, 0x7f4a7c15
    v_mov_b32 v238, s66
    v_mov_b32 v239, s67
    v_lshlrev_b32 v7, 11, v0
    v_and_b32 v8, 0xf0, v0
    v_lshl_add_u32 v7, v8, 22, v7
    s_lshl_b32 s3, s2, 3
    s_add_u32 s3, s3, 262144
    buffer_store_dwordx2 v[238:239], v7, s[40:43], s3 offen sc1
    v_pk_mul_f32 v[236:237], v[230:231], v[232:233] op_sel:[0,0] op_sel_hi:[0,1]
    v_pk_fma_f32 v[230:231], v[230:231], v[232:233], v[236:237] op_sel:[1,1,0] op_sel_hi:[1,0,1] neg_lo:[1,0,0]
    v_cvt_pk_bf16_f32 v209, v230, v231
    ds_write_b32 v175, v209 offset:27456
    v_pk_mul_f32 v[234:235], v[186:187], v[192:193] op_sel:[0,0] op_sel_hi:[0,1]
    v_pk_fma_f32 v[186:187], v[186:187], v[192:193], v[234:235] op_sel:[1,1,0] op_sel_hi:[1,0,1] neg_lo:[1,0,0]
    v_cvt_pk_bf16_f32 v206, v186, -v187
    ds_write_b32 v175, v206 offset:10560
    v_lshrrev_b32 v157, 6, v0
    s_cmp_lt_u32 s2, 176
    s_cbranch_scc1 P_G2
    s_cmp_lt_u32 s2, 234
    s_cbranch_scc0 P_K2
    s_sub_u32 s37, s2, 176
    s_mul_i32 s34, s37, 24576
    s_lshl_b32 s35, s20, 11
    s_add_u32 s34, s34, s35
    s_add_u32 s12, s4, 20971520
    s_addc_u32 s13, s5, 0
    s_mov_b32 s14, 1409024
    s_mov_b32 s15, 0x20000
    v_bfe_u32 v8, v0, 2, 2
    v_mul_u32_u24 v156, 1088, v8
    v_and_b32 v8, 3, v0
    v_lshl_add_u32 v156, v8, 3, v156
    v_bfe_u32 v8, v0, 4, 2
    v_lshl_add_u32 v156, v8, 5, v156
    v_lshl_add_u32 v156, v157, 8, v156
    v_add_u32 v156, 93696, v156
    v_add_u32 v158, s34, v5
    v_add_u32 v9, 8192, v158
    v_add_u32 v10, 16384, v158
    s_waitcnt vmcnt(0)
    s_barrier
    ds_read_b64_tr_b16 v[52:53], v156 offset:0
    ds_read_b64_tr_b16 v[54:55], v156 offset:4352
    ds_read_b64_tr_b16 v[56:57], v156 offset:128
    ds_read_b64_tr_b16 v[58:59], v156 offset:4480
    ds_read_b64_tr_b16 v[60:61], v156 offset:8704
    ds_read_b64_tr_b16 v[62:63], v156 offset:13056
    ds_read_b64_tr_b16 v[64:65], v156 offset:8832
    ds_read_b64_tr_b16 v[66:67], v156 offset:13184
    ds_read_b64_tr_b16 v[68:69], v156 offset:17408
    ds_read_b64_tr_b16 v[70:71], v156 offset:21760
    ds_read_b64_tr_b16 v[72:73], v156 offset:17536
    ds_read_b64_tr_b16 v[74:75], v156 offset:21888
    s_waitcnt lgkmcnt(0)
    buffer_store_dwordx4 v[52:55], v158, s[12:15], 0 offen offset:0 sc1
    buffer_store_dwordx4 v[56:59], v158, s[12:15], 0 offen offset:1024 sc1
    buffer_store_dwordx4 v[60:63], v9, s[12:15], 0 offen offset:0 sc1
    buffer_store_dwordx4 v[64:67], v9, s[12:15], 0 offen offset:1024 sc1
    buffer_store_dwordx4 v[68:71], v10, s[12:15], 0 offen offset:0 sc1
    buffer_store_dwordx4 v[72:75], v10, s[12:15], 0 offen offset:1024 sc1
    s_branch P_K2
P_G2:
    v_bfe_u32 v7, v0, 4, 3
    v_lshlrev_b32 v156, 5, v7
    v_and_b32 v8, 15, v0
    v_mul_u32_u24 v8, 1032, v8
    v_add3_u32 v156, v156, v8, s38
    v_bfe_u32 v7, v0, 4, 2
    v_bfe_u32 v8, v0, 2, 2
    v_lshl_add_u32 v8, v7, 3, v8
    v_lshlrev_b32 v158, 5, v8
    v_and_b32 v8, 3, v0
    v_lshl_add_u32 v158, v8, 3, v158
    s_mul_i32 s34, s20, 4128
    s_add_u32 s34, s34, 93696
    v_add_u32 v158, s34, v158
    s_and_b32 s34, s2, 0xf0
    s_lshl_b32 s35, s20, 2
    s_add_u32 s34, s34, s35
    s_and_b32 s36, s2, 15
    s_lshl_b32 s35, s34, 14
    s_lshl_b32 s3, s36, 10
    s_add_u32 s35, s35, s3
    v_add_u32 v159, s35, v5
    s_add_u32 s8, s4, 16777216
    s_addc_u32 s9, s5, 0
    s_mov_b32 s10, 2818048
    s_mov_b32 s11, 0x20000
    s_add_u32 s12, s4, 25952256
    s_addc_u32 s13, s5, 0
    s_mov_b32 s14, 176128
    s_mov_b32 s15, 0x20000
    s_lshl_b32 s35, s34, 10
    s_lshl_b32 s3, s36, 6
    s_add_u32 s35, s35, s3
    v_and_b32 v8, 15, v0
    v_lshl_add_u32 v9, v8, 2, s35
    v_lshl_add_u32 v9, v7, 10, v9
    s_cmp_lt_u32 s20, 2
    s_cbranch_scc1 P_GW
    s_waitcnt vmcnt(11)
    ds_write2_b32 v156, v52, v56 offset0:0 offset1:1
    ds_write2_b32 v156, v53, v57 offset0:2 offset1:3
    ds_write2_b32 v156, v54, v58 offset0:4 offset1:5
    ds_write2_b32 v156, v55, v59 offset0:6 offset1:7
    s_waitcnt vmcnt(9)
    ds_write2_b32 v156, v60, v64 offset0:64 offset1:65
    ds_write2_b32 v156, v61, v65 offset0:66 offset1:67
    ds_write2_b32 v156, v62, v66 offset0:68 offset1:69
    ds_write2_b32 v156, v63, v67 offset0:70 offset1:71
    s_waitcnt vmcnt(7)
    ds_write2_b32 v156, v68, v72 offset0:128 offset1:129
    ds_write2_b32 v156, v69, v73 offset0:130 offset1:131
    ds_write2_b32 v156, v70, v74 offset0:132 offset1:133
    ds_write2_b32 v156, v71, v75 offset0:134 offset1:135
    s_waitcnt vmcnt(5)
    ds_write2_b32 v156, v76, v80 offset0:192 offset1:193
    ds_write2_b32 v156, v77, v81 offset0:194 offset1:195
    ds_write2_b32 v156, v78, v82 offset0:196 offset1:197
    ds_write2_b32 v156, v79, v83 offset0:198 offset1:199
P_GW:
    s_waitcnt vmcnt(0) lgkmcnt(0)
    s_barrier
    ds_read_b64_tr_b16 v[52:53], v158 offset:0
    ds_read_b64_tr_b16 v[54:55], v158 offset:128
    ds_read_b64_tr_b16 v[56:57], v158 offset:1032
    ds_read_b64_tr_b16 v[58:59], v158 offset:1160
    ds_read_b64_tr_b16 v[60:61], v158 offset:2064
    ds_read_b64_tr_b16 v[62:63], v158 offset:2192
    ds_read_b64_tr_b16 v[64:65], v158 offset:3096
    ds_read_b64_tr_b16 v[66:67], v158 offset:3224
    v_mov_b32 v68, 0
    v_mov_b32 v69, 0
    v_mov_b32 v70, 0
    v_mov_b32 v71, 0
    v_mov_b32 v160, 0x3f803f80
    s_mov_b32 s34, 0
    s_waitcnt lgkmcnt(0)
    buffer_store_dwordx4 v[52:55], v159, s[8:11], s34 offen sc1
    s_add_u32 s34, s34, 16384
    v_dot2c_f32_bf16 v68, v52, v160
    v_dot2c_f32_bf16 v68, v53, v160
    v_dot2c_f32_bf16 v68, v54, v160
    v_dot2c_f32_bf16 v68, v55, v160
    buffer_store_dwordx4 v[56:59], v159, s[8:11], s34 offen sc1
    s_add_u32 s34, s34, 16384
    v_dot2c_f32_bf16 v69, v56, v160
    v_dot2c_f32_bf16 v69, v57, v160
    v_dot2c_f32_bf16 v69, v58, v160
    v_dot2c_f32_bf16 v69, v59, v160
    buffer_store_dwordx4 v[60:63], v159, s[8:11], s34 offen sc1
    s_add_u32 s34, s34, 16384
    v_dot2c_f32_bf16 v70, v60, v160
    v_dot2c_f32_bf16 v70, v61, v160
    v_dot2c_f32_bf16 v70, v62, v160
    v_dot2c_f32_bf16 v70, v63, v160
    buffer_store_dwordx4 v[64:67], v159, s[8:11], s34 offen sc1
    s_add_u32 s34, s34, 16384
    v_dot2c_f32_bf16 v71, v64, v160
    v_dot2c_f32_bf16 v71, v65, v160
    v_dot2c_f32_bf16 v71, v66, v160
    v_dot2c_f32_bf16 v71, v67, v160
    v_permlane32_swap_b32 v68, v70
    s_nop 1
    v_permlane32_swap_b32 v69, v71
    v_add_f32 v68, v68, v70
    v_add_f32 v69, v69, v71
    s_nop 1
    v_permlane16_swap_b32 v68, v69
    v_add_f32 v68, v68, v69
    buffer_store_dword v68, v9, s[12:15], 0 offen sc1
P_K2:
    s_waitcnt lgkmcnt(0)
    s_barrier
    s_and_b32 s3, s2, 15
    s_lshl_b32 s3, s3, 11
    s_add_u32 s31, s3, 262144
    v_add_u32 v9, v32, v5
    buffer_load_dwordx4 v[248:251], v9, s[40:43], s31 offen sc1
    buffer_load_dwordx4 v[252:255], v9, s[40:43], s31 offen offset:1024 sc1
    ds_read_b128 v[84:87], v179 offset:0
    ds_read_b128 v[88:91], v179 offset:8448
    ds_read_b128 v[92:95], v180 offset:11088
    ds_read_b128 v[96:99], v179 offset:64
    ds_read_b128 v[100:103], v179 offset:8512
    ds_read_b128 v[104:107], v180 offset:11152
    ds_read_b128 v[108:111], v179 offset:128
    ds_read_b128 v[112:115], v179 offset:8576
    ds_read_b128 v[116:119], v180 offset:11216
    ds_read_b128 v[120:123], v179 offset:192
    ds_read_b128 v[124:127], v179 offset:8640
    ds_read_b128 v[128:131], v180 offset:11280
    ds_read_b128 v[132:135], v179 offset:256
    ds_read_b128 v[136:139], v179 offset:8704
    ds_read_b128 v[140:143], v180 offset:11344
    s_waitcnt lgkmcnt(12)
    v_mfma_f32_16x16x32_bf16 v[240:243], v[84:87], v[92:95], 0
    v_mfma_f32_16x16x32_bf16 v[244:247], v[88:91], v[92:95], 0
    ds_read_b128 v[144:147], v179 offset:320
    ds_read_b128 v[148:151], v179 offset:8768
    ds_read_b128 v[152:155], v180 offset:11408
    s_waitcnt lgkmcnt(12)
    v_mfma_f32_16x16x32_bf16 v[240:243], v[96:99], v[104:107], v[240:243]
    v_mfma_f32_16x16x32_bf16 v[244:247], v[100:103], v[104:107], v[244:247]
    ds_read_b128 v[84:87], v179 offset:384
    ds_read_b128 v[88:91], v179 offset:8832
    ds_read_b128 v[92:95], v180 offset:11472
    s_waitcnt lgkmcnt(12)
    v_mfma_f32_16x16x32_bf16 v[240:243], v[108:111], v[116:119], v[240:243]
    v_mfma_f32_16x16x32_bf16 v[244:247], v[112:115], v[116:119], v[244:247]
    ds_read_b128 v[96:99], v179 offset:448
    ds_read_b128 v[100:103], v179 offset:8896
    ds_read_b128 v[104:107], v180 offset:11536
    s_mov_b32 s76, 0x3b000000
    s_mov_b32 s77, 0x3b000000
    s_lshl_b32 s28, s27, 16
    s_and_b32 s29, s27, 0xffff0000
    s_lshl_b32 s33, s23, 5
    s_add_u32 s33, s33, 0
    s_add_u32 s8, s4, 25231360
    s_addc_u32 s9, s5, 0
    s_mov_b32 s10, 16384
    s_mov_b32 s11, 0x20000
    s_add_u32 s12, s4, s33
    s_addc_u32 s13, s5, 0
    s_mov_b32 s14, 2088992
    s_mov_b32 s15, 0x20000
    s_lshl_b32 s33, s23, 8
    s_add_u32 s33, s33, 2097152
    s_add_u32 s16, s4, s33
    s_addc_u32 s17, s5, 0
    s_mov_b32 s18, 2031872
    s_mov_b32 s19, 0x20000
    s_waitcnt lgkmcnt(12)
    v_mfma_f32_16x16x32_bf16 v[240:243], v[120:123], v[128:131], v[240:243]
    v_mfma_f32_16x16x32_bf16 v[244:247], v[124:127], v[128:131], v[244:247]
    s_waitcnt lgkmcnt(9)
    v_mfma_f32_16x16x32_bf16 v[240:243], v[132:135], v[140:143], v[240:243]
    v_mfma_f32_16x16x32_bf16 v[244:247], v[136:139], v[140:143], v[244:247]
    s_waitcnt lgkmcnt(6)
    v_mfma_f32_16x16x32_bf16 v[240:243], v[144:147], v[152:155], v[240:243]
    v_mfma_f32_16x16x32_bf16 v[244:247], v[148:151], v[152:155], v[244:247]
    s_waitcnt lgkmcnt(3)
    v_mfma_f32_16x16x32_bf16 v[240:243], v[84:87], v[92:95], v[240:243]
    v_mfma_f32_16x16x32_bf16 v[244:247], v[88:91], v[92:95], v[244:247]
    s_waitcnt lgkmcnt(0)
    v_mfma_f32_16x16x32_bf16 v[240:243], v[96:99], v[104:107], v[240:243]
    v_mfma_f32_16x16x32_bf16 v[244:247], v[100:103], v[104:107], v[244:247]
    s_nop 6
    v_cvt_pk_bf16_f32 v206, v240, v241
    v_cvt_pk_bf16_f32 v207, v242, v243
    v_cvt_pk_bf16_f32 v208, v244, v245
    v_cvt_pk_bf16_f32 v209, v246, v247
    ds_write_b32 v183, v206
    ds_write_b32 v184, v207
    ds_write_b16 v185, v208 offset:1024
    ds_write_b16_d16_hi v185, v208 offset:1088
    ds_write_b16 v185, v209 offset:1152
    ds_write_b16_d16_hi v185, v209 offset:1216
    v_lshrrev_b32 v7, 1, v0
    v_lshlrev_b32 v70, 13, v7
    v_and_b32 v7, 1, v0
    v_lshl_add_u32 v70, v7, 3, v70
    s_cmp_lg_u32 s20, 0
    s_cbranch_scc1 S2_D0
    s_waitcnt vmcnt(0)
S2_D0:
    s_cmp_lg_u32 s20, 0
    s_cbranch_scc1 S2_D1
    s_mov_b32 s33, 0x40000
S2_L1:
    v_cmp_ne_u64 vcc, s[66:67], v[248:249]
    v_cmp_ne_u64 s[34:35], s[66:67], v[250:251]
    s_or_b64 vcc, vcc, s[34:35]
    v_cmp_ne_u64 s[34:35], s[66:67], v[252:253]
    s_or_b64 vcc, vcc, s[34:35]
    v_cmp_ne_u64 s[34:35], s[66:67], v[254:255]
    s_or_b64 vcc, vcc, s[34:35]
    s_cbranch_scc0 S2_OK1
    s_sub_u32 s33, s33, 1
    s_cbranch_scc1 S2_OK1
    s_sleep 1
    buffer_load_dwordx4 v[248:251], v5, s[40:43], s31 offen sc1
    buffer_load_dwordx4 v[252:255], v5, s[40:43], s31 offen offset:1024 sc1
    s_waitcnt vmcnt(0)
    s_branch S2_L1
S2_OK1:
S2_D1:
    s_waitcnt lgkmcnt(0)
    s_barrier
    buffer_load_dwordx4 v[84:87], v35, s[8:11], s68 offen sc1
    buffer_load_dwordx4 v[88:91], v35, s[8:11], s70 offen sc1
    buffer_load_dwordx2 v[92:93], v70, s[12:15], 0 offen offset:0 sc1
    buffer_load_dwordx2 v[94:95], v70, s[12:15], 0 offen offset:16 sc1
    ds_read_u16 v96, v164 offset:0
    ds_read_u16 v97, v165 offset:0
    ds_read_u16 v98, v166 offset:0
    ds_read_u16 v99, v167 offset:0
    ds_read_u16 v100, v168 offset:0
    ds_read_u16 v101, v169 offset:0
    ds_read_u16 v102, v170 offset:0
    ds_read_u16 v103, v171 offset:0
    ds_read_u16 v104, v172 offset:0
    ds_read_u16 v105, v173 offset:0
    ds_read_u16 v106, v174 offset:0
    ds_read_u16 v108, v164 offset:2048
    ds_read_u16 v109, v165 offset:2048
    ds_read_u16 v110, v166 offset:2048
    ds_read_u16 v111, v167 offset:2048
    ds_read_u16 v112, v168 offset:2048
    ds_read_u16 v113, v169 offset:2048
    ds_read_u16 v114, v170 offset:2048
    ds_read_u16 v115, v171 offset:2048
    ds_read_u16 v116, v172 offset:2048
    ds_read_u16 v117, v173 offset:2048
    ds_read_u16 v118, v174 offset:2048
    s_waitcnt lgkmcnt(11)
    v_lshl_or_b32 v120, v97, 16, v96
    v_lshl_or_b32 v121, v99, 16, v98
    v_lshl_or_b32 v122, v101, 16, v100
    v_lshl_or_b32 v123, v103, 16, v102
    ds_write_b128 v35, v[120:123] offset:0
    v_lshl_or_b32 v124, v98, 16, v97
    v_lshl_or_b32 v125, v100, 16, v99
    v_lshl_or_b32 v126, v102, 16, v101
    v_lshl_or_b32 v127, v104, 16, v103
    ds_write_b128 v35, v[124:127] offset:4160
    v_lshl_or_b32 v128, v99, 16, v98
    v_lshl_or_b32 v129, v101, 16, v100
    v_lshl_or_b32 v130, v103, 16, v102
    v_lshl_or_b32 v131, v105, 16, v104
    ds_write_b128 v35, v[128:131] offset:8320
    v_lshl_or_b32 v132, v100, 16, v99
    v_lshl_or_b32 v133, v102, 16, v101
    v_lshl_or_b32 v134, v104, 16, v103
    v_lshl_or_b32 v135, v106, 16, v105
    ds_write_b128 v35, v[132:135] offset:12480
    s_waitcnt lgkmcnt(4)
    v_lshl_or_b32 v136, v109, 16, v108
    v_lshl_or_b32 v137, v111, 16, v110
    v_lshl_or_b32 v138, v113, 16, v112
    v_lshl_or_b32 v139, v115, 16, v114
    ds_write_b128 v35, v[136:139] offset:16640
    v_lshl_or_b32 v140, v110, 16, v109
    v_lshl_or_b32 v141, v112, 16, v111
    v_lshl_or_b32 v142, v114, 16, v113
    v_lshl_or_b32 v143, v116, 16, v115
    ds_write_b128 v35, v[140:143] offset:20800
    v_lshl_or_b32 v144, v111, 16, v110
    v_lshl_or_b32 v145, v113, 16, v112
    v_lshl_or_b32 v146, v115, 16, v114
    v_lshl_or_b32 v147, v117, 16, v116
    ds_write_b128 v35, v[144:147] offset:24960
    v_lshl_or_b32 v148, v112, 16, v111
    v_lshl_or_b32 v149, v114, 16, v113
    v_lshl_or_b32 v150, v116, 16, v115
    v_lshl_or_b32 v151, v118, 16, v117
    ds_write_b128 v35, v[148:151] offset:29120
    v_bfe_u32 v7, v0, 6, 1
    v_mul_u32_u24 v7, 4608, v7
    v_lshrrev_b32 v8, 1, v5
    v_add3_u32 v7, v7, v8, s30
    v_mov_b32 v8, 0
    ds_write2_b32 v7, v8, v8 offset0:0 offset1:1
    s_waitcnt vmcnt(4) lgkmcnt(0)
    s_barrier
    ds_read_b64 a[192:193], v39 offset:3776
    ds_read_b64 a[194:195], v39 offset:3784
    ds_read_b64 a[196:197], v39 offset:3264
    ds_read_b64 a[198:199], v39 offset:3272
    ds_read_b64 a[200:201], v39 offset:2752
    ds_read_b64 a[202:203], v39 offset:2760
    ds_read_b64 a[204:205], v39 offset:2240
    ds_read_b64 a[206:207], v39 offset:2248
    ds_read_b64 a[208:209], v39 offset:3712
    ds_read_b64 a[210:211], v39 offset:3720
    ds_read_b64 a[212:213], v39 offset:3200
    ds_read_b64 a[214:215], v39 offset:3208
    ds_read_b64 a[216:217], v39 offset:2688
    ds_read_b64 a[218:219], v39 offset:2696
    ds_read_b64 a[220:221], v39 offset:2176
    ds_read_b64 a[222:223], v39 offset:2184
    ds_read_b64 a[224:225], v39 offset:3648
    ds_read_b64 a[226:227], v39 offset:3656
    ds_read_b64 a[228:229], v39 offset:3136
    ds_read_b64 a[230:231], v39 offset:3144
    ds_read_b64 a[232:233], v39 offset:2624
    ds_read_b64 a[234:235], v39 offset:2632
    ds_read_b64 a[236:237], v39 offset:2112
    ds_read_b64 a[238:239], v39 offset:2120
    ds_read_b64 a[240:241], v39 offset:3584
    ds_read_b64 a[242:243], v39 offset:3592
    ds_read_b64 a[244:245], v39 offset:3072
    ds_read_b64 a[246:247], v39 offset:3080
    ds_read_b64 a[248:249], v39 offset:2560
    ds_read_b64 a[250:251], v39 offset:2568
    ds_read_b64 a[252:253], v39 offset:2048
    ds_read_b64 a[254:255], v39 offset:2056
    v_mov_b32 v238, s66
    v_mov_b32 v239, s67
    v_lshlrev_b32 v7, 11, v0
    v_and_b32 v8, 0xf0, v0
    v_lshl_add_u32 v7, v8, 22, v7
    s_lshl_b32 s3, s2, 3
    s_add_u32 s3, s3, 294912
    buffer_store_dwordx2 v[238:239], v7, s[40:43], s3 offen sc1
    s_add_u32 s56, s4, 2097152
    s_addc_u32 s57, s5, 0
    s_mov_b32 s58, 2097152
    s_mov_b32 s59, 0x20000
    s_lshl_b32 s33, s24, 15
    s_add_u32 s33, s33, 8388608
    s_add_u32 s92, s4, s33
    s_addc_u32 s93, s5, 0
    s_mov_b32 s94, 65536
    s_mov_b32 s95, 0x20000
    s_add_u32 s84, s4, 8388608
    s_addc_u32 s85, s5, 0
    s_mov_b32 s86, 5636096
    s_mov_b32 s87, 0x20000
    s_lshl_b32 s78, s21, 8
    s_add_u32 s78, s78, 65536
    s_add_u32 s79, s78, 128
    v_mov_b32 v68, 0x3727c5ac
    s_waitcnt vmcnt(3)
    v_pk_mul_f32 v[84:85], v[84:85], s[76:77]
    v_pk_fma_f32 v[88:89], v[88:89], s[76:77], v[68:69] op_sel_hi:[1,1,0]
    v_pk_mul_f32 v[86:87], v[86:87], s[76:77]
    v_pk_fma_f32 v[90:91], v[90:91], s[76:77], v[68:69] op_sel_hi:[1,1,0]
    v_pk_fma_f32 v[88:89], v[84:85], v[84:85], v[88:89] neg_lo:[1,0,0] neg_hi:[1,0,0]
    v_pk_fma_f32 v[90:91], v[86:87], v[86:87], v[90:91] neg_lo:[1,0,0] neg_hi:[1,0,0]
    v_max_f32 v88, v68, v88
    v_max_f32 v89, v68, v89
    v_max_f32 v90, v68, v90
    v_max_f32 v91, v68, v91
    v_rsq_f32 v96, v88
    v_rsq_f32 v97, v89
    v_rsq_f32 v98, v90
    v_rsq_f32 v99, v91
    s_waitcnt vmcnt(1)
    v_lshlrev_b32 v44, 16, v92
    v_and_b32 v45, 0xffff0000, v92
    v_lshlrev_b32 v46, 16, v93
    v_and_b32 v47, 0xffff0000, v93
    v_lshlrev_b32 v48, 16, v94
    v_and_b32 v49, 0xffff0000, v94
    v_lshlrev_b32 v50, 16, v95
    v_and_b32 v51, 0xffff0000, v95
    v_pk_mul_f32 v[80:81], v[84:85], v[96:97] neg_lo:[1,0] neg_hi:[1,0]
    v_pk_mul_f32 v[82:83], v[86:87], v[98:99] neg_lo:[1,0] neg_hi:[1,0]
    v_pk_fma_f32 v[60:61], v[44:45], v[96:97], v[80:81]
    v_pk_fma_f32 v[62:63], v[46:47], v[98:99], v[82:83]
    v_cvt_pk_bf16_f32 v76, v60, v61
    v_cvt_pk_bf16_f32 v77, v62, v63
    ds_write_b64 v37, v[76:77] offset:33792
    v_pk_fma_f32 v[64:65], v[48:49], v[96:97], v[80:81]
    v_pk_fma_f32 v[66:67], v[50:51], v[98:99], v[82:83]
    v_cvt_pk_bf16_f32 v78, v64, v65
    v_cvt_pk_bf16_f32 v79, v66, v67
    ds_write_b64 v37, v[78:79] offset:38400
    v_pk_fma_f32 v[44:45], v[60:61], s[28:29], v[44:45] op_sel:[0,0,0] op_sel_hi:[1,0,1]
    v_pk_fma_f32 v[46:47], v[62:63], s[28:29], v[46:47] op_sel:[0,0,0] op_sel_hi:[1,0,1]
    v_pk_fma_f32 v[48:49], v[64:65], s[28:29], v[48:49] op_sel:[0,1,0] op_sel_hi:[1,1,1]
    v_pk_fma_f32 v[50:51], v[66:67], s[28:29], v[50:51] op_sel:[0,1,0] op_sel_hi:[1,1,1]
    s_waitcnt lgkmcnt(0)
    s_barrier
    buffer_load_dwordx4 v[84:87], v35, s[8:11], s69 offen sc1
    buffer_load_dwordx4 v[88:91], v35, s[8:11], s71 offen sc1
    buffer_load_dwordx2 v[92:93], v70, s[12:15], s97 offen offset:0 sc1
    buffer_load_dwordx2 v[94:95], v70, s[12:15], s97 offen offset:16 sc1
    ds_read_b128 v[152:155], v40 offset:192
    ds_read_b128 v[156:159], v40 offset:704
    ds_read_b128 v[160:163], v40 offset:1216
    ds_read_b128 v[164:167], v40 offset:1728
    ds_read_b128 v[168:171], v40 offset:128
    ds_read_b128 v[172:175], v40 offset:640
    ds_read_b128 v[176:179], v40 offset:1152
    ds_read_b128 v[180:183], v40 offset:1664
    s_waitcnt lgkmcnt(7)
    v_mfma_f32_16x16x32_bf16 v[120:123], a[192:195], v[152:155], 0
    ds_read_b128 v[184:187], v40 offset:64
    ds_read_b128 v[188:191], v40 offset:576
    v_mfma_f32_16x16x32_bf16 v[124:127], a[196:199], v[152:155], 0
    ds_read_b128 v[192:195], v40 offset:1088
    ds_read_b128 v[196:199], v40 offset:1600
    v_mfma_f32_16x16x32_bf16 v[128:131], a[200:203], v[152:155], 0
    ds_read_b128 v[200:203], v40 offset:0
    ds_read_b128 v[204:207], v40 offset:512
    v_mfma_f32_16x16x32_bf16 v[132:135], a[204:207], v[152:155], 0
    ds_read_b128 v[208:211], v40 offset:1024
    ds_read_b128 v[212:215], v40 offset:1536
    s_waitcnt lgkmcnt(14)
    v_mfma_f32_16x16x32_bf16 v[124:127], a[192:195], v[156:159], v[124:127]
    ds_read_b64 v[216:217], v39 offset:1728
    ds_read_b64 v[218:219], v39 offset:1736
    v_mfma_f32_16x16x32_bf16 v[128:131], a[196:199], v[156:159], v[128:131]
    ds_read_b64 v[220:221], v39 offset:1216
    ds_read_b64 v[222:223], v39 offset:1224
    v_mfma_f32_16x16x32_bf16 v[132:135], a[200:203], v[156:159], v[132:135]
    ds_read_b64 v[224:225], v39 offset:704
    ds_read_b64 v[226:227], v39 offset:712
    s_waitcnt lgkmcnt(14)
    v_mfma_f32_16x16x32_bf16 v[128:131], a[192:195], v[160:163], v[128:131]
    ds_read_b64 v[228:229], v39 offset:192
    ds_read_b64 v[230:231], v39 offset:200
    v_mfma_f32_16x16x32_bf16 v[132:135], a[196:199], v[160:163], v[132:135]
    v_bfe_u32 v72, v0, 4, 1
    v_bfe_u32 v73, v0, 1, 2
    v_mfma_f32_16x16x32_bf16 v[132:135], a[192:195], v[164:167], v[132:135]
    v_xor_b32 v72, v72, v73
    v_bfe_u32 v73, v0, 3, 3
    v_mfma_f32_16x16x32_bf16 v[120:123], a[208:211], v[168:171], v[120:123]
    v_lshlrev_b32 v11, 7, v73
    v_lshl_add_u32 v11, v72, 5, v11
    v_mfma_f32_16x16x32_bf16 v[124:127], a[212:215], v[168:171], v[124:127]
    v_and_b32 v72, 1, v0
    v_lshl_add_u32 v11, v72, 4, v11
    v_mfma_f32_16x16x32_bf16 v[128:131], a[216:219], v[168:171], v[128:131]
    v_xor_b32 v12, 64, v11
    v_bfe_u32 v72, v0, 4, 2
    v_mfma_f32_16x16x32_bf16 v[132:135], a[220:223], v[168:171], v[132:135]
    v_bfe_u32 v73, v0, 2, 2
    v_lshl_add_u32 v74, v72, 3, v73
    v_mfma_f32_16x16x32_bf16 v[124:127], a[208:211], v[172:175], v[124:127]
    v_lshlrev_b32 v74, 7, v74
    v_and_b32 v75, 3, v0
    v_mfma_f32_16x16x32_bf16 v[128:131], a[212:215], v[172:175], v[128:131]
    v_lshl_add_u32 v74, v75, 3, v74
    v_and_b32 v72, 1, v72
    v_mfma_f32_16x16x32_bf16 v[132:135], a[216:219], v[172:175], v[132:135]
    v_lshrrev_b32 v73, 1, v73
    v_lshl_or_b32 v73, v72, 1, v73
    v_mfma_f32_16x16x32_bf16 v[128:131], a[208:211], v[176:179], v[128:131]
    s_add_u32 s26, s20, 0
    s_and_b32 s26, s26, 3
    v_mfma_f32_16x16x32_bf16 v[132:135], a[212:215], v[176:179], v[132:135]
    v_xor_b32 v72, s26, v73
    v_lshl_add_u32 v13, v72, 5, v74
    v_mfma_f32_16x16x32_bf16 v[132:135], a[208:211], v[180:183], v[132:135]
    s_add_u32 s26, s20, 1
    s_and_b32 s26, s26, 3
    s_waitcnt lgkmcnt(14)
    v_mfma_f32_16x16x32_bf16 v[120:123], a[224:227], v[184:187], v[120:123]
    v_xor_b32 v72, s26, v73
    v_lshl_add_u32 v14, v72, 5, v74
    v_mfma_f32_16x16x32_bf16 v[124:127], a[228:231], v[184:187], v[124:127]
    s_add_u32 s26, s20, 2
    s_and_b32 s26, s26, 3
    v_mfma_f32_16x16x32_bf16 v[128:131], a[232:235], v[184:187], v[128:131]
    v_xor_b32 v72, s26, v73
    v_lshl_add_u32 v15, v72, 5, v74
    v_mfma_f32_16x16x32_bf16 v[132:135], a[236:239], v[184:187], v[132:135]
    s_add_u32 s26, s20, 3
    s_and_b32 s26, s26, 3
    v_mfma_f32_16x16x32_bf16 v[124:127], a[224:227], v[188:191], v[124:127]
    v_xor_b32 v72, s26, v73
    v_lshl_add_u32 v16, v72, 5, v74
    v_mfma_f32_16x16x32_bf16 v[128:131], a[228:231], v[188:191], v[128:131]
    v_and_b32 v72, 15, v0
    v_lshlrev_b32 v18, 2, v72
    v_mfma_f32_16x16x32_bf16 v[132:135], a[232:235], v[188:191], v[132:135]
    v_add_u32 v18, 140800, v18
    s_lshl_b32 s26, s20, 6
    s_waitcnt lgkmcnt(13)
    v_mfma_f32_16x16x32_bf16 v[128:131], a[224:227], v[192:195], v[128:131]
    s_add_u32 s26, s26, 256
    v_add_u32 v17, s26, v18
    v_mfma_f32_16x16x32_bf16 v[132:135], a[228:231], v[192:195], v[132:135]
    v_and_b32 v73, 63, v0
    v_lshlrev_b32 v19, 2, v73
    s_waitcnt lgkmcnt(12)
    v_mfma_f32_16x16x32_bf16 v[132:135], a[224:227], v[196:199], v[132:135]
    v_add_u32 v19, 140800, v19
    v_lshrrev_b32 v74, 4, v73
    s_add_u32 s31, s31, 32768
    v_add_u32 v9, v32, v5
    buffer_load_dwordx4 v[248:251], v9, s[40:43], s31 offen sc1
    buffer_load_dwordx4 v[252:255], v9, s[40:43], s31 offen offset:1024 sc1
    s_waitcnt lgkmcnt(11)
    v_mfma_f32_16x16x32_bf16 v[120:123], a[240:243], v[200:203], v[120:123]
    v_subrev_u32 v74, s20, v74
    v_and_b32 v74, 3, v74
    v_mfma_f32_16x16x32_bf16 v[124:127], a[244:247], v[200:203], v[124:127]
    v_lshlrev_b32 v74, 8, v74
    s_lshl_b32 s26, s20, 10
    v_mfma_f32_16x16x32_bf16 v[128:131], a[248:251], v[200:203], v[128:131]
    s_add_u32 s26, s26, 141824
    v_lshl_add_u32 v21, v72, 4, s26
    v_mfma_f32_16x16x32_bf16 v[132:135], a[252:255], v[200:203], v[132:135]
    v_add_u32 v20, v21, v74
    v_bfe_u32 v73, v0, 4, 2
    s_waitcnt lgkmcnt(10)
    v_mfma_f32_16x16x32_bf16 v[124:127], a[240:243], v[204:207], v[124:127]
    v_add_u32 v73, s20, v73
    v_and_b32 v73, 3, v73
    v_mfma_f32_16x16x32_bf16 v[128:131], a[244:247], v[204:207], v[128:131]
    v_lshlrev_b32 v72, 4, v72
    v_lshl_add_u32 v22, v73, 8, v72
    v_mfma_f32_16x16x32_bf16 v[132:135], a[248:251], v[204:207], v[132:135]
    s_lshl_b32 s26, s21, 10
    v_add_u32 v22, s26, v22
    s_waitcnt lgkmcnt(9)
    v_mfma_f32_16x16x32_bf16 v[128:131], a[240:243], v[208:211], v[128:131]
    s_lshl_b32 s0, s21, 6
    s_bfe_u32 s26, s22, 0x10002
    v_mfma_f32_16x16x32_bf16 v[132:135], a[244:247], v[208:211], v[132:135]
    s_lshl_b32 s26, s26, 5
    s_add_u32 s0, s0, s26
    s_waitcnt lgkmcnt(8)
    v_mfma_f32_16x16x32_bf16 v[132:135], a[240:243], v[212:215], v[132:135]
    s_lshr_b32 s1, s22, 3
    s_lshl_b32 s1, s1, 2
    v_mfma_f32_16x16x32_bf16 v[136:139], a[196:199], v[164:167], 0
    s_and_b32 s26, s22, 3
    s_add_u32 s1, s1, s26
    v_mfma_f32_16x16x32_bf16 v[136:139], a[200:203], v[160:163], v[136:139]
    s_lshl_b32 s1, s1, 6
    s_and_b32 s26, s20, 1
    ds_write_b128 v41, v[120:123] offset:42496
    ds_write_b128 v41, v[124:127] offset:43776
    ds_write_b128 v41, v[128:131] offset:45056
    ds_write_b128 v41, v[132:135] offset:46336
    v_mfma_f32_16x16x32_bf16 v[140:143], a[200:203], v[164:167], 0
    s_lshl_b32 s26, s26, 5
    s_add_u32 s1, s1, s26
    v_mfma_f32_16x16x32_bf16 v[136:139], a[204:207], v[156:159], v[136:139]
    s_lshr_b32 s26, s20, 1
    s_lshl_b32 s26, s26, 4
    v_mfma_f32_16x16x32_bf16 v[140:143], a[204:207], v[160:163], v[140:143]
    s_add_u32 s27, s0, s26
    v_and_b32 v72, 31, v0
    v_mfma_f32_16x16x32_bf16 v[144:147], a[204:207], v[164:167], 0
    v_bfe_u32 v73, v0, 5, 1
    v_lshlrev_b32 v74, 4, v72
    s_waitcnt lgkmcnt(0)
    s_barrier
    ds_read_b128 v[104:107], v42 offset:42496
    ds_read_b128 v[108:111], v42 offset:47616
    ds_read_b128 v[112:115], v42 offset:52736
    ds_read_b128 v[116:119], v42 offset:57856
    v_mfma_f32_16x16x32_bf16 v[136:139], a[212:215], v[180:183], v[136:139]
    v_lshl_add_u32 v75, v73, 13, v74
    s_mul_i32 s26, s20, 360448
    v_mfma_f32_16x16x32_bf16 v[136:139], a[216:219], v[176:179], v[136:139]
    s_lshl_b32 s32, s1, 4
    s_add_u32 s26, s26, s32
    v_mfma_f32_16x16x32_bf16 v[140:143], a[216:219], v[180:183], v[140:143]
    v_add_u32 v23, s26, v75
    v_xor_b32 v24, 0x200, v23
    v_mfma_f32_16x16x32_bf16 v[136:139], a[220:223], v[172:175], v[136:139]
    s_lshr_b32 s26, s20, 1
    s_lshl_b32 s26, s26, 8
    s_waitcnt lgkmcnt(2)
    v_pk_add_f32 v[104:105], v[104:105], v[108:109]
    v_pk_add_f32 v[106:107], v[106:107], v[110:111]
    v_pk_add_f32 v[104:105], v[104:105], v[44:45]
    v_pk_add_f32 v[106:107], v[106:107], v[46:47]
    v_cvt_pk_bf16_f32 v108, v104, v105
    v_cvt_pk_bf16_f32 v109, v106, v107
    buffer_store_dwordx2 v[108:109], v38, s[16:19], 0 offen offset:0 sc1
    s_waitcnt lgkmcnt(0)
    v_pk_add_f32 v[112:113], v[112:113], v[116:117]
    v_pk_add_f32 v[114:115], v[114:115], v[118:119]
    v_pk_add_f32 v[112:113], v[112:113], v[48:49]
    v_pk_add_f32 v[114:115], v[114:115], v[50:51]
    v_cvt_pk_bf16_f32 v116, v112, v113
    v_cvt_pk_bf16_f32 v117, v114, v115
    buffer_store_dwordx2 v[116:117], v38, s[16:19], 0 offen offset:128 sc1
    v_mfma_f32_16x16x32_bf16 v[140:143], a[220:223], v[176:179], v[140:143]
    v_xor_b32 v74, s26, v74
    v_lshl_add_u32 v74, v73, 15, v74
    v_mfma_f32_16x16x32_bf16 v[144:147], a[220:223], v[180:183], v[144:147]
    s_mul_i32 s26, s20, 1441792
    s_lshl_b32 s32, s0, 4
    v_mfma_f32_16x16x32_bf16 v[136:139], a[228:231], v[196:199], v[136:139]
    s_add_u32 s26, s26, s32
    v_add_u32 v25, s26, v74
    v_mfma_f32_16x16x32_bf16 v[136:139], a[232:235], v[192:195], v[136:139]
    v_add_u32 v74, s1, v72
    v_lshlrev_b32 v26, 7, v74
    v_mfma_f32_16x16x32_bf16 v[140:143], a[232:235], v[196:199], v[140:143]
    ds_read_b64 v[232:233], v39 offset:1664
    ds_read_b64 v[234:235], v39 offset:1672
    v_mfma_f32_16x16x32_bf16 v[136:139], a[236:239], v[188:191], v[136:139]
    ds_read_b64 v[236:237], v39 offset:1152
    ds_read_b64 v[238:239], v39 offset:1160
    v_mfma_f32_16x16x32_bf16 v[140:143], a[236:239], v[192:195], v[140:143]
    ds_read_b64 v[240:241], v39 offset:640
    ds_read_b64 v[242:243], v39 offset:648
    v_mfma_f32_16x16x32_bf16 v[144:147], a[236:239], v[196:199], v[144:147]
    ds_read_b64 v[244:245], v39 offset:128
    ds_read_b64 v[246:247], v39 offset:136
    v_mfma_f32_16x16x32_bf16 v[136:139], a[244:247], v[212:215], v[136:139]
    v_lshl_add_u32 v26, v73, 3, v26
    v_bfe_u32 v75, v0, 1, 1
    v_mfma_f32_16x16x32_bf16 v[136:139], a[248:251], v[208:211], v[136:139]
    v_bfe_u32 v34, v0, 3, 1
    v_lshl_or_b32 v75, v34, 1, v75
    v_mfma_f32_16x16x32_bf16 v[140:143], a[248:251], v[212:215], v[140:143]
    s_bfe_u32 s26, s27, 0x20004
    v_xor_b32 v75, s26, v75
    v_mfma_f32_16x16x32_bf16 v[136:139], a[252:255], v[204:207], v[136:139]
    v_lshl_add_u32 v26, v75, 5, v26
    v_lshlrev_b32 v34, 5, v74
    v_mfma_f32_16x16x32_bf16 v[140:143], a[252:255], v[208:211], v[140:143]
    v_lshl_add_u32 v34, v73, 4, v34
    s_lshl_b32 s26, s27, 10
    v_mfma_f32_16x16x32_bf16 v[144:147], a[252:255], v[212:215], v[144:147]
    v_add_u32 v34, s26, v34
    s_lshl_b32 s26, s20, 13
    v_mfma_f32_16x16x32_bf16 v[136:139], v[216:219], v[152:155], v[136:139]
    s_add_u32 s26, s26, 98304
    v_add_u32 v27, s26, v5
    v_mfma_f32_16x16x32_bf16 v[140:143], v[216:219], v[156:159], v[140:143]
    v_mul_u32_u24 v28, 48, v72
    v_lshl_add_u32 v28, v73, 4, v28
    v_mfma_f32_16x16x32_bf16 v[144:147], v[216:219], v[160:163], v[144:147]
    s_mul_i32 s32, s20, 1536
    s_add_u32 s32, s32, 75264
    v_mfma_f32_16x16x32_bf16 v[148:151], v[216:219], v[164:167], 0
    v_add_u32 v28, s32, v28
    v_bfe_u32 v72, v0, 4, 2
    v_mfma_f32_16x16x32_bf16 v[140:143], v[220:223], v[152:155], v[140:143]
    v_bfe_u32 v74, v0, 2, 2
    v_lshl_add_u32 v74, v72, 3, v74
    v_mfma_f32_16x16x32_bf16 v[144:147], v[220:223], v[156:159], v[144:147]
    v_mul_u32_u24 v29, 48, v74
    v_and_b32 v74, 3, v0
    v_mfma_f32_16x16x32_bf16 v[148:151], v[220:223], v[160:163], v[148:151]
    v_lshl_add_u32 v29, v74, 3, v29
    v_add_u32 v29, s32, v29
    v_mfma_f32_16x16x32_bf16 v[144:147], v[224:227], v[152:155], v[144:147]
    v_and_b32 v72, 15, v0
    v_add_u32 v72, s27, v72
    s_waitcnt vmcnt(2)
    s_cmp_lg_u32 s20, 0
    s_cbranch_scc1 S2_D2
    s_mov_b32 s33, 0x40000
S2_L2:
    v_cmp_ne_u64 vcc, s[66:67], v[248:249]
    v_cmp_ne_u64 s[34:35], s[66:67], v[250:251]
    s_or_b64 vcc, vcc, s[34:35]
    v_cmp_ne_u64 s[34:35], s[66:67], v[252:253]
    s_or_b64 vcc, vcc, s[34:35]
    v_cmp_ne_u64 s[34:35], s[66:67], v[254:255]
    s_or_b64 vcc, vcc, s[34:35]
    s_cbranch_scc0 S2_OK2
    s_sub_u32 s33, s33, 1
    s_cbranch_scc1 S2_OK2
    s_sleep 1
    buffer_load_dwordx4 v[248:251], v5, s[40:43], s31 offen sc1
    buffer_load_dwordx4 v[252:255], v5, s[40:43], s31 offen offset:1024 sc1
    s_waitcnt vmcnt(0)
    s_branch S2_L2
S2_OK2:
    s_cmp_lg_u32 s2, 0
    s_cbranch_scc1 S2_D2
    v_mov_b32 v248, s66
    v_mov_b32 v249, s67
    s_mov_b32 s3, 327680
    buffer_store_dwordx2 v[248:249], v33, s[40:43], s3 offen sc1
S2_D2:
    s_waitcnt vmcnt(0)
    s_barrier
    s_mov_b32 s3, 0
    buffer_atomic_add v4, v2, s[40:43], s3 offen
    v_mfma_f32_16x16x32_bf16 v[148:151], v[224:227], v[156:159], v[148:151]
    v_lshlrev_b32 v74, 2, v72
    v_lshl_add_u32 v74, v73, 13, v74
    v_mfma_f32_16x16x32_bf16 v[148:151], v[228:231], v[152:155], v[148:151]
    v_and_b32 v75, 16, v0
    v_lshl_add_u32 v30, v75, 26, v74
    s_waitcnt lgkmcnt(6)
    v_mfma_f32_16x16x32_bf16 v[136:139], v[232:235], v[168:171], v[136:139]
    ds_read_b64 v[216:217], v39 offset:1600
    ds_read_b64 v[218:219], v39 offset:1608
    v_mfma_f32_16x16x32_bf16 v[140:143], v[232:235], v[172:175], v[140:143]
    buffer_load_dwordx4 a[0:3], v5, s[44:47], s68 offen offset:0 sc1
    v_mfma_f32_16x16x32_bf16 v[144:147], v[232:235], v[176:179], v[144:147]
    ds_read_b64 v[220:221], v39 offset:1088
    ds_read_b64 v[222:223], v39 offset:1096
    v_mfma_f32_16x16x32_bf16 v[148:151], v[232:235], v[180:183], v[148:151]
    ds_read_b64 v[224:225], v39 offset:576
    ds_read_b64 v[226:227], v39 offset:584
    s_waitcnt lgkmcnt(10)
    v_mfma_f32_16x16x32_bf16 v[140:143], v[236:239], v[168:171], v[140:143]
    ds_read_b64 v[228:229], v39 offset:64
    ds_read_b64 v[230:231], v39 offset:72
    v_mfma_f32_16x16x32_bf16 v[144:147], v[236:239], v[172:175], v[144:147]
    buffer_load_dwordx4 a[4:7], v5, s[48:51], s68 offen offset:0 sc1
    v_mfma_f32_16x16x32_bf16 v[148:151], v[236:239], v[176:179], v[148:151]
    v_lshlrev_b32 v31, 10, v72
    v_and_b32 v72, 0x30, v0
    s_waitcnt lgkmcnt(10)
    v_mfma_f32_16x16x32_bf16 v[144:147], v[240:243], v[168:171], v[144:147]
    s_lshl_b32 s26, s1, 1
    v_add3_u32 v31, v31, v72, s26
    v_mfma_f32_16x16x32_bf16 v[148:151], v[240:243], v[172:175], v[148:151]
    v_add_u32 v13, 75264, v13
    v_add_u32 v14, 75264, v14
    s_waitcnt lgkmcnt(8)
    v_mfma_f32_16x16x32_bf16 v[148:151], v[244:247], v[168:171], v[148:151]
    buffer_load_dwordx4 a[8:11], v6, s[52:55], s68 offen offset:0 sc1
    s_waitcnt lgkmcnt(6)
    v_mfma_f32_16x16x32_bf16 v[136:139], v[216:219], v[184:187], v[136:139]
    ds_read_b64 v[232:233], v39 offset:1536
    ds_read_b64 v[234:235], v39 offset:1544
    v_mfma_f32_16x16x32_bf16 v[140:143], v[216:219], v[188:191], v[140:143]
    ds_read_b64 v[236:237], v39 offset:1024
    ds_read_b64 v[238:239], v39 offset:1032
    v_mfma_f32_16x16x32_bf16 v[144:147], v[216:219], v[192:195], v[144:147]
    ds_read_b64 v[240:241], v39 offset:512
    ds_read_b64 v[242:243], v39 offset:520
    v_mfma_f32_16x16x32_bf16 v[148:151], v[216:219], v[196:199], v[148:151]
    buffer_load_dwordx4 a[12:15], v5, s[44:47], s68 offen offset:1024 sc1
    s_waitcnt lgkmcnt(10)
    v_mfma_f32_16x16x32_bf16 v[140:143], v[220:223], v[184:187], v[140:143]
    ds_read_b64 v[244:245], v39 offset:0
    ds_read_b64 v[246:247], v39 offset:8
    v_mfma_f32_16x16x32_bf16 v[144:147], v[220:223], v[188:191], v[144:147]
    v_add_u32 v15, 75264, v15
    v_add_u32 v16, 75264, v16
    v_mfma_f32_16x16x32_bf16 v[148:151], v[220:223], v[192:195], v[148:151]
    s_waitcnt lgkmcnt(10)
    v_mfma_f32_16x16x32_bf16 v[144:147], v[224:227], v[184:187], v[144:147]
    buffer_load_dwordx4 a[16:19], v5, s[48:51], s68 offen offset:1024 sc1
    v_mfma_f32_16x16x32_bf16 v[148:151], v[224:227], v[188:191], v[148:151]
    s_waitcnt lgkmcnt(8)
    v_mfma_f32_16x16x32_bf16 v[148:151], v[228:231], v[184:187], v[148:151]
    s_waitcnt lgkmcnt(0)
    v_pk_mul_f32 v[84:85], v[84:85], s[76:77]
    v_pk_fma_f32 v[88:89], v[88:89], s[76:77], v[68:69] op_sel_hi:[1,1,0]
    v_pk_mul_f32 v[86:87], v[86:87], s[76:77]
    v_pk_fma_f32 v[90:91], v[90:91], s[76:77], v[68:69] op_sel_hi:[1,1,0]
    v_pk_fma_f32 v[88:89], v[84:85], v[84:85], v[88:89] neg_lo:[1,0,0] neg_hi:[1,0,0]
    v_pk_fma_f32 v[90:91], v[86:87], v[86:87], v[90:91] neg_lo:[1,0,0] neg_hi:[1,0,0]
    v_max_f32 v88, v68, v88
    v_max_f32 v89, v68, v89
    v_max_f32 v90, v68, v90
    v_max_f32 v91, v68, v91
    v_rsq_f32 v96, v88
    v_rsq_f32 v97, v89
    v_rsq_f32 v98, v90
    v_rsq_f32 v99, v91
    buffer_load_dwordx4 a[20:23], v6, s[52:55], s68 offen offset:1024 sc1
    v_lshlrev_b32 v52, 16, v92
    v_and_b32 v53, 0xffff0000, v92
    v_lshlrev_b32 v54, 16, v93
    v_and_b32 v55, 0xffff0000, v93
    v_lshlrev_b32 v56, 16, v94
    v_and_b32 v57, 0xffff0000, v94
    v_lshlrev_b32 v58, 16, v95
    v_and_b32 v59, 0xffff0000, v95
    v_pk_mul_f32 v[80:81], v[84:85], v[96:97] neg_lo:[1,0] neg_hi:[1,0]
    v_pk_mul_f32 v[82:83], v[86:87], v[98:99] neg_lo:[1,0] neg_hi:[1,0]
    v_pk_fma_f32 v[60:61], v[52:53], v[96:97], v[80:81]
    v_pk_fma_f32 v[62:63], v[54:55], v[98:99], v[82:83]
    v_cvt_pk_bf16_f32 v76, v60, v61
    v_cvt_pk_bf16_f32 v77, v62, v63
    ds_write_b64 v37, v[76:77] offset:35840
    v_pk_fma_f32 v[64:65], v[56:57], v[96:97], v[80:81]
    v_pk_fma_f32 v[66:67], v[58:59], v[98:99], v[82:83]
    v_cvt_pk_bf16_f32 v78, v64, v65
    v_cvt_pk_bf16_f32 v79, v66, v67
    ds_write_b64 v37, v[78:79] offset:40448
    buffer_load_dwordx4 a[24:27], v5, s[44:47], s68 offen offset:2048 sc1
    v_pk_fma_f32 v[52:53], v[60:61], s[28:29], v[52:53] op_sel:[0,0,0] op_sel_hi:[1,0,1]
    v_pk_fma_f32 v[54:55], v[62:63], s[28:29], v[54:55] op_sel:[0,0,0] op_sel_hi:[1,0,1]
    v_pk_fma_f32 v[56:57], v[64:65], s[28:29], v[56:57] op_sel:[0,1,0] op_sel_hi:[1,1,1]
    v_pk_fma_f32 v[58:59], v[66:67], s[28:29], v[58:59] op_sel:[0,1,0] op_sel_hi:[1,1,1]
    s_getpc_b64 s[38:39]
PF1:
    v_lshlrev_b32 v7, 7, v0
    s_mov_b32 s3, M_END-PF1
    s_min_u32 s3, s3, 20480
    v_min_u32 v7, s3, v7
    global_load_dword v43, v7, s[38:39]
    s_waitcnt lgkmcnt(0)
    s_barrier
    ds_read_b128 v[152:155], v40 offset:2240
    ds_read_b128 v[156:159], v40 offset:2752
    ds_read_b128 v[160:163], v40 offset:3264
    ds_read_b128 v[164:167], v40 offset:3776
    ds_read_b128 v[168:171], v40 offset:2176
    ds_read_b128 v[172:175], v40 offset:2688
    ds_read_b128 v[176:179], v40 offset:3200
    ds_read_b128 v[180:183], v40 offset:3712
    v_mfma_f32_16x16x32_bf16 v[136:139], v[232:235], v[200:203], v[136:139]
    ds_read_b128 v[184:187], v40 offset:2112
    ds_read_b128 v[188:191], v40 offset:2624
    v_mfma_f32_16x16x32_bf16 v[140:143], v[232:235], v[204:207], v[140:143]
    buffer_load_dwordx4 a[28:31], v5, s[48:51], s68 offen offset:2048 sc1
    v_mfma_f32_16x16x32_bf16 v[144:147], v[232:235], v[208:211], v[144:147]
    ds_read_b128 v[192:195], v40 offset:3136
    ds_read_b128 v[196:199], v40 offset:3648
    v_mfma_f32_16x16x32_bf16 v[148:151], v[232:235], v[212:215], v[148:151]
    v_mfma_f32_16x16x32_bf16 v[140:143], v[236:239], v[200:203], v[140:143]
    v_mfma_f32_16x16x32_bf16 v[144:147], v[236:239], v[204:207], v[144:147]
    buffer_load_dwordx4 a[32:35], v6, s[52:55], s68 offen offset:2048 sc1
    v_mfma_f32_16x16x32_bf16 v[148:151], v[236:239], v[208:211], v[148:151]
    v_mfma_f32_16x16x32_bf16 v[144:147], v[240:243], v[200:203], v[144:147]
    v_mfma_f32_16x16x32_bf16 v[148:151], v[240:243], v[204:207], v[148:151]
    v_mfma_f32_16x16x32_bf16 v[148:151], v[244:247], v[200:203], v[148:151]
    buffer_load_dwordx4 a[36:39], v5, s[44:47], s68 offen offset:3072 sc1
    s_waitcnt lgkmcnt(11)
    v_mfma_f32_16x16x32_bf16 v[136:139], a[192:195], v[152:155], v[136:139]
    ds_read_b128 v[200:203], v40 offset:2048
    ds_read_b128 v[204:207], v40 offset:2560
    v_mfma_f32_16x16x32_bf16 v[140:143], a[196:199], v[152:155], v[140:143]
    ds_read_b128 v[208:211], v40 offset:3072
    ds_read_b128 v[212:215], v40 offset:3584
    v_mfma_f32_16x16x32_bf16 v[144:147], a[200:203], v[152:155], v[144:147]
    s_lshl_b32 s37, s20, 12
    s_add_u32 m0, s37, 75264
    v_mfma_f32_16x16x32_bf16 v[148:151], a[204:207], v[152:155], v[148:151]
    buffer_load_dwordx4 a[40:43], v5, s[48:51], s68 offen offset:3072 sc1
    s_waitcnt lgkmcnt(14)
    v_mfma_f32_16x16x32_bf16 v[140:143], a[192:195], v[156:159], v[140:143]
    s_lshl_b32 s34, s21, 16
    s_add_u32 s34, s34, s37
    v_mfma_f32_16x16x32_bf16 v[144:147], a[196:199], v[156:159], v[144:147]
    s_lshl_b32 s33, s24, 15
    s_add_u32 s33, s33, 8454144
    v_mfma_f32_16x16x32_bf16 v[148:151], a[200:203], v[156:159], v[148:151]
    s_add_u32 s64, s4, s33
    s_addc_u32 s65, s5, 0
    s_cmp_eq_u32 s25, 3
    s_cselect_b32 s66, 32768, 0
    s_waitcnt lgkmcnt(13)
    v_mfma_f32_16x16x32_bf16 v[144:147], a[192:195], v[160:163], v[144:147]
    buffer_load_dwordx4 a[44:47], v6, s[52:55], s68 offen offset:3072 sc1
    v_mfma_f32_16x16x32_bf16 v[148:151], a[196:199], v[160:163], v[148:151]
    s_mov_b32 s67, 0x20000
    s_waitcnt lgkmcnt(12)
    v_mfma_f32_16x16x32_bf16 v[148:151], a[192:195], v[164:167], v[148:151]
    s_waitcnt lgkmcnt(11)
    v_mfma_f32_16x16x32_bf16 v[136:139], a[208:211], v[168:171], v[136:139]
    v_mfma_f32_16x16x32_bf16 v[140:143], a[212:215], v[168:171], v[140:143]
    buffer_load_dwordx4 a[48:51], v5, s[44:47], s69 offen offset:0 sc1
    v_mfma_f32_16x16x32_bf16 v[144:147], a[216:219], v[168:171], v[144:147]
    v_mfma_f32_16x16x32_bf16 v[148:151], a[220:223], v[168:171], v[148:151]
    s_waitcnt lgkmcnt(10)
    v_mfma_f32_16x16x32_bf16 v[140:143], a[208:211], v[172:175], v[140:143]
    v_mfma_f32_16x16x32_bf16 v[144:147], a[212:215], v[172:175], v[144:147]
    buffer_load_dwordx4 a[52:55], v5, s[48:51], s69 offen offset:0 sc1
    v_mfma_f32_16x16x32_bf16 v[148:151], a[216:219], v[172:175], v[148:151]
    s_waitcnt lgkmcnt(9)
    v_mfma_f32_16x16x32_bf16 v[144:147], a[208:211], v[176:179], v[144:147]
    v_mfma_f32_16x16x32_bf16 v[148:151], a[212:215], v[176:179], v[148:151]
    s_waitcnt lgkmcnt(8)
    v_mfma_f32_16x16x32_bf16 v[148:151], a[208:211], v[180:183], v[148:151]
    buffer_load_dwordx4 a[56:59], v6, s[52:55], s69 offen offset:0 sc1
    s_waitcnt lgkmcnt(7)
    v_mfma_f32_16x16x32_bf16 v[136:139], a[224:227], v[184:187], v[136:139]
    v_mfma_f32_16x16x32_bf16 v[140:143], a[228:231], v[184:187], v[140:143]
    v_mfma_f32_16x16x32_bf16 v[144:147], a[232:235], v[184:187], v[144:147]
    v_mfma_f32_16x16x32_bf16 v[148:151], a[236:239], v[184:187], v[148:151]
    buffer_load_dwordx4 a[60:63], v5, s[44:47], s69 offen offset:1024 sc1
    s_waitcnt lgkmcnt(6)
    v_mfma_f32_16x16x32_bf16 v[140:143], a[224:227], v[188:191], v[140:143]
    v_mfma_f32_16x16x32_bf16 v[144:147], a[228:231], v[188:191], v[144:147]
    v_mfma_f32_16x16x32_bf16 v[148:151], a[232:235], v[188:191], v[148:151]
    s_waitcnt lgkmcnt(5)
    v_mfma_f32_16x16x32_bf16 v[144:147], a[224:227], v[192:195], v[144:147]
    buffer_load_dwordx4 a[64:67], v5, s[48:51], s69 offen offset:1024 sc1
    v_mfma_f32_16x16x32_bf16 v[148:151], a[228:231], v[192:195], v[148:151]
    s_waitcnt lgkmcnt(4)
    v_mfma_f32_16x16x32_bf16 v[148:151], a[224:227], v[196:199], v[148:151]
    s_mov_b32 s3, 0
    buffer_load_dword v43, v3, s[40:43], s3 offen sc1
    s_waitcnt lgkmcnt(3)
    v_mfma_f32_16x16x32_bf16 v[136:139], a[240:243], v[200:203], v[136:139]
    v_mfma_f32_16x16x32_bf16 v[140:143], a[244:247], v[200:203], v[140:143]
    buffer_load_dwordx4 a[68:71], v6, s[52:55], s69 offen offset:1024 sc1
    v_mfma_f32_16x16x32_bf16 v[144:147], a[248:251], v[200:203], v[144:147]
    v_mfma_f32_16x16x32_bf16 v[148:151], a[252:255], v[200:203], v[148:151]
    s_waitcnt lgkmcnt(2)
    v_mfma_f32_16x16x32_bf16 v[140:143], a[240:243], v[204:207], v[140:143]
    v_mfma_f32_16x16x32_bf16 v[144:147], a[244:247], v[204:207], v[144:147]
    buffer_load_dwordx4 a[72:75], v5, s[44:47], s69 offen offset:2048 sc1
    v_mfma_f32_16x16x32_bf16 v[148:151], a[248:251], v[204:207], v[148:151]
    s_waitcnt lgkmcnt(1)
    v_mfma_f32_16x16x32_bf16 v[144:147], a[240:243], v[208:211], v[144:147]
    v_mfma_f32_16x16x32_bf16 v[148:151], a[244:247], v[208:211], v[148:151]
    s_waitcnt lgkmcnt(0)
    v_mfma_f32_16x16x32_bf16 v[148:151], a[240:243], v[212:215], v[148:151]
    buffer_load_dwordx4 a[76:79], v5, s[48:51], s69 offen offset:2048 sc1
    ds_write_b128 v41, v[136:139] offset:42496
    ds_write_b128 v41, v[140:143] offset:43776
    s_nop 1
    ds_write_b128 v41, v[144:147] offset:45056
    s_nop 1
    ds_write_b128 v41, v[148:151] offset:46336
    s_waitcnt lgkmcnt(0)
    s_barrier
    ds_read_b128 v[104:107], v42 offset:42496
    ds_read_b128 v[108:111], v42 offset:47616
    ds_read_b128 v[112:115], v42 offset:52736
    ds_read_b128 v[116:119], v42 offset:57856
    s_waitcnt lgkmcnt(2)
    v_pk_add_f32 v[104:105], v[104:105], v[108:109]
    v_pk_add_f32 v[106:107], v[106:107], v[110:111]
    v_pk_add_f32 v[104:105], v[104:105], v[52:53]
    v_pk_add_f32 v[106:107], v[106:107], v[54:55]
    v_cvt_pk_bf16_f32 v108, v104, v105
    v_cvt_pk_bf16_f32 v109, v106, v107
    buffer_store_dwordx2 v[108:109], v38, s[16:19], s97 offen offset:0 sc1
    s_waitcnt lgkmcnt(0)
    v_pk_add_f32 v[112:113], v[112:113], v[116:117]
    v_pk_add_f32 v[114:115], v[114:115], v[118:119]
    v_pk_add_f32 v[112:113], v[112:113], v[56:57]
    v_pk_add_f32 v[114:115], v[114:115], v[58:59]
    v_cvt_pk_bf16_f32 v116, v112, v113
    v_cvt_pk_bf16_f32 v117, v114, v115
    buffer_store_dwordx2 v[116:117], v38, s[16:19], s97 offen offset:128 sc1
    buffer_load_dwordx4 a[80:83], v6, s[52:55], s69 offen offset:2048 sc1
    buffer_load_dwordx4 a[84:87], v5, s[44:47], s69 offen offset:3072 sc1
    buffer_load_dwordx4 a[88:91], v5, s[48:51], s69 offen offset:3072 sc1
    buffer_load_dwordx4 a[92:95], v6, s[52:55], s69 offen offset:3072 sc1
    s_mov_b32 s3, 0
    s_cmp_lg_u32 s20, 0
    s_cbranch_scc1 PC_D2
    s_waitcnt vmcnt(9)
    s_mov_b32 s33, 0x40000
PC_L2:
    v_cmp_ne_u32 vcc, 16, v43
    s_cmp_eq_u64 vcc, 0
    s_cbranch_scc1 PC_D2
    s_sub_u32 s33, s33, 1
    s_cbranch_scc1 PC_D2
    s_sleep 1
    buffer_load_dword v43, v3, s[40:43], s3 offen sc1
    s_waitcnt vmcnt(0)
    s_branch PC_L2
PC_D2:
    s_barrier
    buffer_load_dwordx4 v11, s[56:59], s34 offen offset:0 sc1 lds
    buffer_load_dwordx4 v12, s[56:59], s34 offen offset:1024 sc1 lds
    buffer_load_dwordx4 v11, s[56:59], s34 offen offset:2048 sc1 lds
    buffer_load_dwordx4 v12, s[56:59], s34 offen offset:3072 sc1 lds
    s_add_u32 m0, s37, 91648
    s_add_u32 s34, s34, 16384
    buffer_load_dwordx4 v11, s[56:59], s34 offen offset:0 sc1 lds
    buffer_load_dwordx4 v12, s[56:59], s34 offen offset:1024 sc1 lds
    buffer_load_dwordx4 v11, s[56:59], s34 offen offset:2048 sc1 lds
    buffer_load_dwordx4 v12, s[56:59], s34 offen offset:3072 sc1 lds
    s_add_u32 m0, s37, 108032
    s_add_u32 s34, s34, 16384
    s_waitcnt vmcnt(4)
    s_barrier
    ds_read_b64_tr_b16 v[168:169], v13 offset:0
    ds_read_b64_tr_b16 v[170:171], v13 offset:512
    ds_read_b64_tr_b16 v[172:173], v14 offset:0
    ds_read_b64_tr_b16 v[174:175], v14 offset:512
    ds_read_b64_tr_b16 v[176:177], v15 offset:0
    ds_read_b64_tr_b16 v[178:179], v15 offset:512
    ds_read_b64_tr_b16 v[180:181], v16 offset:0
    ds_read_b64_tr_b16 v[182:183], v16 offset:512
    s_waitcnt lgkmcnt(4)
    v_mfma_f32_16x16x32_bf16 v[108:111], v[168:171], v[168:171], 0
    ds_read_b64_tr_b16 v[184:185], v13 offset:4096
    buffer_load_dwordx4 v11, s[56:59], s34 offen offset:0 sc1 lds
    v_mfma_f32_16x16x32_bf16 v[200:203], a[0:3], v[168:171], 0
    ds_read_b64_tr_b16 v[186:187], v13 offset:4608
    s_mov_b32 s36, 0
    v_mfma_f32_16x16x32_bf16 v[204:207], a[4:7], v[168:171], 0
    ds_read_b64_tr_b16 v[188:189], v14 offset:4096
    s_mov_b32 s35, 0
    v_mfma_f32_16x16x32_bf16 v[208:211], a[8:11], v[168:171], 0
    ds_read_b64_tr_b16 v[190:191], v14 offset:4608
    s_mov_b32 s12, 0x22222222
    v_mfma_f32_16x16x32_bf16 v[212:215], a[0:3], v[172:175], 0
    ds_read_b64_tr_b16 v[192:193], v15 offset:4096
    buffer_load_dwordx4 v12, s[56:59], s34 offen offset:1024 sc1 lds
    v_mfma_f32_16x16x32_bf16 v[216:219], a[4:7], v[172:175], 0
    ds_read_b64_tr_b16 v[194:195], v15 offset:4608
    s_mov_b32 s13, 0x22222222
    v_mfma_f32_16x16x32_bf16 v[220:223], a[8:11], v[172:175], 0
    ds_read_b64_tr_b16 v[196:197], v16 offset:4096
    s_waitcnt lgkmcnt(7)
    v_mfma_f32_16x16x32_bf16 v[224:227], a[0:3], v[176:179], 0
    ds_read_b64_tr_b16 v[198:199], v16 offset:4608
    s_mov_b32 s14, 0x44444444
    v_mfma_f32_16x16x32_bf16 v[228:231], a[4:7], v[176:179], 0
    buffer_load_dwordx4 v11, s[56:59], s34 offen offset:2048 sc1 lds
    s_mov_b32 s15, 0x44444444
    v_mfma_f32_16x16x32_bf16 v[232:235], a[8:11], v[176:179], 0
    s_mov_b32 s16, 0x88888888
    s_mov_b32 s17, 0x88888888
    v_mfma_f32_16x16x32_bf16 v[236:239], a[0:3], v[180:183], 0
    s_mov_b32 s18, 0xf0000f
    s_mov_b32 s19, 0xf0000f00
    v_mfma_f32_16x16x32_bf16 v[240:243], a[4:7], v[180:183], 0
    v_mfma_f32_16x16x32_bf16 v[244:247], a[8:11], v[180:183], 0
    buffer_load_dwordx4 v12, s[56:59], s34 offen offset:3072 sc1 lds
    s_waitcnt lgkmcnt(4)
    v_mfma_f32_16x16x32_bf16 v[108:111], v[184:187], v[184:187], v[108:111]
    ds_read_b64_tr_b16 v[168:169], v13 offset:8192
    s_add_u32 m0, s37, 124416
    v_mfma_f32_16x16x32_bf16 v[200:203], a[12:15], v[184:187], v[200:203]
    ds_read_b64_tr_b16 v[170:171], v13 offset:8704
    s_add_u32 s34, s34, 16384
    v_mfma_f32_16x16x32_bf16 v[204:207], a[16:19], v[184:187], v[204:207]
    ds_read_b64_tr_b16 v[172:173], v14 offset:8192
    v_mfma_f32_16x16x32_bf16 v[208:211], a[20:23], v[184:187], v[208:211]
    ds_read_b64_tr_b16 v[174:175], v14 offset:8704
    buffer_load_dwordx4 v11, s[56:59], s34 offen offset:0 sc1 lds
    v_mfma_f32_16x16x32_bf16 v[212:215], a[12:15], v[188:191], v[212:215]
    ds_read_b64_tr_b16 v[176:177], v15 offset:8192
    v_mfma_f32_16x16x32_bf16 v[216:219], a[16:19], v[188:191], v[216:219]
    ds_read_b64_tr_b16 v[178:179], v15 offset:8704
    v_mfma_f32_16x16x32_bf16 v[220:223], a[20:23], v[188:191], v[220:223]
    ds_read_b64_tr_b16 v[180:181], v16 offset:8192
    s_waitcnt lgkmcnt(7)
    v_mfma_f32_16x16x32_bf16 v[224:227], a[12:15], v[192:195], v[224:227]
    ds_read_b64_tr_b16 v[182:183], v16 offset:8704
    buffer_load_dwordx4 v12, s[56:59], s34 offen offset:1024 sc1 lds
    v_mfma_f32_16x16x32_bf16 v[228:231], a[16:19], v[192:195], v[228:231]
    v_mfma_f32_16x16x32_bf16 v[232:235], a[20:23], v[192:195], v[232:235]
    v_mfma_f32_16x16x32_bf16 v[236:239], a[12:15], v[196:199], v[236:239]
    v_mfma_f32_16x16x32_bf16 v[240:243], a[16:19], v[196:199], v[240:243]
    buffer_load_dwordx4 v11, s[56:59], s34 offen offset:2048 sc1 lds
    v_mfma_f32_16x16x32_bf16 v[244:247], a[20:23], v[196:199], v[244:247]
    s_waitcnt lgkmcnt(4)
    v_mfma_f32_16x16x32_bf16 v[108:111], v[168:171], v[168:171], v[108:111]
    ds_read_b64_tr_b16 v[184:185], v13 offset:12288
    v_mfma_f32_16x16x32_bf16 v[200:203], a[24:27], v[168:171], v[200:203]
    ds_read_b64_tr_b16 v[186:187], v13 offset:12800
    v_mfma_f32_16x16x32_bf16 v[204:207], a[28:31], v[168:171], v[204:207]
    ds_read_b64_tr_b16 v[188:189], v14 offset:12288
    buffer_load_dwordx4 v12, s[56:59], s34 offen offset:3072 sc1 lds
    v_mfma_f32_16x16x32_bf16 v[208:211], a[32:35], v[168:171], v[208:211]
    ds_read_b64_tr_b16 v[190:191], v14 offset:12800
    s_add_u32 m0, s37, 33280
    v_mfma_f32_16x16x32_bf16 v[212:215], a[24:27], v[172:175], v[212:215]
    ds_read_b64_tr_b16 v[192:193], v15 offset:12288
    s_add_u32 s34, s34, 999424
    v_mfma_f32_16x16x32_bf16 v[216:219], a[28:31], v[172:175], v[216:219]
    ds_read_b64_tr_b16 v[194:195], v15 offset:12800
    v_and_b32 v103, 0x30, v0
    v_mfma_f32_16x16x32_bf16 v[220:223], a[32:35], v[172:175], v[220:223]
    ds_read_b64_tr_b16 v[196:197], v16 offset:12288
    s_waitcnt lgkmcnt(7)
    v_mfma_f32_16x16x32_bf16 v[224:227], a[24:27], v[176:179], v[224:227]
    ds_read_b64_tr_b16 v[198:199], v16 offset:12800
    v_and_b32 v8, 15, v0
    v_mfma_f32_16x16x32_bf16 v[228:231], a[28:31], v[176:179], v[228:231]
    v_lshl_add_u32 v103, v8, 6, v103
    buffer_load_dwordx4 v[44:47], v103, s[60:63], 0 offen offset:0 sc1
    v_mfma_f32_16x16x32_bf16 v[232:235], a[32:35], v[176:179], v[232:235]
    v_mfma_f32_16x16x32_bf16 v[236:239], a[24:27], v[180:183], v[236:239]
    v_mfma_f32_16x16x32_bf16 v[240:243], a[28:31], v[180:183], v[240:243]
    v_mfma_f32_16x16x32_bf16 v[244:247], a[32:35], v[180:183], v[244:247]
    buffer_load_dwordx4 v[52:55], v103, s[60:63], 0 offen offset:1024 sc1
    s_waitcnt vmcnt(10)
    s_barrier
    s_waitcnt lgkmcnt(4)
    v_mfma_f32_16x16x32_bf16 v[108:111], v[184:187], v[184:187], v[108:111]
    ds_read_b64_tr_b16 v[168:169], v13 offset:16384
    s_mov_b32 s3, 32768
    v_mfma_f32_16x16x32_bf16 v[200:203], a[36:39], v[184:187], v[200:203]
    ds_read_b64_tr_b16 v[170:171], v13 offset:16896
    buffer_atomic_add v4, v2, s[40:43], s3 offen
    v_mfma_f32_16x16x32_bf16 v[204:207], a[40:43], v[184:187], v[204:207]
    ds_read_b64_tr_b16 v[172:173], v14 offset:16384
    v_mfma_f32_16x16x32_bf16 v[208:211], a[44:47], v[184:187], v[208:211]
    ds_read_b64_tr_b16 v[174:175], v14 offset:16896
    buffer_load_dwordx4 v[60:63], v103, s[60:63], 0 offen offset:2048 sc1
    v_mfma_f32_16x16x32_bf16 v[212:215], a[36:39], v[188:191], v[212:215]
    ds_read_b64_tr_b16 v[176:177], v15 offset:16384
    v_mfma_f32_16x16x32_bf16 v[216:219], a[40:43], v[188:191], v[216:219]
    ds_read_b64_tr_b16 v[178:179], v15 offset:16896
    v_mfma_f32_16x16x32_bf16 v[220:223], a[44:47], v[188:191], v[220:223]
    ds_read_b64_tr_b16 v[180:181], v16 offset:16384
    s_waitcnt lgkmcnt(7)
    v_mfma_f32_16x16x32_bf16 v[224:227], a[36:39], v[192:195], v[224:227]
    ds_read_b64_tr_b16 v[182:183], v16 offset:16896
    buffer_load_dwordx4 a[96:99], v5, s[44:47], s70 offen offset:0 sc1
    v_mfma_f32_16x16x32_bf16 v[228:231], a[40:43], v[192:195], v[228:231]
    v_mfma_f32_16x16x32_bf16 v[232:235], a[44:47], v[192:195], v[232:235]
    v_mfma_f32_16x16x32_bf16 v[236:239], a[36:39], v[196:199], v[236:239]
    v_mfma_f32_16x16x32_bf16 v[240:243], a[40:43], v[196:199], v[240:243]
    buffer_load_dwordx4 a[100:103], v5, s[48:51], s70 offen offset:0 sc1
    v_mfma_f32_16x16x32_bf16 v[244:247], a[44:47], v[196:199], v[244:247]
    s_waitcnt lgkmcnt(4)
    v_mfma_f32_16x16x32_bf16 v[108:111], v[168:171], v[168:171], v[108:111]
    ds_read_b64_tr_b16 v[184:185], v13 offset:20480
    v_mfma_f32_16x16x32_bf16 v[200:203], a[48:51], v[168:171], v[200:203]
    ds_read_b64_tr_b16 v[186:187], v13 offset:20992
    v_mfma_f32_16x16x32_bf16 v[204:207], a[52:55], v[168:171], v[204:207]
    ds_read_b64_tr_b16 v[188:189], v14 offset:20480
    buffer_load_dwordx4 a[104:107], v6, s[52:55], s70 offen offset:0 sc1
    v_mfma_f32_16x16x32_bf16 v[208:211], a[56:59], v[168:171], v[208:211]
    ds_read_b64_tr_b16 v[190:191], v14 offset:20992
    v_mfma_f32_16x16x32_bf16 v[212:215], a[48:51], v[172:175], v[212:215]
    ds_read_b64_tr_b16 v[192:193], v15 offset:20480
    v_mfma_f32_16x16x32_bf16 v[216:219], a[52:55], v[172:175], v[216:219]
    ds_read_b64_tr_b16 v[194:195], v15 offset:20992
    v_mfma_f32_16x16x32_bf16 v[220:223], a[56:59], v[172:175], v[220:223]
    ds_read_b64_tr_b16 v[196:197], v16 offset:20480
    s_waitcnt lgkmcnt(7)
    v_mfma_f32_16x16x32_bf16 v[224:227], a[48:51], v[176:179], v[224:227]
    ds_read_b64_tr_b16 v[198:199], v16 offset:20992
    buffer_load_dwordx4 a[108:111], v5, s[44:47], s70 offen offset:1024 sc1
    v_mfma_f32_16x16x32_bf16 v[228:231], a[52:55], v[176:179], v[228:231]
    v_mfma_f32_16x16x32_bf16 v[232:235], a[56:59], v[176:179], v[232:235]
    v_mfma_f32_16x16x32_bf16 v[236:239], a[48:51], v[180:183], v[236:239]
    v_mfma_f32_16x16x32_bf16 v[240:243], a[52:55], v[180:183], v[240:243]
    buffer_load_dwordx4 a[112:115], v5, s[48:51], s70 offen offset:1024 sc1
    v_mfma_f32_16x16x32_bf16 v[244:247], a[56:59], v[180:183], v[244:247]
    s_waitcnt lgkmcnt(4)
    v_mfma_f32_16x16x32_bf16 v[108:111], v[184:187], v[184:187], v[108:111]
    ds_read_b64_tr_b16 v[168:169], v13 offset:24576
    v_mfma_f32_16x16x32_bf16 v[200:203], a[60:63], v[184:187], v[200:203]
    ds_read_b64_tr_b16 v[170:171], v13 offset:25088
    v_mfma_f32_16x16x32_bf16 v[204:207], a[64:67], v[184:187], v[204:207]
    ds_read_b64_tr_b16 v[172:173], v14 offset:24576
    buffer_load_dwordx4 a[116:119], v6, s[52:55], s70 offen offset:1024 sc1
    v_mfma_f32_16x16x32_bf16 v[208:211], a[68:71], v[184:187], v[208:211]
    ds_read_b64_tr_b16 v[174:175], v14 offset:25088
    v_mfma_f32_16x16x32_bf16 v[212:215], a[60:63], v[188:191], v[212:215]
    ds_read_b64_tr_b16 v[176:177], v15 offset:24576
    v_mfma_f32_16x16x32_bf16 v[216:219], a[64:67], v[188:191], v[216:219]
    ds_read_b64_tr_b16 v[178:179], v15 offset:25088
    v_mfma_f32_16x16x32_bf16 v[220:223], a[68:71], v[188:191], v[220:223]
    ds_read_b64_tr_b16 v[180:181], v16 offset:24576
    s_waitcnt lgkmcnt(7)
    v_mfma_f32_16x16x32_bf16 v[224:227], a[60:63], v[192:195], v[224:227]
    ds_read_b64_tr_b16 v[182:183], v16 offset:25088
    buffer_load_dwordx4 a[120:123], v5, s[44:47], s70 offen offset:2048 sc1
    v_mfma_f32_16x16x32_bf16 v[228:231], a[64:67], v[192:195], v[228:231]
    v_mfma_f32_16x16x32_bf16 v[232:235], a[68:71], v[192:195], v[232:235]
    v_mfma_f32_16x16x32_bf16 v[236:239], a[60:63], v[196:199], v[236:239]
    v_mfma_f32_16x16x32_bf16 v[240:243], a[64:67], v[196:199], v[240:243]
    buffer_load_dwordx4 a[124:127], v5, s[48:51], s70 offen offset:2048 sc1
    v_mfma_f32_16x16x32_bf16 v[244:247], a[68:71], v[196:199], v[244:247]
    s_waitcnt lgkmcnt(4)
    v_mfma_f32_16x16x32_bf16 v[108:111], v[168:171], v[168:171], v[108:111]
    ds_read_b64_tr_b16 v[184:185], v13 offset:28672
    v_mfma_f32_16x16x32_bf16 v[200:203], a[72:75], v[168:171], v[200:203]
    ds_read_b64_tr_b16 v[186:187], v13 offset:29184
    v_mfma_f32_16x16x32_bf16 v[204:207], a[76:79], v[168:171], v[204:207]
    ds_read_b64_tr_b16 v[188:189], v14 offset:28672
    buffer_load_dwordx4 a[128:131], v6, s[52:55], s70 offen offset:2048 sc1
    v_mfma_f32_16x16x32_bf16 v[208:211], a[80:83], v[168:171], v[208:211]
    ds_read_b64_tr_b16 v[190:191], v14 offset:29184
    v_mfma_f32_16x16x32_bf16 v[212:215], a[72:75], v[172:175], v[212:215]
    ds_read_b64_tr_b16 v[192:193], v15 offset:28672
    v_mfma_f32_16x16x32_bf16 v[216:219], a[76:79], v[172:175], v[216:219]
    ds_read_b64_tr_b16 v[194:195], v15 offset:29184
    v_mfma_f32_16x16x32_bf16 v[220:223], a[80:83], v[172:175], v[220:223]
    ds_read_b64_tr_b16 v[196:197], v16 offset:28672
    s_waitcnt lgkmcnt(7)
    v_mfma_f32_16x16x32_bf16 v[224:227], a[72:75], v[176:179], v[224:227]
    ds_read_b64_tr_b16 v[198:199], v16 offset:29184
    buffer_load_dwordx4 a[132:135], v5, s[44:47], s70 offen offset:3072 sc1
    v_mfma_f32_16x16x32_bf16 v[228:231], a[76:79], v[176:179], v[228:231]
    v_mfma_f32_16x16x32_bf16 v[232:235], a[80:83], v[176:179], v[232:235]
    v_mfma_f32_16x16x32_bf16 v[236:239], a[72:75], v[180:183], v[236:239]
    v_mfma_f32_16x16x32_bf16 v[240:243], a[76:79], v[180:183], v[240:243]
    buffer_load_dwordx4 a[136:139], v5, s[48:51], s70 offen offset:3072 sc1
    v_mfma_f32_16x16x32_bf16 v[244:247], a[80:83], v[180:183], v[244:247]
    s_waitcnt vmcnt(15)
    s_barrier
    s_waitcnt lgkmcnt(4)
    v_mfma_f32_16x16x32_bf16 v[108:111], v[184:187], v[184:187], v[108:111]
    ds_read_b64_tr_b16 v[168:169], v13 offset:32768
    v_mfma_f32_16x16x32_bf16 v[200:203], a[84:87], v[184:187], v[200:203]
    ds_read_b64_tr_b16 v[170:171], v13 offset:33280
    v_mfma_f32_16x16x32_bf16 v[204:207], a[88:91], v[184:187], v[204:207]
    ds_read_b64_tr_b16 v[172:173], v14 offset:32768
    buffer_load_dwordx4 a[140:143], v6, s[52:55], s70 offen offset:3072 sc1
    v_mfma_f32_16x16x32_bf16 v[208:211], a[92:95], v[184:187], v[208:211]
    ds_read_b64_tr_b16 v[174:175], v14 offset:33280
    v_mfma_f32_16x16x32_bf16 v[212:215], a[84:87], v[188:191], v[212:215]
    ds_read_b64_tr_b16 v[176:177], v15 offset:32768
    v_mfma_f32_16x16x32_bf16 v[216:219], a[88:91], v[188:191], v[216:219]
    ds_read_b64_tr_b16 v[178:179], v15 offset:33280
    v_mfma_f32_16x16x32_bf16 v[220:223], a[92:95], v[188:191], v[220:223]
    ds_read_b64_tr_b16 v[180:181], v16 offset:32768
    s_waitcnt lgkmcnt(7)
    v_mfma_f32_16x16x32_bf16 v[224:227], a[84:87], v[192:195], v[224:227]
    ds_read_b64_tr_b16 v[182:183], v16 offset:33280
    buffer_load_dwordx4 a[144:147], v5, s[44:47], s71 offen offset:0 sc1
    v_mfma_f32_16x16x32_bf16 v[228:231], a[88:91], v[192:195], v[228:231]
    v_mfma_f32_16x16x32_bf16 v[232:235], a[92:95], v[192:195], v[232:235]
    v_mfma_f32_16x16x32_bf16 v[236:239], a[84:87], v[196:199], v[236:239]
    v_mfma_f32_16x16x32_bf16 v[240:243], a[88:91], v[196:199], v[240:243]
    buffer_load_dwordx4 a[148:151], v5, s[48:51], s71 offen offset:0 sc1
    v_mfma_f32_16x16x32_bf16 v[244:247], a[92:95], v[196:199], v[244:247]
    s_waitcnt vmcnt(11)
    s_waitcnt lgkmcnt(4)
    v_mfma_f32_16x16x32_bf16 v[108:111], v[168:171], v[168:171], v[108:111]
    ds_read_b64_tr_b16 v[184:185], v13 offset:36864
    v_add_u32 v8, 75264, v26
    v_mfma_f32_16x16x32_bf16 v[200:203], a[96:99], v[168:171], v[200:203]
    ds_read_b64_tr_b16 v[186:187], v13 offset:37376
    ds_read2_b64 v[112:115], v8 offset0:0 offset1:2
    v_mfma_f32_16x16x32_bf16 v[204:207], a[100:103], v[168:171], v[204:207]
    ds_read_b64_tr_b16 v[188:189], v14 offset:36864
    buffer_load_dwordx4 a[152:155], v6, s[52:55], s71 offen offset:0 sc1
    v_mfma_f32_16x16x32_bf16 v[208:211], a[104:107], v[168:171], v[208:211]
    ds_read_b64_tr_b16 v[190:191], v14 offset:37376
    v_mfma_f32_16x16x32_bf16 v[212:215], a[96:99], v[172:175], v[212:215]
    ds_read_b64_tr_b16 v[192:193], v15 offset:36864
    v_add_f32_dpp v44, v44, v44 quad_perm:[1,0,3,2] row_mask:0xf bank_mask:0xf
    v_mfma_f32_16x16x32_bf16 v[216:219], a[100:103], v[172:175], v[216:219]
    ds_read_b64_tr_b16 v[194:195], v15 offset:37376
    v_add_f32_dpp v45, v45, v45 quad_perm:[1,0,3,2] row_mask:0xf bank_mask:0xf
    v_mfma_f32_16x16x32_bf16 v[220:223], a[104:107], v[172:175], v[220:223]
    ds_read_b64_tr_b16 v[196:197], v16 offset:36864
    s_waitcnt lgkmcnt(8)
    v_mfma_f32_16x16x32_bf16 v[224:227], a[96:99], v[176:179], v[224:227]
    ds_read_b64_tr_b16 v[198:199], v16 offset:37376
    buffer_load_dwordx4 a[156:159], v5, s[44:47], s71 offen offset:1024 sc1
    v_mfma_f32_16x16x32_bf16 v[228:231], a[100:103], v[176:179], v[228:231]
    v_add_f32_dpp v46, v46, v46 quad_perm:[1,0,3,2] row_mask:0xf bank_mask:0xf
    v_add_f32_dpp v47, v47, v47 quad_perm:[1,0,3,2] row_mask:0xf bank_mask:0xf
    v_mfma_f32_16x16x32_bf16 v[232:235], a[104:107], v[176:179], v[232:235]
    v_add_f32_dpp v52, v52, v52 quad_perm:[1,0,3,2] row_mask:0xf bank_mask:0xf
    v_add_f32_dpp v53, v53, v53 quad_perm:[1,0,3,2] row_mask:0xf bank_mask:0xf
    v_mfma_f32_16x16x32_bf16 v[236:239], a[96:99], v[180:183], v[236:239]
    v_add_f32_dpp v54, v54, v54 quad_perm:[1,0,3,2] row_mask:0xf bank_mask:0xf
    v_add_f32_dpp v55, v55, v55 quad_perm:[1,0,3,2] row_mask:0xf bank_mask:0xf
    v_mfma_f32_16x16x32_bf16 v[240:243], a[100:103], v[180:183], v[240:243]
    buffer_load_dwordx4 a[160:163], v5, s[48:51], s71 offen offset:1024 sc1
    v_add_f32_dpp v60, v60, v60 quad_perm:[1,0,3,2] row_mask:0xf bank_mask:0xf
    v_mfma_f32_16x16x32_bf16 v[244:247], a[104:107], v[180:183], v[244:247]
    v_add_f32_dpp v61, v61, v61 quad_perm:[1,0,3,2] row_mask:0xf bank_mask:0xf
    s_waitcnt vmcnt(11)
    s_waitcnt lgkmcnt(4)
    v_mfma_f32_16x16x32_bf16 v[108:111], v[184:187], v[184:187], v[108:111]
    ds_read_b64_tr_b16 v[168:169], v13 offset:40960
    v_add_f32_dpp v62, v62, v62 quad_perm:[1,0,3,2] row_mask:0xf bank_mask:0xf
    v_mfma_f32_16x16x32_bf16 v[200:203], a[108:111], v[184:187], v[200:203]
    ds_read_b64_tr_b16 v[170:171], v13 offset:41472
    v_add_f32_dpp v63, v63, v63 quad_perm:[1,0,3,2] row_mask:0xf bank_mask:0xf
    v_mfma_f32_16x16x32_bf16 v[204:207], a[112:115], v[184:187], v[204:207]
    ds_read_b64_tr_b16 v[172:173], v14 offset:40960
    buffer_load_dwordx4 a[164:167], v6, s[52:55], s71 offen offset:1024 sc1
    v_mfma_f32_16x16x32_bf16 v[208:211], a[116:119], v[184:187], v[208:211]
    ds_read_b64_tr_b16 v[174:175], v14 offset:41472
    v_add_f32_dpp v44, v44, v44 quad_perm:[2,3,0,1] row_mask:0xf bank_mask:0xf
    v_mfma_f32_16x16x32_bf16 v[212:215], a[108:111], v[188:191], v[212:215]
    ds_read_b64_tr_b16 v[176:177], v15 offset:40960
    v_add_f32_dpp v45, v45, v45 quad_perm:[2,3,0,1] row_mask:0xf bank_mask:0xf
    v_mfma_f32_16x16x32_bf16 v[216:219], a[112:115], v[188:191], v[216:219]
    ds_read_b64_tr_b16 v[178:179], v15 offset:41472
    v_add_f32_dpp v46, v46, v46 quad_perm:[2,3,0,1] row_mask:0xf bank_mask:0xf
    v_mfma_f32_16x16x32_bf16 v[220:223], a[116:119], v[188:191], v[220:223]
    ds_read_b64_tr_b16 v[180:181], v16 offset:40960
    s_waitcnt lgkmcnt(7)
    v_mfma_f32_16x16x32_bf16 v[224:227], a[108:111], v[192:195], v[224:227]
    ds_read_b64_tr_b16 v[182:183], v16 offset:41472
    buffer_load_dwordx4 a[168:171], v5, s[44:47], s71 offen offset:2048 sc1
    v_mfma_f32_16x16x32_bf16 v[228:231], a[112:115], v[192:195], v[228:231]
    ds_read_b64_tr_b16 v[120:121], v13 offset:61440
    v_add_f32_dpp v47, v47, v47 quad_perm:[2,3,0,1] row_mask:0xf bank_mask:0xf
    v_mfma_f32_16x16x32_bf16 v[232:235], a[116:119], v[192:195], v[232:235]
    ds_read_b64_tr_b16 v[122:123], v13 offset:61952
    v_add_f32_dpp v52, v52, v52 quad_perm:[2,3,0,1] row_mask:0xf bank_mask:0xf
    v_mfma_f32_16x16x32_bf16 v[236:239], a[108:111], v[196:199], v[236:239]
    ds_read_b64_tr_b16 v[124:125], v14 offset:61440
    v_add_f32_dpp v53, v53, v53 quad_perm:[2,3,0,1] row_mask:0xf bank_mask:0xf
    v_mfma_f32_16x16x32_bf16 v[240:243], a[112:115], v[196:199], v[240:243]
    ds_read_b64_tr_b16 v[126:127], v14 offset:61952
    buffer_load_dwordx4 a[172:175], v5, s[48:51], s71 offen offset:2048 sc1
    v_mfma_f32_16x16x32_bf16 v[244:247], a[116:119], v[196:199], v[244:247]
    v_add_f32_dpp v54, v54, v54 quad_perm:[2,3,0,1] row_mask:0xf bank_mask:0xf
    s_waitcnt vmcnt(11)
    s_waitcnt lgkmcnt(8)
    v_mfma_f32_16x16x32_bf16 v[108:111], v[168:171], v[168:171], v[108:111]
    ds_read_b64_tr_b16 v[184:185], v13 offset:45056
    v_add_f32_dpp v55, v55, v55 quad_perm:[2,3,0,1] row_mask:0xf bank_mask:0xf
    v_mfma_f32_16x16x32_bf16 v[200:203], a[120:123], v[168:171], v[200:203]
    ds_read_b64_tr_b16 v[186:187], v13 offset:45568
    v_add_f32_dpp v60, v60, v60 quad_perm:[2,3,0,1] row_mask:0xf bank_mask:0xf
    v_mfma_f32_16x16x32_bf16 v[204:207], a[124:127], v[168:171], v[204:207]
    ds_read_b64_tr_b16 v[188:189], v14 offset:45056
    buffer_load_dwordx4 a[176:179], v6, s[52:55], s71 offen offset:2048 sc1
    v_mfma_f32_16x16x32_bf16 v[208:211], a[128:131], v[168:171], v[208:211]
    ds_read_b64_tr_b16 v[190:191], v14 offset:45568
    v_add_f32_dpp v61, v61, v61 quad_perm:[2,3,0,1] row_mask:0xf bank_mask:0xf
    v_mfma_f32_16x16x32_bf16 v[212:215], a[120:123], v[172:175], v[212:215]
    ds_read_b64_tr_b16 v[192:193], v15 offset:45056
    v_add_f32_dpp v62, v62, v62 quad_perm:[2,3,0,1] row_mask:0xf bank_mask:0xf
    v_mfma_f32_16x16x32_bf16 v[216:219], a[124:127], v[172:175], v[216:219]
    ds_read_b64_tr_b16 v[194:195], v15 offset:45568
    v_add_f32_dpp v63, v63, v63 quad_perm:[2,3,0,1] row_mask:0xf bank_mask:0xf
    v_mfma_f32_16x16x32_bf16 v[220:223], a[128:131], v[172:175], v[220:223]
    ds_read_b64_tr_b16 v[196:197], v16 offset:45056
    s_waitcnt lgkmcnt(11)
    v_mfma_f32_16x16x32_bf16 v[224:227], a[120:123], v[176:179], v[224:227]
    ds_read_b64_tr_b16 v[198:199], v16 offset:45568
    buffer_load_dwordx4 a[180:183], v5, s[44:47], s71 offen offset:3072 sc1
    v_mfma_f32_16x16x32_bf16 v[228:231], a[124:127], v[176:179], v[228:231]
    ds_read_b64_tr_b16 v[84:85], v13 offset:57344
    v_add_f32_dpp v44, v44, v44 row_half_mirror row_mask:0xf bank_mask:0xf
    v_mfma_f32_16x16x32_bf16 v[232:235], a[128:131], v[176:179], v[232:235]
    ds_read_b64_tr_b16 v[86:87], v13 offset:57856
    v_add_f32_dpp v45, v45, v45 row_half_mirror row_mask:0xf bank_mask:0xf
    v_mfma_f32_16x16x32_bf16 v[236:239], a[120:123], v[180:183], v[236:239]
    ds_read_b64_tr_b16 v[88:89], v14 offset:57344
    v_add_f32_dpp v46, v46, v46 row_half_mirror row_mask:0xf bank_mask:0xf
    v_mfma_f32_16x16x32_bf16 v[240:243], a[124:127], v[180:183], v[240:243]
    ds_read_b64_tr_b16 v[90:91], v14 offset:57856
    buffer_load_dwordx4 a[184:187], v5, s[48:51], s71 offen offset:3072 sc1
    v_mfma_f32_16x16x32_bf16 v[244:247], a[128:131], v[180:183], v[244:247]
    v_add_f32_dpp v47, v47, v47 row_half_mirror row_mask:0xf bank_mask:0xf
    s_waitcnt vmcnt(11)
    s_waitcnt lgkmcnt(8)
    v_mfma_f32_16x16x32_bf16 v[108:111], v[184:187], v[184:187], v[108:111]
    ds_read_b64_tr_b16 v[168:169], v13 offset:49152
    s_mov_b32 s3, 32768
    v_mfma_f32_16x16x32_bf16 v[200:203], a[132:135], v[184:187], v[200:203]
    ds_read_b64_tr_b16 v[170:171], v13 offset:49664
    buffer_load_dword v43, v3, s[40:43], s3 offen sc1
    v_mfma_f32_16x16x32_bf16 v[204:207], a[136:139], v[184:187], v[204:207]
    ds_read_b64_tr_b16 v[172:173], v14 offset:49152
    v_add_f32_dpp v52, v52, v52 row_half_mirror row_mask:0xf bank_mask:0xf
    v_mfma_f32_16x16x32_bf16 v[208:211], a[140:143], v[184:187], v[208:211]
    ds_read_b64_tr_b16 v[174:175], v14 offset:49664
    buffer_load_dwordx4 a[188:191], v6, s[52:55], s71 offen offset:3072 sc1
    v_mfma_f32_16x16x32_bf16 v[212:215], a[132:135], v[188:191], v[212:215]
    ds_read_b64_tr_b16 v[176:177], v15 offset:49152
    v_add_f32_dpp v53, v53, v53 row_half_mirror row_mask:0xf bank_mask:0xf
    v_mfma_f32_16x16x32_bf16 v[216:219], a[136:139], v[188:191], v[216:219]
    ds_read_b64_tr_b16 v[178:179], v15 offset:49664
    v_add_f32_dpp v54, v54, v54 row_half_mirror row_mask:0xf bank_mask:0xf
    v_mfma_f32_16x16x32_bf16 v[220:223], a[140:143], v[188:191], v[220:223]
    ds_read_b64_tr_b16 v[180:181], v16 offset:49152
    s_waitcnt lgkmcnt(11)
    v_mfma_f32_16x16x32_bf16 v[224:227], a[132:135], v[192:195], v[224:227]
    ds_read_b64_tr_b16 v[182:183], v16 offset:49664
    buffer_load_dwordx4 a[192:195], v23, s[72:75], s36 offen sc1
    v_mfma_f32_16x16x32_bf16 v[228:231], a[136:139], v[192:195], v[228:231]
    ds_read_b64_tr_b16 v[92:93], v15 offset:57344
    v_add_f32_dpp v55, v55, v55 row_half_mirror row_mask:0xf bank_mask:0xf
    v_mfma_f32_16x16x32_bf16 v[232:235], a[140:143], v[192:195], v[232:235]
    ds_read_b64_tr_b16 v[94:95], v15 offset:57856
    v_add_f32_dpp v60, v60, v60 row_half_mirror row_mask:0xf bank_mask:0xf
    v_mfma_f32_16x16x32_bf16 v[236:239], a[132:135], v[196:199], v[236:239]
    ds_read_b64_tr_b16 v[96:97], v16 offset:57344
    v_add_f32_dpp v61, v61, v61 row_half_mirror row_mask:0xf bank_mask:0xf
    v_mfma_f32_16x16x32_bf16 v[240:243], a[136:139], v[196:199], v[240:243]
    ds_read_b64_tr_b16 v[98:99], v16 offset:57856
    buffer_load_dwordx4 a[196:199], v24, s[72:75], s36 offen sc1
    v_mfma_f32_16x16x32_bf16 v[244:247], a[140:143], v[196:199], v[244:247]
    s_add_u32 s36, s36, 16384
    s_waitcnt vmcnt(12)
    s_waitcnt lgkmcnt(8)
    v_mfma_f32_16x16x32_bf16 v[108:111], v[168:171], v[168:171], v[108:111]
    ds_read_b64_tr_b16 v[184:185], v13 offset:53248
    v_add_f32_dpp v62, v62, v62 row_half_mirror row_mask:0xf bank_mask:0xf
    v_mfma_f32_16x16x32_bf16 v[200:203], a[144:147], v[168:171], v[200:203]
    ds_read_b64_tr_b16 v[186:187], v13 offset:53760
    v_add_f32_dpp v63, v63, v63 row_half_mirror row_mask:0xf bank_mask:0xf
    v_mfma_f32_16x16x32_bf16 v[204:207], a[148:151], v[168:171], v[204:207]
    ds_read_b64_tr_b16 v[188:189], v14 offset:53248
    buffer_load_dwordx4 a[200:203], v23, s[72:75], s36 offen sc1
    v_mfma_f32_16x16x32_bf16 v[208:211], a[152:155], v[168:171], v[208:211]
    ds_read_b64_tr_b16 v[190:191], v14 offset:53760
    v_add_f32_dpp v44, v44, v44 row_mirror row_mask:0xf bank_mask:0xf
    v_mfma_f32_16x16x32_bf16 v[212:215], a[144:147], v[172:175], v[212:215]
    ds_read_b64_tr_b16 v[192:193], v15 offset:53248
    v_add_f32_dpp v45, v45, v45 row_mirror row_mask:0xf bank_mask:0xf
    v_mfma_f32_16x16x32_bf16 v[216:219], a[148:151], v[172:175], v[216:219]
    ds_read_b64_tr_b16 v[194:195], v15 offset:53760
    v_add_f32_dpp v46, v46, v46 row_mirror row_mask:0xf bank_mask:0xf
    v_mfma_f32_16x16x32_bf16 v[220:223], a[152:155], v[172:175], v[220:223]
    ds_read_b64_tr_b16 v[196:197], v16 offset:53248
    s_waitcnt lgkmcnt(11)
    v_mfma_f32_16x16x32_bf16 v[224:227], a[144:147], v[176:179], v[224:227]
    ds_read_b64_tr_b16 v[198:199], v16 offset:53760
    buffer_load_dwordx4 a[204:207], v24, s[72:75], s36 offen sc1
    v_mfma_f32_16x16x32_bf16 v[228:231], a[148:151], v[176:179], v[228:231]
    ds_read_b64_tr_b16 v[128:129], v15 offset:61440
    s_add_u32 s36, s36, 16384
    v_mfma_f32_16x16x32_bf16 v[232:235], a[152:155], v[176:179], v[232:235]
    ds_read_b64_tr_b16 v[130:131], v15 offset:61952
    v_add_f32_dpp v47, v47, v47 row_mirror row_mask:0xf bank_mask:0xf
    v_mfma_f32_16x16x32_bf16 v[236:239], a[144:147], v[180:183], v[236:239]
    ds_read_b64_tr_b16 v[132:133], v16 offset:61440
    v_add_f32_dpp v52, v52, v52 row_mirror row_mask:0xf bank_mask:0xf
    v_mfma_f32_16x16x32_bf16 v[240:243], a[148:151], v[180:183], v[240:243]
    ds_read_b64_tr_b16 v[134:135], v16 offset:61952
    buffer_load_dwordx4 a[208:211], v23, s[72:75], s36 offen sc1
    v_mfma_f32_16x16x32_bf16 v[244:247], a[152:155], v[180:183], v[244:247]
    v_add_f32_dpp v53, v53, v53 row_mirror row_mask:0xf bank_mask:0xf
    s_waitcnt vmcnt(12)
    s_waitcnt vmcnt(9)
    s_waitcnt vmcnt(5)
    s_waitcnt lgkmcnt(8)
    v_mfma_f32_16x16x32_bf16 v[108:111], v[184:187], v[184:187], v[108:111]
    v_add_f32_dpp v54, v54, v54 row_mirror row_mask:0xf bank_mask:0xf
    v_add_f32_dpp v55, v55, v55 row_mirror row_mask:0xf bank_mask:0xf
    v_mfma_f32_16x16x32_bf16 v[208:211], a[164:167], v[184:187], v[208:211]
    v_add_f32_dpp v60, v60, v60 row_mirror row_mask:0xf bank_mask:0xf
    v_add_f32_dpp v61, v61, v61 row_mirror row_mask:0xf bank_mask:0xf
    v_mfma_f32_16x16x32_bf16 v[220:223], a[164:167], v[188:191], v[220:223]
    v_add_f32_dpp v62, v62, v62 row_mirror row_mask:0xf bank_mask:0xf
    v_add_f32_dpp v63, v63, v63 row_mirror row_mask:0xf bank_mask:0xf
    s_waitcnt lgkmcnt(4)
    v_mfma_f32_16x16x32_bf16 v[232:235], a[164:167], v[192:195], v[232:235]
    v_add_u32 v8, 145920, v35
    ds_write_b128 v8, v[44:47] offset:0
    v_mfma_f32_16x16x32_bf16 v[244:247], a[164:167], v[196:199], v[244:247]
    ds_write_b128 v8, v[52:55] offset:4096
    ds_write_b128 v8, v[60:63] offset:8192
    v_mfma_f32_16x16x32_bf16 v[108:111], v[84:87], v[84:87], v[108:111]
    buffer_load_dwordx4 a[212:215], v24, s[72:75], s36 offen sc1
    s_add_u32 s36, s36, 16384
    v_mfma_f32_16x16x32_bf16 v[208:211], a[176:179], v[84:87], v[208:211]
    v_mfma_f32_16x16x32_bf16 v[220:223], a[176:179], v[88:91], v[220:223]
    v_mfma_f32_16x16x32_bf16 v[232:235], a[176:179], v[92:95], v[232:235]
    v_mfma_f32_16x16x32_bf16 v[244:247], a[176:179], v[96:99], v[244:247]
    buffer_load_dwordx4 a[216:219], v23, s[72:75], s36 offen sc1
    s_waitcnt lgkmcnt(3)
    v_mfma_f32_16x16x32_bf16 v[108:111], v[120:123], v[120:123], v[108:111]
    v_mfma_f32_16x16x32_bf16 v[208:211], a[188:191], v[120:123], v[208:211]
    v_mfma_f32_16x16x32_bf16 v[220:223], a[188:191], v[124:127], v[220:223]
    v_mfma_f32_16x16x32_bf16 v[232:235], a[188:191], v[128:131], v[232:235]
    buffer_load_dwordx4 a[220:223], v24, s[72:75], s36 offen sc1
    s_add_u32 s36, s36, 16384
    v_mfma_f32_16x16x32_bf16 v[244:247], a[188:191], v[132:135], v[244:247]
    v_mfma_f32_16x16x32_bf16 v[200:203], a[156:159], v[184:187], v[200:203]
    v_mfma_f32_16x16x32_bf16 v[204:207], a[160:163], v[184:187], v[204:207]
    v_cndmask_b32 v102, v108, v109, s[12:13]
    v_cndmask_b32 v102, v102, v110, s[14:15]
    v_mfma_f32_16x16x32_bf16 v[212:215], a[156:159], v[188:191], v[212:215]
    v_cndmask_b32 v102, v102, v111, s[16:17]
    buffer_load_dwordx4 a[224:227], v23, s[72:75], s36 offen sc1
    v_mfma_f32_16x16x32_bf16 v[216:219], a[160:163], v[188:191], v[216:219]
    s_mov_b64 exec, s[18:19]
    ds_write_b32 v17, v102 offset:0
    s_mov_b64 exec, s[100:101]
    ds_write_b32 v18, v208 offset:192
    ds_write_b32 v18, v220 offset:0
    ds_write_b32 v18, v232 offset:64
    ds_write_b32 v18, v244 offset:128
    s_mov_b64 exec, -1
    v_mfma_f32_16x16x32_bf16 v[224:227], a[156:159], v[192:195], v[224:227]
    v_mfma_f32_16x16x32_bf16 v[228:231], a[160:163], v[192:195], v[228:231]
    v_mfma_f32_16x16x32_bf16 v[236:239], a[156:159], v[196:199], v[236:239]
    buffer_load_dwordx4 a[228:231], v24, s[72:75], s36 offen sc1
    v_mfma_f32_16x16x32_bf16 v[240:243], a[160:163], v[196:199], v[240:243]
    s_add_u32 s36, s36, 16384
    v_mfma_f32_16x16x32_bf16 v[200:203], a[168:171], v[84:87], v[200:203]
    v_mfma_f32_16x16x32_bf16 v[204:207], a[172:175], v[84:87], v[204:207]
    s_mov_b32 s3, 32768
    s_cmp_lg_u32 s20, 0
    s_cbranch_scc1 PC_D3
    s_mov_b32 s33, 0x40000
PC_L3:
    v_cmp_ne_u32 vcc, 16, v43
    s_cmp_eq_u64 vcc, 0
    s_cbranch_scc1 PC_D3
    s_sub_u32 s33, s33, 1
    s_cbranch_scc1 PC_D3
    s_sleep 1
    buffer_load_dword v43, v3, s[40:43], s3 offen sc1
    s_waitcnt vmcnt(0)
    s_branch PC_L3
PC_D3:
    s_waitcnt lgkmcnt(0)
    s_barrier
    ds_read2_b32 v[100:101], v19 offset0:0 offset1:64
    v_mfma_f32_16x16x32_bf16 v[212:215], a[168:171], v[88:91], v[212:215]
    buffer_load_dwordx4 v11, s[56:59], s34 offen offset:0 sc1 lds
    v_mfma_f32_16x16x32_bf16 v[216:219], a[172:175], v[88:91], v[216:219]
    v_mfma_f32_16x16x32_bf16 v[224:227], a[168:171], v[92:95], v[224:227]
    v_mfma_f32_16x16x32_bf16 v[228:231], a[172:175], v[92:95], v[228:231]
    v_mfma_f32_16x16x32_bf16 v[236:239], a[168:171], v[96:99], v[236:239]
    s_waitcnt lgkmcnt(0)
    v_mfma_f32_16x16x32_bf16 v[240:243], a[172:175], v[96:99], v[240:243]
    v_mul_f32 v104, 0xbb000000, v100
    v_mul_f32 v101, s76, v101
    v_mfma_f32_16x16x32_bf16 v[200:203], a[180:183], v[120:123], v[200:203]
    v_fma_f32 v101, -v104, v104, v101
    v_max_f32 v101, 0, v101
    v_mfma_f32_16x16x32_bf16 v[204:207], a[184:187], v[120:123], v[204:207]
    v_add_f32 v107, 0x3727c5ac, v101
    buffer_load_dwordx4 v12, s[56:59], s34 offen offset:1024 sc1 lds
    v_mfma_f32_16x16x32_bf16 v[212:215], a[180:183], v[124:127], v[212:215]
    v_rsq_f32 v100, v107
    s_nop 0
    v_mul_f32 v105, 0xc0135761, v100
    v_mfma_f32_16x16x32_bf16 v[216:219], a[184:187], v[124:127], v[216:219]
    v_mul_f32 v101, v100, v100
    v_mul_f32 v100, 0xbdd2d3e8, v100
    v_mfma_f32_16x16x32_bf16 v[224:227], a[180:183], v[128:131], v[224:227]
    v_mul_f32 v106, v101, v100
    v_mfma_f32_16x16x32_bf16 v[228:231], a[184:187], v[128:131], v[228:231]
    ds_write_b128 v20, v[104:107]
    ds_read_b128 v[68:71], v21 offset:0
    ds_read_b128 v[72:75], v21 offset:256
    ds_read_b128 v[76:79], v21 offset:512
    ds_read_b128 v[80:83], v21 offset:768
    buffer_load_dwordx4 v11, s[56:59], s34 offen offset:2048 sc1 lds
    v_mfma_f32_16x16x32_bf16 v[236:239], a[180:183], v[132:135], v[236:239]
    v_mfma_f32_16x16x32_bf16 v[240:243], a[184:187], v[132:135], v[240:243]
    v_subrev_u32 v13, 41984, v13
    v_subrev_u32 v14, 41984, v14
    v_subrev_u32 v15, 41984, v15
    v_subrev_u32 v16, 41984, v16
    s_waitcnt lgkmcnt(0)
    v_pk_fma_f32 v[208:209], v[60:61], v[68:69], v[208:209] op_sel:[0,0,0] op_sel_hi:[1,0,1]
    v_pk_fma_f32 v[220:221], v[60:61], v[72:73], v[220:221] op_sel:[0,0,0] op_sel_hi:[1,0,1]
    buffer_load_dwordx4 v12, s[56:59], s34 offen offset:3072 sc1 lds
    s_add_u32 m0, s37, 49664
    s_add_u32 s34, s34, 16384
    buffer_load_dwordx4 v11, s[56:59], s34 offen offset:0 sc1 lds
    v_pk_fma_f32 v[210:211], v[62:63], v[68:69], v[210:211] op_sel:[0,0,0] op_sel_hi:[1,0,1]
    v_pk_fma_f32 v[222:223], v[62:63], v[72:73], v[222:223] op_sel:[0,0,0] op_sel_hi:[1,0,1]
    v_pk_mul_f32 v[96:97], v[208:209], v[208:209]
    v_pk_mul_f32 v[98:99], v[220:221], v[220:221]
    v_pk_mul_f32 v[210:211], v[210:211], v[208:209]
    v_pk_mul_f32 v[222:223], v[222:223], v[220:221]
    v_pk_fma_f32 v[96:97], v[96:97], v[70:71], v[68:69] op_sel:[0,0,1] op_sel_hi:[1,0,1]
    v_pk_fma_f32 v[98:99], v[98:99], v[74:75], v[72:73] op_sel:[0,0,1] op_sel_hi:[1,0,1]
    v_pk_mul_f32 v[96:97], v[96:97], v[208:209]
    v_pk_mul_f32 v[98:99], v[98:99], v[220:221]
    v_exp_f32 v96, v96
    v_exp_f32 v98, v98
    buffer_load_dwordx4 v12, s[56:59], s34 offen offset:1024 sc1 lds
    v_exp_f32 v97, v97
    v_exp_f32 v99, v99
    v_pk_fma_f32 v[96:97], v[96:97], v[70:71], v[70:71] op_sel:[0,1,1] op_sel_hi:[1,1,1]
    v_pk_fma_f32 v[98:99], v[98:99], v[74:75], v[74:75] op_sel:[0,1,1] op_sel_hi:[1,1,1]
    v_rcp_f32 v96, v96
    v_rcp_f32 v98, v98
    v_rcp_f32 v97, v97
    v_rcp_f32 v99, v99
    v_pk_mul_f32 v[210:211], v[210:211], v[96:97]
    v_pk_mul_f32 v[222:223], v[222:223], v[98:99]
    v_cvt_pk_bf16_f32 v92, v210, v211
    v_cvt_pk_bf16_f32 v93, v222, v223
    buffer_load_dwordx4 v11, s[56:59], s34 offen offset:2048 sc1 lds
    v_pk_fma_f32 v[232:233], v[60:61], v[76:77], v[232:233] op_sel:[0,0,0] op_sel_hi:[1,0,1]
    v_pk_fma_f32 v[244:245], v[60:61], v[80:81], v[244:245] op_sel:[0,0,0] op_sel_hi:[1,0,1]
    buffer_load_dwordx4 v12, s[56:59], s34 offen offset:3072 sc1 lds
    s_add_u32 m0, s37, 108032
    s_add_u32 s34, s34, 16384
    buffer_load_dwordx4 v11, s[56:59], s34 offen offset:0 sc1 lds
    v_pk_fma_f32 v[234:235], v[62:63], v[76:77], v[234:235] op_sel:[0,0,0] op_sel_hi:[1,0,1]
    v_pk_fma_f32 v[246:247], v[62:63], v[80:81], v[246:247] op_sel:[0,0,0] op_sel_hi:[1,0,1]
    v_pk_mul_f32 v[96:97], v[232:233], v[232:233]
    v_pk_mul_f32 v[98:99], v[244:245], v[244:245]
    v_pk_mul_f32 v[234:235], v[234:235], v[232:233]
    v_pk_mul_f32 v[246:247], v[246:247], v[244:245]
    v_pk_fma_f32 v[96:97], v[96:97], v[78:79], v[76:77] op_sel:[0,0,1] op_sel_hi:[1,0,1]
    v_pk_fma_f32 v[98:99], v[98:99], v[82:83], v[80:81] op_sel:[0,0,1] op_sel_hi:[1,0,1]
    v_pk_mul_f32 v[96:97], v[96:97], v[232:233]
    v_pk_mul_f32 v[98:99], v[98:99], v[244:245]
    v_exp_f32 v96, v96
    v_exp_f32 v98, v98
    buffer_load_dwordx4 v12, s[56:59], s34 offen offset:1024 sc1 lds
    v_exp_f32 v97, v97
    v_exp_f32 v99, v99
    v_pk_fma_f32 v[96:97], v[96:97], v[78:79], v[78:79] op_sel:[0,1,1] op_sel_hi:[1,1,1]
    v_pk_fma_f32 v[98:99], v[98:99], v[82:83], v[82:83] op_sel:[0,1,1] op_sel_hi:[1,1,1]
    v_rcp_f32 v96, v96
    v_rcp_f32 v98, v98
    v_rcp_f32 v97, v97
    v_rcp_f32 v99, v99
    v_pk_mul_f32 v[234:235], v[234:235], v[96:97]
    v_pk_mul_f32 v[246:247], v[246:247], v[98:99]
    v_cvt_pk_bf16_f32 v94, v234, v235
    v_cvt_pk_bf16_f32 v95, v246, v247
    buffer_load_dwordx4 v11, s[56:59], s34 offen offset:2048 sc1 lds
    v_permlane32_swap_b32 v92, v94
    v_permlane32_swap_b32 v93, v95
    s_nop 1
    v_permlane16_swap_b32 v92, v93
    v_permlane16_swap_b32 v94, v95
    buffer_store_dwordx4 v[92:95], v22, s[64:67], 0 offen sc1
    v_pk_fma_f32 v[200:201], v[44:45], v[68:69], v[200:201] op_sel:[0,0,0] op_sel_hi:[1,0,1]
    v_pk_fma_f32 v[212:213], v[44:45], v[72:73], v[212:213] op_sel:[0,0,0] op_sel_hi:[1,0,1]
    buffer_load_dwordx4 v12, s[56:59], s34 offen offset:3072 sc1 lds
    s_add_u32 m0, s37, 124416
    s_add_u32 s34, s34, 16384
    buffer_load_dwordx4 v11, s[56:59], s34 offen offset:0 sc1 lds
    v_pk_fma_f32 v[202:203], v[46:47], v[68:69], v[202:203] op_sel:[0,0,0] op_sel_hi:[1,0,1]
    v_pk_fma_f32 v[214:215], v[46:47], v[72:73], v[214:215] op_sel:[0,0,0] op_sel_hi:[1,0,1]
    v_pk_mul_f32 v[96:97], v[200:201], v[200:201]
    v_pk_mul_f32 v[98:99], v[212:213], v[212:213]
    v_pk_mul_f32 v[202:203], v[202:203], v[200:201]
    v_pk_mul_f32 v[214:215], v[214:215], v[212:213]
    v_pk_fma_f32 v[96:97], v[96:97], v[70:71], v[68:69] op_sel:[0,0,1] op_sel_hi:[1,0,1]
    v_pk_fma_f32 v[98:99], v[98:99], v[74:75], v[72:73] op_sel:[0,0,1] op_sel_hi:[1,0,1]
    v_pk_mul_f32 v[96:97], v[96:97], v[200:201]
    v_pk_mul_f32 v[98:99], v[98:99], v[212:213]
    v_exp_f32 v96, v96
    v_exp_f32 v98, v98
    v_exp_f32 v97, v97
    v_exp_f32 v99, v99
    v_pk_fma_f32 v[96:97], v[96:97], v[70:71], v[70:71] op_sel:[0,1,1] op_sel_hi:[1,1,1]
    v_pk_fma_f32 v[98:99], v[98:99], v[74:75], v[74:75] op_sel:[0,1,1] op_sel_hi:[1,1,1]
    v_rcp_f32 v96, v96
    v_rcp_f32 v98, v98
    v_rcp_f32 v97, v97
    v_rcp_f32 v99, v99
    v_pk_mul_f32 v[202:203], v[202:203], v[96:97]
    v_pk_mul_f32 v[214:215], v[214:215], v[98:99]
    v_cvt_pk_bf16_f32 v84, v202, v203
    v_cvt_pk_bf16_f32 v85, v214, v215
    v_pk_fma_f32 v[224:225], v[44:45], v[76:77], v[224:225] op_sel:[0,0,0] op_sel_hi:[1,0,1]
    v_pk_fma_f32 v[236:237], v[44:45], v[80:81], v[236:237] op_sel:[0,0,0] op_sel_hi:[1,0,1]
    v_pk_fma_f32 v[226:227], v[46:47], v[76:77], v[226:227] op_sel:[0,0,0] op_sel_hi:[1,0,1]
    v_pk_fma_f32 v[238:239], v[46:47], v[80:81], v[238:239] op_sel:[0,0,0] op_sel_hi:[1,0,1]
    v_pk_mul_f32 v[96:97], v[224:225], v[224:225]
    v_pk_mul_f32 v[98:99], v[236:237], v[236:237]
    v_pk_mul_f32 v[226:227], v[226:227], v[224:225]
    v_pk_mul_f32 v[238:239], v[238:239], v[236:237]
    v_pk_fma_f32 v[96:97], v[96:97], v[78:79], v[76:77] op_sel:[0,0,1] op_sel_hi:[1,0,1]
    v_pk_fma_f32 v[98:99], v[98:99], v[82:83], v[80:81] op_sel:[0,0,1] op_sel_hi:[1,0,1]
    v_pk_mul_f32 v[96:97], v[96:97], v[224:225]
    v_pk_mul_f32 v[98:99], v[98:99], v[236:237]
    v_exp_f32 v96, v96
    v_exp_f32 v98, v98
    v_exp_f32 v97, v97
    v_exp_f32 v99, v99
    v_pk_fma_f32 v[96:97], v[96:97], v[78:79], v[78:79] op_sel:[0,1,1] op_sel_hi:[1,1,1]
    v_pk_fma_f32 v[98:99], v[98:99], v[82:83], v[82:83] op_sel:[0,1,1] op_sel_hi:[1,1,1]
    v_rcp_f32 v96, v96
    v_rcp_f32 v98, v98
    v_rcp_f32 v97, v97
    v_rcp_f32 v99, v99
    v_pk_mul_f32 v[226:227], v[226:227], v[96:97]
    v_pk_mul_f32 v[238:239], v[238:239], v[98:99]
    v_cvt_pk_bf16_f32 v86, v226, v227
    v_cvt_pk_bf16_f32 v87, v238, v239
    s_nop 0
    v_permlane32_swap_b32 v84, v86
    v_permlane32_swap_b32 v85, v87
    s_nop 1
    v_permlane16_swap_b32 v84, v85
    v_permlane16_swap_b32 v86, v87
    buffer_store_dwordx4 v[84:87], v22, s[92:95], 0 offen sc1
    v_pk_fma_f32 v[204:205], v[52:53], v[68:69], v[204:205] op_sel:[0,0,0] op_sel_hi:[1,0,1]
    v_pk_fma_f32 v[216:217], v[52:53], v[72:73], v[216:217] op_sel:[0,0,0] op_sel_hi:[1,0,1]
    v_pk_fma_f32 v[206:207], v[54:55], v[68:69], v[206:207] op_sel:[0,0,0] op_sel_hi:[1,0,1]
    v_pk_fma_f32 v[218:219], v[54:55], v[72:73], v[218:219] op_sel:[0,0,0] op_sel_hi:[1,0,1]
    v_pk_mul_f32 v[96:97], v[204:205], v[204:205]
    v_pk_mul_f32 v[98:99], v[216:217], v[216:217]
    v_pk_mul_f32 v[206:207], v[206:207], v[204:205]
    v_pk_mul_f32 v[218:219], v[218:219], v[216:217]
    v_pk_fma_f32 v[96:97], v[96:97], v[70:71], v[68:69] op_sel:[0,0,1] op_sel_hi:[1,0,1]
    v_pk_fma_f32 v[98:99], v[98:99], v[74:75], v[72:73] op_sel:[0,0,1] op_sel_hi:[1,0,1]
    v_pk_mul_f32 v[96:97], v[96:97], v[204:205]
    v_pk_mul_f32 v[98:99], v[98:99], v[216:217]
    v_exp_f32 v96, v96
    v_exp_f32 v98, v98
    v_exp_f32 v97, v97
    v_exp_f32 v99, v99
    v_pk_fma_f32 v[96:97], v[96:97], v[70:71], v[70:71] op_sel:[0,1,1] op_sel_hi:[1,1,1]
    v_pk_fma_f32 v[98:99], v[98:99], v[74:75], v[74:75] op_sel:[0,1,1] op_sel_hi:[1,1,1]
    v_rcp_f32 v96, v96
    v_rcp_f32 v98, v98
    v_rcp_f32 v97, v97
    v_rcp_f32 v99, v99
    v_pk_mul_f32 v[206:207], v[206:207], v[96:97]
    v_pk_mul_f32 v[218:219], v[218:219], v[98:99]
    v_cvt_pk_bf16_f32 v88, v206, v207
    v_cvt_pk_bf16_f32 v89, v218, v219
    v_pk_fma_f32 v[228:229], v[52:53], v[76:77], v[228:229] op_sel:[0,0,0] op_sel_hi:[1,0,1]
    v_pk_fma_f32 v[240:241], v[52:53], v[80:81], v[240:241] op_sel:[0,0,0] op_sel_hi:[1,0,1]
    v_pk_fma_f32 v[230:231], v[54:55], v[76:77], v[230:231] op_sel:[0,0,0] op_sel_hi:[1,0,1]
    v_pk_fma_f32 v[242:243], v[54:55], v[80:81], v[242:243] op_sel:[0,0,0] op_sel_hi:[1,0,1]
    v_pk_mul_f32 v[96:97], v[228:229], v[228:229]
    v_pk_mul_f32 v[98:99], v[240:241], v[240:241]
    v_pk_mul_f32 v[230:231], v[230:231], v[228:229]
    v_pk_mul_f32 v[242:243], v[242:243], v[240:241]
    v_pk_fma_f32 v[96:97], v[96:97], v[78:79], v[76:77] op_sel:[0,0,1] op_sel_hi:[1,0,1]
    v_pk_fma_f32 v[98:99], v[98:99], v[82:83], v[80:81] op_sel:[0,0,1] op_sel_hi:[1,0,1]
    v_pk_mul_f32 v[96:97], v[96:97], v[228:229]
    v_pk_mul_f32 v[98:99], v[98:99], v[240:241]
    v_exp_f32 v96, v96
    v_exp_f32 v98, v98
    v_exp_f32 v97, v97
    v_exp_f32 v99, v99
    v_pk_fma_f32 v[96:97], v[96:97], v[78:79], v[78:79] op_sel:[0,1,1] op_sel_hi:[1,1,1]
    v_pk_fma_f32 v[98:99], v[98:99], v[82:83], v[82:83] op_sel:[0,1,1] op_sel_hi:[1,1,1]
    v_rcp_f32 v96, v96
    v_rcp_f32 v98, v98
    v_rcp_f32 v97, v97
    v_rcp_f32 v99, v99
    v_pk_mul_f32 v[230:231], v[230:231], v[96:97]
    v_pk_mul_f32 v[242:243], v[242:243], v[98:99]
    v_cvt_pk_bf16_f32 v90, v230, v231
    v_cvt_pk_bf16_f32 v91, v242, v243
    s_nop 0
    v_permlane32_swap_b32 v88, v90
    v_permlane32_swap_b32 v89, v91
    s_nop 1
    v_permlane16_swap_b32 v88, v89
    v_permlane16_swap_b32 v90, v91
    buffer_store_dwordx4 v[88:91], v22, s[92:95], s99 offen sc1
    s_waitcnt vmcnt(8)
    s_barrier
    ds_read_b64_tr_b16 v[168:169], v13 offset:0
    ds_read_b64_tr_b16 v[170:171], v13 offset:512
    ds_read_b64_tr_b16 v[172:173], v14 offset:0
    ds_read_b64_tr_b16 v[174:175], v14 offset:512
    ds_read_b64_tr_b16 v[176:177], v15 offset:0
    ds_read_b64_tr_b16 v[178:179], v15 offset:512
    ds_read_b64_tr_b16 v[180:181], v16 offset:0
    ds_read_b64_tr_b16 v[182:183], v16 offset:512
    s_waitcnt lgkmcnt(4)
    v_mfma_f32_16x16x32_bf16 v[108:111], v[168:171], v[168:171], 0
    ds_read_b64_tr_b16 v[184:185], v13 offset:4096
    v_mfma_f32_16x16x32_bf16 v[120:123], a[0:3], v[168:171], 0
    ds_read_b64_tr_b16 v[186:187], v13 offset:4608
    buffer_load_dwordx4 v12, s[56:59], s34 offen offset:1024 sc1 lds
    v_mfma_f32_16x16x32_bf16 v[124:127], a[4:7], v[168:171], 0
    ds_read_b64_tr_b16 v[188:189], v14 offset:4096
    v_mfma_f32_16x16x32_bf16 v[128:131], a[8:11], v[168:171], 0
    ds_read_b64_tr_b16 v[190:191], v14 offset:4608
    v_mfma_f32_16x16x32_bf16 v[132:135], a[0:3], v[172:175], 0
    ds_read_b64_tr_b16 v[192:193], v15 offset:4096
    v_mfma_f32_16x16x32_bf16 v[136:139], a[4:7], v[172:175], 0
    ds_read_b64_tr_b16 v[194:195], v15 offset:4608
    buffer_load_dwordx4 v11, s[56:59], s34 offen offset:2048 sc1 lds
    v_mfma_f32_16x16x32_bf16 v[140:143], a[8:11], v[172:175], 0
    ds_read_b64_tr_b16 v[196:197], v16 offset:4096
    s_waitcnt lgkmcnt(7)
    v_mfma_f32_16x16x32_bf16 v[144:147], a[0:3], v[176:179], 0
    ds_read_b64_tr_b16 v[198:199], v16 offset:4608
    v_mfma_f32_16x16x32_bf16 v[148:151], a[4:7], v[176:179], 0
    v_mfma_f32_16x16x32_bf16 v[152:155], a[8:11], v[176:179], 0
    buffer_load_dwordx4 v12, s[56:59], s34 offen offset:3072 sc1 lds
    v_mfma_f32_16x16x32_bf16 v[156:159], a[0:3], v[180:183], 0
    v_mfma_f32_16x16x32_bf16 v[160:163], a[4:7], v[180:183], 0
    v_mfma_f32_16x16x32_bf16 v[164:167], a[8:11], v[180:183], 0
    s_waitcnt lgkmcnt(4)
    v_mfma_f32_16x16x32_bf16 v[108:111], v[184:187], v[184:187], v[108:111]
    ds_read_b64_tr_b16 v[168:169], v13 offset:8192
    buffer_load_dwordx4 a[232:235], v23, s[72:75], s36 offen sc1
    v_mfma_f32_16x16x32_bf16 v[120:123], a[12:15], v[184:187], v[120:123]
    ds_read_b64_tr_b16 v[170:171], v13 offset:8704
    v_mfma_f32_16x16x32_bf16 v[124:127], a[16:19], v[184:187], v[124:127]
    ds_read_b64_tr_b16 v[172:173], v14 offset:8192
    v_mfma_f32_16x16x32_bf16 v[128:131], a[20:23], v[184:187], v[128:131]
    ds_read_b64_tr_b16 v[174:175], v14 offset:8704
    v_mfma_f32_16x16x32_bf16 v[132:135], a[12:15], v[188:191], v[132:135]
    ds_read_b64_tr_b16 v[176:177], v15 offset:8192
    buffer_load_dwordx4 a[236:239], v24, s[72:75], s36 offen sc1
    v_mfma_f32_16x16x32_bf16 v[136:139], a[16:19], v[188:191], v[136:139]
    ds_read_b64_tr_b16 v[178:179], v15 offset:8704
    s_add_u32 s36, s36, 16384
    v_mfma_f32_16x16x32_bf16 v[140:143], a[20:23], v[188:191], v[140:143]
    ds_read_b64_tr_b16 v[180:181], v16 offset:8192
    s_waitcnt lgkmcnt(7)
    v_mfma_f32_16x16x32_bf16 v[144:147], a[12:15], v[192:195], v[144:147]
    ds_read_b64_tr_b16 v[182:183], v16 offset:8704
    v_mfma_f32_16x16x32_bf16 v[148:151], a[16:19], v[192:195], v[148:151]
    buffer_load_dwordx4 a[240:243], v23, s[72:75], s36 offen sc1
    v_mfma_f32_16x16x32_bf16 v[152:155], a[20:23], v[192:195], v[152:155]
    v_mfma_f32_16x16x32_bf16 v[156:159], a[12:15], v[196:199], v[156:159]
    v_mfma_f32_16x16x32_bf16 v[160:163], a[16:19], v[196:199], v[160:163]
    v_mfma_f32_16x16x32_bf16 v[164:167], a[20:23], v[196:199], v[164:167]
    buffer_load_dwordx4 a[244:247], v24, s[72:75], s36 offen sc1
    s_waitcnt lgkmcnt(4)
    v_mfma_f32_16x16x32_bf16 v[108:111], v[168:171], v[168:171], v[108:111]
    ds_read_b64_tr_b16 v[184:185], v13 offset:12288
    s_add_u32 s36, s36, 16384
    v_mfma_f32_16x16x32_bf16 v[120:123], a[24:27], v[168:171], v[120:123]
    ds_read_b64_tr_b16 v[186:187], v13 offset:12800
    v_mfma_f32_16x16x32_bf16 v[124:127], a[28:31], v[168:171], v[124:127]
    ds_read_b64_tr_b16 v[188:189], v14 offset:12288
    v_mfma_f32_16x16x32_bf16 v[128:131], a[32:35], v[168:171], v[128:131]
    ds_read_b64_tr_b16 v[190:191], v14 offset:12800
    buffer_load_dwordx4 a[248:251], v23, s[72:75], s36 offen sc1
    v_mfma_f32_16x16x32_bf16 v[132:135], a[24:27], v[172:175], v[132:135]
    ds_read_b64_tr_b16 v[192:193], v15 offset:12288
    v_mfma_f32_16x16x32_bf16 v[136:139], a[28:31], v[172:175], v[136:139]
    ds_read_b64_tr_b16 v[194:195], v15 offset:12800
    v_mfma_f32_16x16x32_bf16 v[140:143], a[32:35], v[172:175], v[140:143]
    ds_read_b64_tr_b16 v[196:197], v16 offset:12288
    s_waitcnt lgkmcnt(7)
    v_mfma_f32_16x16x32_bf16 v[144:147], a[24:27], v[176:179], v[144:147]
    ds_read_b64_tr_b16 v[198:199], v16 offset:12800
    buffer_load_dwordx4 a[252:255], v24, s[72:75], s36 offen sc1
    v_mfma_f32_16x16x32_bf16 v[148:151], a[28:31], v[176:179], v[148:151]
    s_add_u32 s36, s36, 16384
    v_mfma_f32_16x16x32_bf16 v[152:155], a[32:35], v[176:179], v[152:155]
    v_mfma_f32_16x16x32_bf16 v[156:159], a[24:27], v[180:183], v[156:159]
    v_mfma_f32_16x16x32_bf16 v[160:163], a[28:31], v[180:183], v[160:163]
    buffer_load_dwordx4 a[0:3], v23, s[72:75], s36 offen sc1
    v_mfma_f32_16x16x32_bf16 v[164:167], a[32:35], v[180:183], v[164:167]
    s_waitcnt lgkmcnt(4)
    v_mfma_f32_16x16x32_bf16 v[108:111], v[184:187], v[184:187], v[108:111]
    ds_read_b64_tr_b16 v[168:169], v13 offset:16384
    v_mfma_f32_16x16x32_bf16 v[120:123], a[36:39], v[184:187], v[120:123]
    ds_read_b64_tr_b16 v[170:171], v13 offset:16896
    v_mfma_f32_16x16x32_bf16 v[124:127], a[40:43], v[184:187], v[124:127]
    ds_read_b64_tr_b16 v[172:173], v14 offset:16384
    buffer_load_dwordx4 a[4:7], v24, s[72:75], s36 offen sc1
    v_mfma_f32_16x16x32_bf16 v[128:131], a[44:47], v[184:187], v[128:131]
    ds_read_b64_tr_b16 v[174:175], v14 offset:16896
    s_add_u32 s36, s36, 16384
    v_mfma_f32_16x16x32_bf16 v[132:135], a[36:39], v[188:191], v[132:135]
    ds_read_b64_tr_b16 v[176:177], v15 offset:16384
    v_mfma_f32_16x16x32_bf16 v[136:139], a[40:43], v[188:191], v[136:139]
    ds_read_b64_tr_b16 v[178:179], v15 offset:16896
    v_mfma_f32_16x16x32_bf16 v[140:143], a[44:47], v[188:191], v[140:143]
    ds_read_b64_tr_b16 v[180:181], v16 offset:16384
    s_waitcnt lgkmcnt(7)
    v_mfma_f32_16x16x32_bf16 v[144:147], a[36:39], v[192:195], v[144:147]
    ds_read_b64_tr_b16 v[182:183], v16 offset:16896
    buffer_load_dwordx4 a[8:11], v23, s[72:75], s36 offen sc1
    v_mfma_f32_16x16x32_bf16 v[148:151], a[40:43], v[192:195], v[148:151]
    v_mfma_f32_16x16x32_bf16 v[152:155], a[44:47], v[192:195], v[152:155]
    v_mfma_f32_16x16x32_bf16 v[156:159], a[36:39], v[196:199], v[156:159]
    v_mfma_f32_16x16x32_bf16 v[160:163], a[40:43], v[196:199], v[160:163]
    buffer_load_dwordx4 a[12:15], v24, s[72:75], s36 offen sc1
    s_add_u32 s36, s36, 16384
    v_mfma_f32_16x16x32_bf16 v[164:167], a[44:47], v[196:199], v[164:167]
    s_waitcnt vmcnt(10)
    s_barrier
    s_waitcnt lgkmcnt(4)
    v_mfma_f32_16x16x32_bf16 v[108:111], v[168:171], v[168:171], v[108:111]
    ds_read_b64_tr_b16 v[184:185], v13 offset:20480
    buffer_atomic_add v4, v33, s[40:43], s78 offen
    v_mfma_f32_16x16x32_bf16 v[120:123], a[48:51], v[168:171], v[120:123]
    ds_read_b64_tr_b16 v[186:187], v13 offset:20992
    v_mfma_f32_16x16x32_bf16 v[124:127], a[52:55], v[168:171], v[124:127]
    ds_read_b64_tr_b16 v[188:189], v14 offset:20480
    buffer_load_dwordx4 a[16:19], v23, s[72:75], s36 offen sc1
    v_mfma_f32_16x16x32_bf16 v[128:131], a[56:59], v[168:171], v[128:131]
    ds_read_b64_tr_b16 v[190:191], v14 offset:20992
    v_mfma_f32_16x16x32_bf16 v[132:135], a[48:51], v[172:175], v[132:135]
    ds_read_b64_tr_b16 v[192:193], v15 offset:20480
    v_mfma_f32_16x16x32_bf16 v[136:139], a[52:55], v[172:175], v[136:139]
    ds_read_b64_tr_b16 v[194:195], v15 offset:20992
    v_mfma_f32_16x16x32_bf16 v[140:143], a[56:59], v[172:175], v[140:143]
    ds_read_b64_tr_b16 v[196:197], v16 offset:20480
    s_waitcnt lgkmcnt(7)
    v_mfma_f32_16x16x32_bf16 v[144:147], a[48:51], v[176:179], v[144:147]
    ds_read_b64_tr_b16 v[198:199], v16 offset:20992
    buffer_load_dwordx4 a[20:23], v24, s[72:75], s36 offen sc1
    v_mfma_f32_16x16x32_bf16 v[148:151], a[52:55], v[176:179], v[148:151]
    s_add_u32 s36, s36, 16384
    v_mfma_f32_16x16x32_bf16 v[152:155], a[56:59], v[176:179], v[152:155]
    v_mfma_f32_16x16x32_bf16 v[156:159], a[48:51], v[180:183], v[156:159]
    v_mfma_f32_16x16x32_bf16 v[160:163], a[52:55], v[180:183], v[160:163]
    buffer_load_dwordx4 a[24:27], v23, s[72:75], s36 offen sc1
    v_mfma_f32_16x16x32_bf16 v[164:167], a[56:59], v[180:183], v[164:167]
    s_waitcnt lgkmcnt(4)
    v_mfma_f32_16x16x32_bf16 v[108:111], v[184:187], v[184:187], v[108:111]
    ds_read_b64_tr_b16 v[168:169], v13 offset:24576
    v_mfma_f32_16x16x32_bf16 v[120:123], a[60:63], v[184:187], v[120:123]
    ds_read_b64_tr_b16 v[170:171], v13 offset:25088
    v_mfma_f32_16x16x32_bf16 v[124:127], a[64:67], v[184:187], v[124:127]
    ds_read_b64_tr_b16 v[172:173], v14 offset:24576
    buffer_load_dwordx4 a[28:31], v24, s[72:75], s36 offen sc1
    v_mfma_f32_16x16x32_bf16 v[128:131], a[68:71], v[184:187], v[128:131]
    ds_read_b64_tr_b16 v[174:175], v14 offset:25088
    s_add_u32 s36, s36, 16384
    v_mfma_f32_16x16x32_bf16 v[132:135], a[60:63], v[188:191], v[132:135]
    ds_read_b64_tr_b16 v[176:177], v15 offset:24576
    v_mfma_f32_16x16x32_bf16 v[136:139], a[64:67], v[188:191], v[136:139]
    ds_read_b64_tr_b16 v[178:179], v15 offset:25088
    v_mfma_f32_16x16x32_bf16 v[140:143], a[68:71], v[188:191], v[140:143]
    ds_read_b64_tr_b16 v[180:181], v16 offset:24576
    s_waitcnt lgkmcnt(7)
    v_mfma_f32_16x16x32_bf16 v[144:147], a[60:63], v[192:195], v[144:147]
    ds_read_b64_tr_b16 v[182:183], v16 offset:25088
    buffer_load_dwordx4 a[32:35], v23, s[72:75], s36 offen sc1
    v_mfma_f32_16x16x32_bf16 v[148:151], a[64:67], v[192:195], v[148:151]
    v_mfma_f32_16x16x32_bf16 v[152:155], a[68:71], v[192:195], v[152:155]
    v_mfma_f32_16x16x32_bf16 v[156:159], a[60:63], v[196:199], v[156:159]
    v_mfma_f32_16x16x32_bf16 v[160:163], a[64:67], v[196:199], v[160:163]
    buffer_load_dwordx4 a[36:39], v24, s[72:75], s36 offen sc1
    s_add_u32 s36, s36, 16384
    v_mfma_f32_16x16x32_bf16 v[164:167], a[68:71], v[196:199], v[164:167]
    s_waitcnt lgkmcnt(4)
    v_mfma_f32_16x16x32_bf16 v[108:111], v[168:171], v[168:171], v[108:111]
    ds_read_b64_tr_b16 v[184:185], v13 offset:28672
    v_mfma_f32_16x16x32_bf16 v[120:123], a[72:75], v[168:171], v[120:123]
    ds_read_b64_tr_b16 v[186:187], v13 offset:29184
    v_mfma_f32_16x16x32_bf16 v[124:127], a[76:79], v[168:171], v[124:127]
    ds_read_b64_tr_b16 v[188:189], v14 offset:28672
    buffer_load_dwordx4 a[40:43], v23, s[72:75], s36 offen sc1
    v_mfma_f32_16x16x32_bf16 v[128:131], a[80:83], v[168:171], v[128:131]
    ds_read_b64_tr_b16 v[190:191], v14 offset:29184
    v_mfma_f32_16x16x32_bf16 v[132:135], a[72:75], v[172:175], v[132:135]
    ds_read_b64_tr_b16 v[192:193], v15 offset:28672
    v_mfma_f32_16x16x32_bf16 v[136:139], a[76:79], v[172:175], v[136:139]
    ds_read_b64_tr_b16 v[194:195], v15 offset:29184
    v_mfma_f32_16x16x32_bf16 v[140:143], a[80:83], v[172:175], v[140:143]
    ds_read_b64_tr_b16 v[196:197], v16 offset:28672
    s_waitcnt lgkmcnt(7)
    v_mfma_f32_16x16x32_bf16 v[144:147], a[72:75], v[176:179], v[144:147]
    ds_read_b64_tr_b16 v[198:199], v16 offset:29184
    buffer_load_dwordx4 a[44:47], v24, s[72:75], s36 offen sc1
    v_mfma_f32_16x16x32_bf16 v[148:151], a[76:79], v[176:179], v[148:151]
    s_add_u32 s36, s36, 16384
    v_mfma_f32_16x16x32_bf16 v[152:155], a[80:83], v[176:179], v[152:155]
    v_mfma_f32_16x16x32_bf16 v[156:159], a[72:75], v[180:183], v[156:159]
    v_mfma_f32_16x16x32_bf16 v[160:163], a[76:79], v[180:183], v[160:163]
    buffer_load_dwordx4 a[48:51], v23, s[72:75], s36 offen sc1
    v_mfma_f32_16x16x32_bf16 v[164:167], a[80:83], v[180:183], v[164:167]
    v_add_u32 v13, 41984, v13
    v_add_u32 v14, 41984, v14
    v_add_u32 v15, 41984, v15
    v_add_u32 v16, 41984, v16
    s_waitcnt lgkmcnt(4)
    v_mfma_f32_16x16x32_bf16 v[108:111], v[184:187], v[184:187], v[108:111]
    ds_read_b64_tr_b16 v[168:169], v13 offset:32768
    v_mfma_f32_16x16x32_bf16 v[120:123], a[84:87], v[184:187], v[120:123]
    ds_read_b64_tr_b16 v[170:171], v13 offset:33280
    v_mfma_f32_16x16x32_bf16 v[124:127], a[88:91], v[184:187], v[124:127]
    ds_read_b64_tr_b16 v[172:173], v14 offset:32768
    buffer_load_dwordx4 a[52:55], v24, s[72:75], s36 offen sc1
    v_mfma_f32_16x16x32_bf16 v[128:131], a[92:95], v[184:187], v[128:131]
    ds_read_b64_tr_b16 v[174:175], v14 offset:33280
    s_add_u32 s36, s36, 16384
    v_mfma_f32_16x16x32_bf16 v[132:135], a[84:87], v[188:191], v[132:135]
    ds_read_b64_tr_b16 v[176:177], v15 offset:32768
    v_mfma_f32_16x16x32_bf16 v[136:139], a[88:91], v[188:191], v[136:139]
    ds_read_b64_tr_b16 v[178:179], v15 offset:33280
    v_mfma_f32_16x16x32_bf16 v[140:143], a[92:95], v[188:191], v[140:143]
    ds_read_b64_tr_b16 v[180:181], v16 offset:32768
    s_waitcnt lgkmcnt(7)
    v_mfma_f32_16x16x32_bf16 v[144:147], a[84:87], v[192:195], v[144:147]
    ds_read_b64_tr_b16 v[182:183], v16 offset:33280
    buffer_load_dwordx4 a[56:59], v23, s[72:75], s36 offen sc1
    v_mfma_f32_16x16x32_bf16 v[148:151], a[88:91], v[192:195], v[148:151]
    v_mfma_f32_16x16x32_bf16 v[152:155], a[92:95], v[192:195], v[152:155]
    v_mfma_f32_16x16x32_bf16 v[156:159], a[84:87], v[196:199], v[156:159]
    v_mfma_f32_16x16x32_bf16 v[160:163], a[88:91], v[196:199], v[160:163]
    buffer_load_dwordx4 a[60:63], v24, s[72:75], s36 offen sc1
    s_add_u32 s36, s36, 16384
    v_mfma_f32_16x16x32_bf16 v[164:167], a[92:95], v[196:199], v[164:167]
    s_waitcnt lgkmcnt(4)
    v_mfma_f32_16x16x32_bf16 v[108:111], v[168:171], v[168:171], v[108:111]
    ds_read_b64_tr_b16 v[184:185], v13 offset:36864
    v_mfma_f32_16x16x32_bf16 v[120:123], a[96:99], v[168:171], v[120:123]
    ds_read_b64_tr_b16 v[186:187], v13 offset:37376
    v_mfma_f32_16x16x32_bf16 v[124:127], a[100:103], v[168:171], v[124:127]
    ds_read_b64_tr_b16 v[188:189], v14 offset:36864
    buffer_load_dwordx4 a[64:67], v23, s[72:75], s36 offen sc1
    v_mfma_f32_16x16x32_bf16 v[128:131], a[104:107], v[168:171], v[128:131]
    ds_read_b64_tr_b16 v[190:191], v14 offset:37376
    v_mfma_f32_16x16x32_bf16 v[132:135], a[96:99], v[172:175], v[132:135]
    ds_read_b64_tr_b16 v[192:193], v15 offset:36864
    v_mfma_f32_16x16x32_bf16 v[136:139], a[100:103], v[172:175], v[136:139]
    ds_read_b64_tr_b16 v[194:195], v15 offset:37376
    v_mfma_f32_16x16x32_bf16 v[140:143], a[104:107], v[172:175], v[140:143]
    ds_read_b64_tr_b16 v[196:197], v16 offset:36864
    s_waitcnt lgkmcnt(7)
    v_mfma_f32_16x16x32_bf16 v[144:147], a[96:99], v[176:179], v[144:147]
    ds_read_b64_tr_b16 v[198:199], v16 offset:37376
    buffer_load_dwordx4 a[68:71], v24, s[72:75], s36 offen sc1
    v_mfma_f32_16x16x32_bf16 v[148:151], a[100:103], v[176:179], v[148:151]
    s_add_u32 s36, s36, 16384
    v_mfma_f32_16x16x32_bf16 v[152:155], a[104:107], v[176:179], v[152:155]
    v_mfma_f32_16x16x32_bf16 v[156:159], a[96:99], v[180:183], v[156:159]
    v_mfma_f32_16x16x32_bf16 v[160:163], a[100:103], v[180:183], v[160:163]
    buffer_load_dwordx4 a[72:75], v23, s[72:75], s36 offen sc1
    v_mfma_f32_16x16x32_bf16 v[164:167], a[104:107], v[180:183], v[164:167]
    s_waitcnt lgkmcnt(4)
    v_mfma_f32_16x16x32_bf16 v[108:111], v[184:187], v[184:187], v[108:111]
    ds_read_b64_tr_b16 v[168:169], v13 offset:40960
    v_mfma_f32_16x16x32_bf16 v[120:123], a[108:111], v[184:187], v[120:123]
    ds_read_b64_tr_b16 v[170:171], v13 offset:41472
    v_mfma_f32_16x16x32_bf16 v[124:127], a[112:115], v[184:187], v[124:127]
    ds_read_b64_tr_b16 v[172:173], v14 offset:40960
    buffer_load_dwordx4 a[76:79], v24, s[72:75], s36 offen sc1
    v_mfma_f32_16x16x32_bf16 v[128:131], a[116:119], v[184:187], v[128:131]
    ds_read_b64_tr_b16 v[174:175], v14 offset:41472
    s_add_u32 s36, s36, 16384
    v_mfma_f32_16x16x32_bf16 v[132:135], a[108:111], v[188:191], v[132:135]
    ds_read_b64_tr_b16 v[176:177], v15 offset:40960
    v_mfma_f32_16x16x32_bf16 v[136:139], a[112:115], v[188:191], v[136:139]
    ds_read_b64_tr_b16 v[178:179], v15 offset:41472
    v_mfma_f32_16x16x32_bf16 v[140:143], a[116:119], v[188:191], v[140:143]
    ds_read_b64_tr_b16 v[180:181], v16 offset:40960
    s_waitcnt lgkmcnt(7)
    v_mfma_f32_16x16x32_bf16 v[144:147], a[108:111], v[192:195], v[144:147]
    ds_read_b64_tr_b16 v[182:183], v16 offset:41472
    buffer_load_dwordx4 a[80:83], v23, s[72:75], s36 offen sc1
    v_mfma_f32_16x16x32_bf16 v[148:151], a[112:115], v[192:195], v[148:151]
    ds_read_b64_tr_b16 v[232:233], v13 offset:61440
    v_mfma_f32_16x16x32_bf16 v[152:155], a[116:119], v[192:195], v[152:155]
    ds_read_b64_tr_b16 v[234:235], v13 offset:61952
    v_mfma_f32_16x16x32_bf16 v[156:159], a[108:111], v[196:199], v[156:159]
    ds_read_b64_tr_b16 v[236:237], v14 offset:61440
    v_mfma_f32_16x16x32_bf16 v[160:163], a[112:115], v[196:199], v[160:163]
    ds_read_b64_tr_b16 v[238:239], v14 offset:61952
    buffer_load_dwordx4 a[84:87], v24, s[72:75], s36 offen sc1
    v_mfma_f32_16x16x32_bf16 v[164:167], a[116:119], v[196:199], v[164:167]
    s_add_u32 s36, s36, 16384
    s_waitcnt lgkmcnt(8)
    v_mfma_f32_16x16x32_bf16 v[108:111], v[168:171], v[168:171], v[108:111]
    ds_read_b64_tr_b16 v[184:185], v13 offset:45056
    v_mfma_f32_16x16x32_bf16 v[120:123], a[120:123], v[168:171], v[120:123]
    ds_read_b64_tr_b16 v[186:187], v13 offset:45568
    v_mfma_f32_16x16x32_bf16 v[124:127], a[124:127], v[168:171], v[124:127]
    ds_read_b64_tr_b16 v[188:189], v14 offset:45056
    buffer_load_dwordx4 a[88:91], v23, s[72:75], s36 offen sc1
    v_mfma_f32_16x16x32_bf16 v[128:131], a[128:131], v[168:171], v[128:131]
    ds_read_b64_tr_b16 v[190:191], v14 offset:45568
    v_mfma_f32_16x16x32_bf16 v[132:135], a[120:123], v[172:175], v[132:135]
    ds_read_b64_tr_b16 v[192:193], v15 offset:45056
    v_mfma_f32_16x16x32_bf16 v[136:139], a[124:127], v[172:175], v[136:139]
    ds_read_b64_tr_b16 v[194:195], v15 offset:45568
    v_mfma_f32_16x16x32_bf16 v[140:143], a[128:131], v[172:175], v[140:143]
    ds_read_b64_tr_b16 v[196:197], v16 offset:45056
    s_waitcnt lgkmcnt(11)
    v_mfma_f32_16x16x32_bf16 v[144:147], a[120:123], v[176:179], v[144:147]
    ds_read_b64_tr_b16 v[198:199], v16 offset:45568
    buffer_load_dwordx4 a[92:95], v24, s[72:75], s36 offen sc1
    v_mfma_f32_16x16x32_bf16 v[148:151], a[124:127], v[176:179], v[148:151]
    ds_read_b64_tr_b16 v[84:85], v13 offset:57344
    v_add_u32 v7, 327680, v23
    v_mfma_f32_16x16x32_bf16 v[152:155], a[128:131], v[176:179], v[152:155]
    ds_read_b64_tr_b16 v[86:87], v13 offset:57856
    v_mfma_f32_16x16x32_bf16 v[156:159], a[120:123], v[180:183], v[156:159]
    ds_read_b64_tr_b16 v[88:89], v14 offset:57344
    v_mfma_f32_16x16x32_bf16 v[160:163], a[124:127], v[180:183], v[160:163]
    ds_read_b64_tr_b16 v[90:91], v14 offset:57856
    buffer_load_dwordx4 a[96:99], v7, s[72:75], 0 offen sc1
    v_mfma_f32_16x16x32_bf16 v[164:167], a[128:131], v[180:183], v[164:167]
    v_add_u32 v7, 327680, v24
    s_waitcnt lgkmcnt(8)
    v_mfma_f32_16x16x32_bf16 v[108:111], v[184:187], v[184:187], v[108:111]
    ds_read_b64_tr_b16 v[168:169], v13 offset:49152
    buffer_load_dword v43, v32, s[40:43], s78 offen sc1
    v_mfma_f32_16x16x32_bf16 v[120:123], a[132:135], v[184:187], v[120:123]
    ds_read_b64_tr_b16 v[170:171], v13 offset:49664
    v_mfma_f32_16x16x32_bf16 v[124:127], a[136:139], v[184:187], v[124:127]
    ds_read_b64_tr_b16 v[172:173], v14 offset:49152
    buffer_load_dwordx4 a[100:103], v7, s[72:75], 0 offen sc1
    v_mfma_f32_16x16x32_bf16 v[128:131], a[140:143], v[184:187], v[128:131]
    ds_read_b64_tr_b16 v[174:175], v14 offset:49664
    v_add_u32 v7, 344064, v23
    v_mfma_f32_16x16x32_bf16 v[132:135], a[132:135], v[188:191], v[132:135]
    ds_read_b64_tr_b16 v[176:177], v15 offset:49152
    v_mfma_f32_16x16x32_bf16 v[136:139], a[136:139], v[188:191], v[136:139]
    ds_read_b64_tr_b16 v[178:179], v15 offset:49664
    v_mfma_f32_16x16x32_bf16 v[140:143], a[140:143], v[188:191], v[140:143]
    ds_read_b64_tr_b16 v[180:181], v16 offset:49152
    s_waitcnt lgkmcnt(11)
    v_mfma_f32_16x16x32_bf16 v[144:147], a[132:135], v[192:195], v[144:147]
    ds_read_b64_tr_b16 v[182:183], v16 offset:49664
    buffer_load_dwordx4 a[104:107], v7, s[72:75], 0 offen sc1
    v_mfma_f32_16x16x32_bf16 v[148:151], a[136:139], v[192:195], v[148:151]
    ds_read_b64_tr_b16 v[92:93], v15 offset:57344
    v_add_u32 v7, 344064, v24
    v_mfma_f32_16x16x32_bf16 v[152:155], a[140:143], v[192:195], v[152:155]
    ds_read_b64_tr_b16 v[94:95], v15 offset:57856
    v_mfma_f32_16x16x32_bf16 v[156:159], a[132:135], v[196:199], v[156:159]
    ds_read_b64_tr_b16 v[96:97], v16 offset:57344
    v_mfma_f32_16x16x32_bf16 v[160:163], a[136:139], v[196:199], v[160:163]
    ds_read_b64_tr_b16 v[98:99], v16 offset:57856
    buffer_load_dwordx4 a[108:111], v7, s[72:75], 0 offen sc1
    v_mfma_f32_16x16x32_bf16 v[164:167], a[140:143], v[196:199], v[164:167]
    s_waitcnt lgkmcnt(8)
    v_mfma_f32_16x16x32_bf16 v[108:111], v[168:171], v[168:171], v[108:111]
    ds_read_b64_tr_b16 v[184:185], v13 offset:53248
    v_mfma_f32_16x16x32_bf16 v[120:123], a[144:147], v[168:171], v[120:123]
    ds_read_b64_tr_b16 v[186:187], v13 offset:53760
    v_mfma_f32_16x16x32_bf16 v[124:127], a[148:151], v[168:171], v[124:127]
    ds_read_b64_tr_b16 v[188:189], v14 offset:53248
    v_mfma_f32_16x16x32_bf16 v[128:131], a[152:155], v[168:171], v[128:131]
    ds_read_b64_tr_b16 v[190:191], v14 offset:53760
    v_mfma_f32_16x16x32_bf16 v[132:135], a[144:147], v[172:175], v[132:135]
    ds_read_b64_tr_b16 v[192:193], v15 offset:53248
    v_mfma_f32_16x16x32_bf16 v[136:139], a[148:151], v[172:175], v[136:139]
    ds_read_b64_tr_b16 v[194:195], v15 offset:53760
    v_mfma_f32_16x16x32_bf16 v[140:143], a[152:155], v[172:175], v[140:143]
    ds_read_b64_tr_b16 v[196:197], v16 offset:53248
    s_waitcnt lgkmcnt(11)
    v_mfma_f32_16x16x32_bf16 v[144:147], a[144:147], v[176:179], v[144:147]
    ds_read_b64_tr_b16 v[198:199], v16 offset:53760
    v_mfma_f32_16x16x32_bf16 v[148:151], a[148:151], v[176:179], v[148:151]
    ds_read_b64_tr_b16 v[240:241], v15 offset:61440
    v_mfma_f32_16x16x32_bf16 v[152:155], a[152:155], v[176:179], v[152:155]
    ds_read_b64_tr_b16 v[242:243], v15 offset:61952
    v_mfma_f32_16x16x32_bf16 v[156:159], a[144:147], v[180:183], v[156:159]
    ds_read_b64_tr_b16 v[244:245], v16 offset:61440
    v_mfma_f32_16x16x32_bf16 v[160:163], a[148:151], v[180:183], v[160:163]
    ds_read_b64_tr_b16 v[246:247], v16 offset:61952
    v_mfma_f32_16x16x32_bf16 v[164:167], a[152:155], v[180:183], v[164:167]
    s_waitcnt lgkmcnt(8)
    v_mfma_f32_16x16x32_bf16 v[108:111], v[184:187], v[184:187], v[108:111]
    s_cmp_ge_u32 s22, 8
    s_cselect_b32 s26, 41984, 0
    v_mfma_f32_16x16x32_bf16 v[128:131], a[164:167], v[184:187], v[128:131]
    s_add_u32 s26, s26, 33280
    v_add_u32 v8, s26, v26
    v_mfma_f32_16x16x32_bf16 v[140:143], a[164:167], v[188:191], v[140:143]
    ds_read2_b64 v[116:119], v8 offset0:0 offset1:2
    s_waitcnt lgkmcnt(5)
    v_mfma_f32_16x16x32_bf16 v[152:155], a[164:167], v[192:195], v[152:155]
    v_mfma_f32_16x16x32_bf16 v[164:167], a[164:167], v[196:199], v[164:167]
    v_mfma_f32_16x16x32_bf16 v[108:111], v[84:87], v[84:87], v[108:111]
    v_mfma_f32_16x16x32_bf16 v[128:131], a[176:179], v[84:87], v[128:131]
    v_mfma_f32_16x16x32_bf16 v[140:143], a[176:179], v[88:91], v[140:143]
    v_mfma_f32_16x16x32_bf16 v[152:155], a[176:179], v[92:95], v[152:155]
    v_mfma_f32_16x16x32_bf16 v[164:167], a[176:179], v[96:99], v[164:167]
    s_waitcnt lgkmcnt(1)
    v_mfma_f32_16x16x32_bf16 v[108:111], v[232:235], v[232:235], v[108:111]
    v_mfma_f32_16x16x32_bf16 v[128:131], a[188:191], v[232:235], v[128:131]
    v_mfma_f32_16x16x32_bf16 v[140:143], a[188:191], v[236:239], v[140:143]
    v_mfma_f32_16x16x32_bf16 v[152:155], a[188:191], v[240:243], v[152:155]
    v_mfma_f32_16x16x32_bf16 v[164:167], a[188:191], v[244:247], v[164:167]
    v_mfma_f32_16x16x32_bf16 v[120:123], a[156:159], v[184:187], v[120:123]
    v_mfma_f32_16x16x32_bf16 v[124:127], a[160:163], v[184:187], v[124:127]
    s_nop 1
    v_cndmask_b32 v102, v108, v109, s[12:13]
    v_cndmask_b32 v102, v102, v110, s[14:15]
    v_mfma_f32_16x16x32_bf16 v[132:135], a[156:159], v[188:191], v[132:135]
    v_cndmask_b32 v102, v102, v111, s[16:17]
    v_mfma_f32_16x16x32_bf16 v[136:139], a[160:163], v[188:191], v[136:139]
    s_mov_b64 exec, s[18:19]
    ds_write_b32 v17, v102 offset:512
    s_mov_b64 exec, s[100:101]
    ds_write_b32 v18, v128 offset:704
    ds_write_b32 v18, v140 offset:512
    ds_write_b32 v18, v152 offset:576
    ds_write_b32 v18, v164 offset:640
    s_mov_b64 exec, -1
    v_mfma_f32_16x16x32_bf16 v[144:147], a[156:159], v[192:195], v[144:147]
    v_mfma_f32_16x16x32_bf16 v[148:151], a[160:163], v[192:195], v[148:151]
    v_mfma_f32_16x16x32_bf16 v[156:159], a[156:159], v[196:199], v[156:159]
    v_mfma_f32_16x16x32_bf16 v[160:163], a[160:163], v[196:199], v[160:163]
    v_mfma_f32_16x16x32_bf16 v[120:123], a[168:171], v[84:87], v[120:123]
    v_mfma_f32_16x16x32_bf16 v[124:127], a[172:175], v[84:87], v[124:127]
    s_cmp_lg_u32 s20, 0
    s_cbranch_scc1 PC_D4
    s_waitcnt vmcnt(3)
    s_mov_b32 s33, 0x40000
PC_L4:
    v_cmp_ne_u32 vcc, 16, v43
    s_cmp_eq_u64 vcc, 0
    s_cbranch_scc1 PC_D4
    s_sub_u32 s33, s33, 1
    s_cbranch_scc1 PC_D4
    s_sleep 1
    buffer_load_dword v43, v32, s[40:43], s78 offen sc1
    s_waitcnt vmcnt(0)
    s_branch PC_L4
PC_D4:
    s_waitcnt lgkmcnt(0)
    s_barrier
    ds_read2_b32 v[100:101], v19 offset0:128 offset1:192
    buffer_load_dwordx4 v[200:203], v25, s[84:87], s35 offen sc1
    v_mfma_f32_16x16x32_bf16 v[132:135], a[168:171], v[88:91], v[132:135]
    s_add_u32 s35, s35, 65536
    v_mfma_f32_16x16x32_bf16 v[136:139], a[172:175], v[88:91], v[136:139]
    v_mfma_f32_16x16x32_bf16 v[144:147], a[168:171], v[92:95], v[144:147]
    v_mfma_f32_16x16x32_bf16 v[148:151], a[172:175], v[92:95], v[148:151]
    buffer_load_dwordx4 v[204:207], v25, s[84:87], s35 offen sc1
    v_mfma_f32_16x16x32_bf16 v[156:159], a[168:171], v[96:99], v[156:159]
    s_waitcnt lgkmcnt(0)
    v_mfma_f32_16x16x32_bf16 v[160:163], a[172:175], v[96:99], v[160:163]
    v_mul_f32 v104, 0xbb000000, v100
    v_mul_f32 v101, s76, v101
    v_mfma_f32_16x16x32_bf16 v[120:123], a[180:183], v[232:235], v[120:123]
    v_fma_f32 v101, -v104, v104, v101
    v_max_f32 v101, 0, v101
    v_mfma_f32_16x16x32_bf16 v[124:127], a[184:187], v[232:235], v[124:127]
    v_add_f32 v107, 0x3727c5ac, v101
    s_add_u32 s35, s35, 65536
    v_mfma_f32_16x16x32_bf16 v[132:135], a[180:183], v[236:239], v[132:135]
    v_rsq_f32 v100, v107
    s_nop 0
    v_mul_f32 v105, 0xc0135761, v100
    v_mfma_f32_16x16x32_bf16 v[136:139], a[184:187], v[236:239], v[136:139]
    v_mul_f32 v101, v100, v100
    v_mul_f32 v100, 0xbdd2d3e8, v100
    v_mfma_f32_16x16x32_bf16 v[144:147], a[180:183], v[240:243], v[144:147]
    v_mul_f32 v106, v101, v100
    buffer_load_dwordx4 v[208:211], v25, s[84:87], s35 offen sc1
    v_mfma_f32_16x16x32_bf16 v[148:151], a[184:187], v[240:243], v[148:151]
    ds_write_b128 v20, v[104:107]
    ds_read_b128 v[68:71], v21 offset:0
    ds_read_b128 v[72:75], v21 offset:256
    ds_read_b128 v[76:79], v21 offset:512
    ds_read_b128 v[80:83], v21 offset:768
    s_add_u32 s35, s35, 65536
    v_mfma_f32_16x16x32_bf16 v[156:159], a[180:183], v[244:247], v[156:159]
    v_mfma_f32_16x16x32_bf16 v[160:163], a[184:187], v[244:247], v[160:163]
    s_waitcnt lgkmcnt(0)
    v_pk_fma_f32 v[128:129], v[60:61], v[68:69], v[128:129] op_sel:[0,0,0] op_sel_hi:[1,0,1]
    v_pk_fma_f32 v[140:141], v[60:61], v[72:73], v[140:141] op_sel:[0,0,0] op_sel_hi:[1,0,1]
    buffer_load_dwordx4 v[212:215], v25, s[84:87], s35 offen sc1
    v_pk_fma_f32 v[130:131], v[62:63], v[68:69], v[130:131] op_sel:[0,0,0] op_sel_hi:[1,0,1]
    v_pk_fma_f32 v[142:143], v[62:63], v[72:73], v[142:143] op_sel:[0,0,0] op_sel_hi:[1,0,1]
    v_pk_mul_f32 v[96:97], v[128:129], v[128:129]
    v_pk_mul_f32 v[98:99], v[140:141], v[140:141]
    v_pk_mul_f32 v[130:131], v[130:131], v[128:129]
    v_pk_mul_f32 v[142:143], v[142:143], v[140:141]
    v_pk_fma_f32 v[96:97], v[96:97], v[70:71], v[68:69] op_sel:[0,0,1] op_sel_hi:[1,0,1]
    v_pk_fma_f32 v[98:99], v[98:99], v[74:75], v[72:73] op_sel:[0,0,1] op_sel_hi:[1,0,1]
    v_pk_mul_f32 v[96:97], v[96:97], v[128:129]
    v_pk_mul_f32 v[98:99], v[98:99], v[140:141]
    v_exp_f32 v96, v96
    v_exp_f32 v98, v98
    v_exp_f32 v97, v97
    v_exp_f32 v99, v99
    v_pk_fma_f32 v[96:97], v[96:97], v[70:71], v[70:71] op_sel:[0,1,1] op_sel_hi:[1,1,1]
    v_pk_fma_f32 v[98:99], v[98:99], v[74:75], v[74:75] op_sel:[0,1,1] op_sel_hi:[1,1,1]
    v_rcp_f32 v96, v96
    v_rcp_f32 v98, v98
    s_add_u32 s35, s35, 65536
    buffer_load_dwordx4 v[216:219], v25, s[84:87], s35 offen sc1
    v_rcp_f32 v97, v97
    v_rcp_f32 v99, v99
    v_pk_mul_f32 v[130:131], v[130:131], v[96:97]
    v_pk_mul_f32 v[142:143], v[142:143], v[98:99]
    v_cvt_pk_bf16_f32 v92, v130, v131
    v_cvt_pk_bf16_f32 v93, v142, v143
    v_pk_fma_f32 v[152:153], v[60:61], v[76:77], v[152:153] op_sel:[0,0,0] op_sel_hi:[1,0,1]
    v_pk_fma_f32 v[164:165], v[60:61], v[80:81], v[164:165] op_sel:[0,0,0] op_sel_hi:[1,0,1]
    s_add_u32 s35, s35, 65536
    buffer_load_dwordx4 v[220:223], v25, s[84:87], s35 offen sc1
    v_pk_fma_f32 v[154:155], v[62:63], v[76:77], v[154:155] op_sel:[0,0,0] op_sel_hi:[1,0,1]
    v_pk_fma_f32 v[166:167], v[62:63], v[80:81], v[166:167] op_sel:[0,0,0] op_sel_hi:[1,0,1]
    v_pk_mul_f32 v[96:97], v[152:153], v[152:153]
    v_pk_mul_f32 v[98:99], v[164:165], v[164:165]
    v_pk_mul_f32 v[154:155], v[154:155], v[152:153]
    v_pk_mul_f32 v[166:167], v[166:167], v[164:165]
    v_pk_fma_f32 v[96:97], v[96:97], v[78:79], v[76:77] op_sel:[0,0,1] op_sel_hi:[1,0,1]
    v_pk_fma_f32 v[98:99], v[98:99], v[82:83], v[80:81] op_sel:[0,0,1] op_sel_hi:[1,0,1]
    v_pk_mul_f32 v[96:97], v[96:97], v[152:153]
    v_pk_mul_f32 v[98:99], v[98:99], v[164:165]
    v_exp_f32 v96, v96
    v_exp_f32 v98, v98
    v_exp_f32 v97, v97
    v_exp_f32 v99, v99
    v_pk_fma_f32 v[96:97], v[96:97], v[78:79], v[78:79] op_sel:[0,1,1] op_sel_hi:[1,1,1]
    v_pk_fma_f32 v[98:99], v[98:99], v[82:83], v[82:83] op_sel:[0,1,1] op_sel_hi:[1,1,1]
    v_rcp_f32 v96, v96
    v_rcp_f32 v98, v98
    s_add_u32 s35, s35, 65536
    buffer_load_dwordx4 v[224:227], v25, s[84:87], s35 offen sc1
    v_rcp_f32 v97, v97
    v_rcp_f32 v99, v99
    v_pk_mul_f32 v[154:155], v[154:155], v[96:97]
    v_pk_mul_f32 v[166:167], v[166:167], v[98:99]
    v_cvt_pk_bf16_f32 v94, v154, v155
    v_cvt_pk_bf16_f32 v95, v166, v167
    s_nop 0
    v_permlane32_swap_b32 v92, v94
    v_permlane32_swap_b32 v93, v95
    s_nop 1
    v_permlane16_swap_b32 v92, v93
    v_permlane16_swap_b32 v94, v95
    buffer_store_dwordx4 v[92:95], v22, s[64:67], s98 offen sc1
    v_pk_fma_f32 v[120:121], v[44:45], v[68:69], v[120:121] op_sel:[0,0,0] op_sel_hi:[1,0,1]
    v_pk_fma_f32 v[132:133], v[44:45], v[72:73], v[132:133] op_sel:[0,0,0] op_sel_hi:[1,0,1]
    s_add_u32 s35, s35, 65536
    buffer_load_dwordx4 v[228:231], v25, s[84:87], s35 offen sc1
    v_pk_fma_f32 v[122:123], v[46:47], v[68:69], v[122:123] op_sel:[0,0,0] op_sel_hi:[1,0,1]
    v_pk_fma_f32 v[134:135], v[46:47], v[72:73], v[134:135] op_sel:[0,0,0] op_sel_hi:[1,0,1]
    v_pk_mul_f32 v[96:97], v[120:121], v[120:121]
    v_pk_mul_f32 v[98:99], v[132:133], v[132:133]
    v_pk_mul_f32 v[122:123], v[122:123], v[120:121]
    v_pk_mul_f32 v[134:135], v[134:135], v[132:133]
    v_pk_fma_f32 v[96:97], v[96:97], v[70:71], v[68:69] op_sel:[0,0,1] op_sel_hi:[1,0,1]
    v_pk_fma_f32 v[98:99], v[98:99], v[74:75], v[72:73] op_sel:[0,0,1] op_sel_hi:[1,0,1]
    v_pk_mul_f32 v[96:97], v[96:97], v[120:121]
    v_pk_mul_f32 v[98:99], v[98:99], v[132:133]
    v_exp_f32 v96, v96
    v_exp_f32 v98, v98
    v_exp_f32 v97, v97
    v_exp_f32 v99, v99
    v_pk_fma_f32 v[96:97], v[96:97], v[70:71], v[70:71] op_sel:[0,1,1] op_sel_hi:[1,1,1]
    v_pk_fma_f32 v[98:99], v[98:99], v[74:75], v[74:75] op_sel:[0,1,1] op_sel_hi:[1,1,1]
    v_rcp_f32 v96, v96
    v_rcp_f32 v98, v98
    s_add_u32 s35, s35, 65536
    buffer_load_dwordx4 v[232:235], v25, s[84:87], s35 offen sc1
    v_rcp_f32 v97, v97
    v_rcp_f32 v99, v99
    v_pk_mul_f32 v[122:123], v[122:123], v[96:97]
    v_pk_mul_f32 v[134:135], v[134:135], v[98:99]
    v_cvt_pk_bf16_f32 v84, v122, v123
    v_cvt_pk_bf16_f32 v85, v134, v135
    v_pk_fma_f32 v[144:145], v[44:45], v[76:77], v[144:145] op_sel:[0,0,0] op_sel_hi:[1,0,1]
    v_pk_fma_f32 v[156:157], v[44:45], v[80:81], v[156:157] op_sel:[0,0,0] op_sel_hi:[1,0,1]
    s_add_u32 s35, s35, 65536
    buffer_load_dwordx4 v[236:239], v25, s[84:87], s35 offen sc1
    v_pk_fma_f32 v[146:147], v[46:47], v[76:77], v[146:147] op_sel:[0,0,0] op_sel_hi:[1,0,1]
    v_pk_fma_f32 v[158:159], v[46:47], v[80:81], v[158:159] op_sel:[0,0,0] op_sel_hi:[1,0,1]
    v_pk_mul_f32 v[96:97], v[144:145], v[144:145]
    v_pk_mul_f32 v[98:99], v[156:157], v[156:157]
    v_pk_mul_f32 v[146:147], v[146:147], v[144:145]
    v_pk_mul_f32 v[158:159], v[158:159], v[156:157]
    v_pk_fma_f32 v[96:97], v[96:97], v[78:79], v[76:77] op_sel:[0,0,1] op_sel_hi:[1,0,1]
    v_pk_fma_f32 v[98:99], v[98:99], v[82:83], v[80:81] op_sel:[0,0,1] op_sel_hi:[1,0,1]
    v_pk_mul_f32 v[96:97], v[96:97], v[144:145]
    v_pk_mul_f32 v[98:99], v[98:99], v[156:157]
    v_exp_f32 v96, v96
    v_exp_f32 v98, v98
    v_exp_f32 v97, v97
    v_exp_f32 v99, v99
    v_pk_fma_f32 v[96:97], v[96:97], v[78:79], v[78:79] op_sel:[0,1,1] op_sel_hi:[1,1,1]
    v_pk_fma_f32 v[98:99], v[98:99], v[82:83], v[82:83] op_sel:[0,1,1] op_sel_hi:[1,1,1]
    v_rcp_f32 v96, v96
    v_rcp_f32 v98, v98
    s_add_u32 s35, s35, 65536
    buffer_load_dwordx4 v[240:243], v25, s[84:87], s35 offen sc1
    v_rcp_f32 v97, v97
    v_rcp_f32 v99, v99
    v_pk_mul_f32 v[146:147], v[146:147], v[96:97]
    v_pk_mul_f32 v[158:159], v[158:159], v[98:99]
    v_cvt_pk_bf16_f32 v86, v146, v147
    v_cvt_pk_bf16_f32 v87, v158, v159
    s_nop 0
    v_permlane32_swap_b32 v84, v86
    v_permlane32_swap_b32 v85, v87
    s_nop 1
    v_permlane16_swap_b32 v84, v85
    v_permlane16_swap_b32 v86, v87
    buffer_store_dwordx4 v[84:87], v22, s[92:95], s98 offen sc1
    v_pk_fma_f32 v[124:125], v[52:53], v[68:69], v[124:125] op_sel:[0,0,0] op_sel_hi:[1,0,1]
    v_pk_fma_f32 v[136:137], v[52:53], v[72:73], v[136:137] op_sel:[0,0,0] op_sel_hi:[1,0,1]
    s_add_u32 s35, s35, 65536
    buffer_load_dwordx4 v[244:247], v25, s[84:87], s35 offen sc1
    v_pk_fma_f32 v[126:127], v[54:55], v[68:69], v[126:127] op_sel:[0,0,0] op_sel_hi:[1,0,1]
    v_pk_fma_f32 v[138:139], v[54:55], v[72:73], v[138:139] op_sel:[0,0,0] op_sel_hi:[1,0,1]
    v_pk_mul_f32 v[96:97], v[124:125], v[124:125]
    v_pk_mul_f32 v[98:99], v[136:137], v[136:137]
    v_pk_mul_f32 v[126:127], v[126:127], v[124:125]
    v_pk_mul_f32 v[138:139], v[138:139], v[136:137]
    v_pk_fma_f32 v[96:97], v[96:97], v[70:71], v[68:69] op_sel:[0,0,1] op_sel_hi:[1,0,1]
    v_pk_fma_f32 v[98:99], v[98:99], v[74:75], v[72:73] op_sel:[0,0,1] op_sel_hi:[1,0,1]
    v_pk_mul_f32 v[96:97], v[96:97], v[124:125]
    v_pk_mul_f32 v[98:99], v[98:99], v[136:137]
    v_exp_f32 v96, v96
    v_exp_f32 v98, v98
    v_exp_f32 v97, v97
    v_exp_f32 v99, v99
    v_pk_fma_f32 v[96:97], v[96:97], v[70:71], v[70:71] op_sel:[0,1,1] op_sel_hi:[1,1,1]
    v_pk_fma_f32 v[98:99], v[98:99], v[74:75], v[74:75] op_sel:[0,1,1] op_sel_hi:[1,1,1]
    v_rcp_f32 v96, v96
    v_rcp_f32 v98, v98
    s_add_u32 s35, s35, 65536
    buffer_load_dwordx4 v[168:171], v25, s[84:87], s35 offen sc1
    v_rcp_f32 v97, v97
    v_rcp_f32 v99, v99
    v_pk_mul_f32 v[126:127], v[126:127], v[96:97]
    v_pk_mul_f32 v[138:139], v[138:139], v[98:99]
    v_cvt_pk_bf16_f32 v88, v126, v127
    v_cvt_pk_bf16_f32 v89, v138, v139
    v_pk_fma_f32 v[148:149], v[52:53], v[76:77], v[148:149] op_sel:[0,0,0] op_sel_hi:[1,0,1]
    v_pk_fma_f32 v[160:161], v[52:53], v[80:81], v[160:161] op_sel:[0,0,0] op_sel_hi:[1,0,1]
    s_add_u32 s35, s35, 65536
    buffer_load_dwordx4 v[172:175], v25, s[84:87], s35 offen sc1
    v_pk_fma_f32 v[150:151], v[54:55], v[76:77], v[150:151] op_sel:[0,0,0] op_sel_hi:[1,0,1]
    v_pk_fma_f32 v[162:163], v[54:55], v[80:81], v[162:163] op_sel:[0,0,0] op_sel_hi:[1,0,1]
    v_pk_mul_f32 v[96:97], v[148:149], v[148:149]
    v_pk_mul_f32 v[98:99], v[160:161], v[160:161]
    v_pk_mul_f32 v[150:151], v[150:151], v[148:149]
    v_pk_mul_f32 v[162:163], v[162:163], v[160:161]
    v_pk_fma_f32 v[96:97], v[96:97], v[78:79], v[76:77] op_sel:[0,0,1] op_sel_hi:[1,0,1]
    v_pk_fma_f32 v[98:99], v[98:99], v[82:83], v[80:81] op_sel:[0,0,1] op_sel_hi:[1,0,1]
    v_pk_mul_f32 v[96:97], v[96:97], v[148:149]
    v_pk_mul_f32 v[98:99], v[98:99], v[160:161]
    v_exp_f32 v96, v96
    v_exp_f32 v98, v98
    v_exp_f32 v97, v97
    v_exp_f32 v99, v99
    v_pk_fma_f32 v[96:97], v[96:97], v[78:79], v[78:79] op_sel:[0,1,1] op_sel_hi:[1,1,1]
    v_pk_fma_f32 v[98:99], v[98:99], v[82:83], v[82:83] op_sel:[0,1,1] op_sel_hi:[1,1,1]
    v_rcp_f32 v96, v96
    v_rcp_f32 v98, v98
    s_add_u32 s35, s35, 65536
    buffer_load_dwordx4 v[176:179], v25, s[84:87], s35 offen sc1
    v_rcp_f32 v97, v97
    v_rcp_f32 v99, v99
    v_pk_mul_f32 v[150:151], v[150:151], v[96:97]
    v_pk_mul_f32 v[162:163], v[162:163], v[98:99]
    v_cvt_pk_bf16_f32 v90, v150, v151
    v_cvt_pk_bf16_f32 v91, v162, v163
    s_nop 0
    v_permlane32_swap_b32 v88, v90
    v_permlane32_swap_b32 v89, v91
    s_nop 1
    v_permlane16_swap_b32 v88, v89
    v_permlane16_swap_b32 v90, v91
    buffer_store_dwordx4 v[88:91], v22, s[92:95], s96 offen sc1
    s_waitcnt vmcnt(17)
    v_mfma_f32_32x32x16_bf16 v[120:135], v[200:203], a[192:195], 0
    s_add_u32 s35, s35, 65536
    buffer_load_dwordx4 v[180:183], v25, s[84:87], s35 offen sc1
    v_mfma_f32_32x32x16_bf16 v[136:151], v[200:203], a[196:199], 0
    s_add_u32 s35, s35, 65536
    buffer_load_dwordx4 v[184:187], v25, s[84:87], s35 offen sc1
    s_waitcnt vmcnt(18)
    v_mfma_f32_32x32x16_bf16 v[120:135], v[204:207], a[200:203], v[120:135]
    s_add_u32 s35, s35, 65536
    buffer_load_dwordx4 v[188:191], v25, s[84:87], s35 offen sc1
    v_mfma_f32_32x32x16_bf16 v[136:151], v[204:207], a[204:207], v[136:151]
    s_add_u32 s35, s35, 65536
    buffer_load_dwordx4 v[192:195], v25, s[84:87], s35 offen sc1
    s_waitcnt vmcnt(19)
    v_mfma_f32_32x32x16_bf16 v[120:135], v[208:211], a[208:211], v[120:135]
    s_add_u32 s35, s35, 65536
    buffer_load_dwordx4 v[196:199], v25, s[84:87], s35 offen sc1
    v_mfma_f32_32x32x16_bf16 v[136:151], v[208:211], a[212:215], v[136:151]
    v_add_u32 v10, 1310720, v25
    buffer_load_dwordx4 v[248:251], v10, s[84:87], 0 offen sc1
    s_waitcnt vmcnt(20)
    v_mfma_f32_32x32x16_bf16 v[120:135], v[212:215], a[216:219], v[120:135]
    v_add_u32 v9, 1376256, v25
    buffer_load_dwordx4 v[252:255], v9, s[84:87], 0 offen sc1
    v_mfma_f32_32x32x16_bf16 v[136:151], v[212:215], a[220:223], v[136:151]
    s_waitcnt vmcnt(20)
    v_mfma_f32_32x32x16_bf16 v[120:135], v[216:219], a[224:227], v[120:135]
    buffer_load_dwordx4 a[112:115], v5, s[48:51], s70 offen offset:1024 sc1
    v_mfma_f32_32x32x16_bf16 v[136:151], v[216:219], a[228:231], v[136:151]
    s_waitcnt vmcnt(20)
    v_mfma_f32_32x32x16_bf16 v[120:135], v[220:223], a[232:235], v[120:135]
    buffer_load_dwordx4 a[116:119], v6, s[52:55], s70 offen offset:1024 sc1
    v_mfma_f32_32x32x16_bf16 v[136:151], v[220:223], a[236:239], v[136:151]
    s_waitcnt vmcnt(20)
    v_mfma_f32_32x32x16_bf16 v[120:135], v[224:227], a[240:243], v[120:135]
    buffer_load_dwordx4 a[120:123], v5, s[44:47], s70 offen offset:2048 sc1
    v_mfma_f32_32x32x16_bf16 v[136:151], v[224:227], a[244:247], v[136:151]
    s_waitcnt vmcnt(19)
    v_mfma_f32_32x32x16_bf16 v[120:135], v[228:231], a[248:251], v[120:135]
    buffer_load_dwordx4 a[124:127], v5, s[48:51], s70 offen offset:2048 sc1
    v_mfma_f32_32x32x16_bf16 v[136:151], v[228:231], a[252:255], v[136:151]
    s_waitcnt vmcnt(19)
    v_mfma_f32_32x32x16_bf16 v[120:135], v[232:235], a[0:3], v[120:135]
    buffer_load_dwordx4 a[128:131], v6, s[52:55], s70 offen offset:2048 sc1
    v_mfma_f32_32x32x16_bf16 v[136:151], v[232:235], a[4:7], v[136:151]
    s_waitcnt vmcnt(19)
    v_mfma_f32_32x32x16_bf16 v[120:135], v[236:239], a[8:11], v[120:135]
    buffer_load_dwordx4 a[132:135], v5, s[44:47], s70 offen offset:3072 sc1
    v_mfma_f32_32x32x16_bf16 v[136:151], v[236:239], a[12:15], v[136:151]
    s_waitcnt vmcnt(19)
    v_mfma_f32_32x32x16_bf16 v[120:135], v[240:243], a[16:19], v[120:135]
    buffer_load_dwordx4 a[136:139], v5, s[48:51], s70 offen offset:3072 sc1
    v_mfma_f32_32x32x16_bf16 v[136:151], v[240:243], a[20:23], v[136:151]
    s_waitcnt vmcnt(14)
    s_barrier
    buffer_atomic_add v4, v33, s[40:43], s79 offen
    v_mfma_f32_32x32x16_bf16 v[120:135], v[244:247], a[24:27], v[120:135]
    buffer_load_dwordx4 a[140:143], v6, s[52:55], s70 offen offset:3072 sc1
    v_mfma_f32_32x32x16_bf16 v[136:151], v[244:247], a[28:31], v[136:151]
    v_mfma_f32_32x32x16_bf16 v[120:135], v[168:171], a[32:35], v[120:135]
    buffer_load_dwordx4 a[144:147], v5, s[44:47], s71 offen offset:0 sc1
    v_mfma_f32_32x32x16_bf16 v[136:151], v[168:171], a[36:39], v[136:151]
    v_mfma_f32_32x32x16_bf16 v[120:135], v[172:175], a[40:43], v[120:135]
    buffer_load_dwordx4 a[148:151], v5, s[48:51], s71 offen offset:0 sc1
    v_mfma_f32_32x32x16_bf16 v[136:151], v[172:175], a[44:47], v[136:151]
    v_mfma_f32_32x32x16_bf16 v[120:135], v[176:179], a[48:51], v[120:135]
    buffer_load_dwordx4 a[152:155], v6, s[52:55], s71 offen offset:0 sc1
    v_mfma_f32_32x32x16_bf16 v[136:151], v[176:179], a[52:55], v[136:151]
    s_waitcnt vmcnt(18)
    v_mfma_f32_32x32x16_bf16 v[120:135], v[180:183], a[56:59], v[120:135]
    buffer_load_dwordx4 a[156:159], v5, s[44:47], s71 offen offset:1024 sc1
    v_mfma_f32_32x32x16_bf16 v[136:151], v[180:183], a[60:63], v[136:151]
    s_waitcnt vmcnt(18)
    v_mfma_f32_32x32x16_bf16 v[120:135], v[184:187], a[64:67], v[120:135]
    buffer_load_dwordx4 a[160:163], v5, s[48:51], s71 offen offset:1024 sc1
    v_mfma_f32_32x32x16_bf16 v[136:151], v[184:187], a[68:71], v[136:151]
    s_getpc_b64 s[38:39]
PF5:
    v_lshlrev_b32 v7, 7, v0
    s_mov_b32 s3, M_END-PF5
    s_min_u32 s3, s3, 12288
    v_min_u32 v7, s3, v7
    global_load_dword v43, v7, s[38:39]
    s_waitcnt vmcnt(19)
    v_mfma_f32_32x32x16_bf16 v[120:135], v[188:191], a[72:75], v[120:135]
    buffer_load_dwordx4 a[164:167], v6, s[52:55], s71 offen offset:1024 sc1
    v_mfma_f32_32x32x16_bf16 v[136:151], v[188:191], a[76:79], v[136:151]
    s_waitcnt vmcnt(19)
    v_mfma_f32_32x32x16_bf16 v[120:135], v[192:195], a[80:83], v[120:135]
    buffer_load_dwordx4 a[168:171], v5, s[44:47], s71 offen offset:2048 sc1
    v_mfma_f32_32x32x16_bf16 v[136:151], v[192:195], a[84:87], v[136:151]
    s_waitcnt vmcnt(19)
    v_mfma_f32_32x32x16_bf16 v[120:135], v[196:199], a[88:91], v[120:135]
    buffer_load_dwordx4 a[172:175], v5, s[48:51], s71 offen offset:2048 sc1
    v_mfma_f32_32x32x16_bf16 v[136:151], v[196:199], a[92:95], v[136:151]
    s_waitcnt vmcnt(19)
    v_mfma_f32_32x32x16_bf16 v[120:135], v[248:251], a[96:99], v[120:135]
    buffer_load_dwordx4 a[176:179], v6, s[52:55], s71 offen offset:2048 sc1
    v_mfma_f32_32x32x16_bf16 v[136:151], v[248:251], a[100:103], v[136:151]
    s_waitcnt vmcnt(19)
    v_mfma_f32_32x32x16_bf16 v[120:135], v[252:255], a[104:107], v[120:135]
    buffer_load_dwordx4 a[180:183], v5, s[44:47], s71 offen offset:3072 sc1
    v_mfma_f32_32x32x16_bf16 v[136:151], v[252:255], a[108:111], v[136:151]
    s_add_u32 s8, s4, 25296896
    s_addc_u32 s9, s5, 0
    s_mov_b32 s10, 16384
    s_mov_b32 s11, 0x20000
    v_xor_b32 v201, 8192, v27
    v_xor_b32 v202, 16384, v27
    v_xor_b32 v203, 24576, v27
    s_nop 4
    ds_write_b128 v201, v[136:139] offset:2048
    ds_write_b128 v201, v[140:143] offset:3072
    ds_write_b128 v202, v[128:131] offset:4096
    ds_write_b128 v202, v[132:135] offset:5120
    ds_write_b128 v203, v[144:147] offset:6144
    ds_write_b128 v203, v[148:151] offset:7168
    v_lshlrev_b32 v224, 16, v112
    v_and_b32 v225, 0xffff0000, v112
    v_lshlrev_b32 v226, 16, v113
    v_and_b32 v227, 0xffff0000, v113
    v_lshlrev_b32 v228, 16, v114
    v_and_b32 v229, 0xffff0000, v114
    v_lshlrev_b32 v230, 16, v115
    v_and_b32 v231, 0xffff0000, v115
    v_pk_add_f32 v[120:121], v[120:121], v[224:225]
    v_pk_add_f32 v[122:123], v[122:123], v[226:227]
    v_pk_add_f32 v[124:125], v[124:125], v[228:229]
    v_pk_add_f32 v[126:127], v[126:127], v[230:231]
    s_waitcnt lgkmcnt(0)
    s_barrier
    ds_read_b128 v[200:203], v27 offset:2048
    ds_read_b128 v[204:207], v27 offset:3072
    ds_read_b128 v[208:211], v27 offset:4096
    ds_read_b128 v[212:215], v27 offset:5120
    ds_read_b128 v[216:219], v27 offset:6144
    ds_read_b128 v[220:223], v27 offset:7168
    buffer_load_dword v43, v32, s[40:43], s79 offen sc1
    s_waitcnt lgkmcnt(4)
    v_pk_add_f32 v[120:121], v[120:121], v[200:201]
    v_pk_add_f32 v[122:123], v[122:123], v[202:203]
    v_pk_add_f32 v[124:125], v[124:125], v[204:205]
    v_pk_add_f32 v[126:127], v[126:127], v[206:207]
    s_waitcnt lgkmcnt(0)
    v_pk_add_f32 v[208:209], v[208:209], v[216:217]
    v_pk_add_f32 v[210:211], v[210:211], v[218:219]
    v_pk_add_f32 v[212:213], v[212:213], v[220:221]
    v_pk_add_f32 v[214:215], v[214:215], v[222:223]
    v_pk_add_f32 v[120:121], v[120:121], v[208:209]
    v_pk_add_f32 v[122:123], v[122:123], v[210:211]
    v_pk_add_f32 v[124:125], v[124:125], v[212:213]
    v_pk_add_f32 v[126:127], v[126:127], v[214:215]
    v_cvt_pk_bf16_f32 v112, v120, v121
    v_cvt_pk_bf16_f32 v113, v122, v123
    v_cvt_pk_bf16_f32 v114, v124, v125
    v_cvt_pk_bf16_f32 v115, v126, v127
    s_nop 0
    v_permlane32_swap_b32 v112, v114
    v_permlane32_swap_b32 v113, v115
    ds_write_b128 v28, v[112:115] offset:0
    ds_read_b64_tr_b16 v[208:209], v29 offset:0
    ds_read_b64_tr_b16 v[210:211], v29 offset:192
    buffer_store_dwordx4 v[112:115], v34, s[88:91], 0 offen sc1
    v_mov_b32 v212, 0
    v_mov_b32 v213, 0
    v_mov_b32 v214, 0x3f803f80
    s_waitcnt lgkmcnt(0)
    v_dot2c_f32_bf16 v212, v208, v214
    v_dot2c_f32_bf16 v213, v208, v208
    v_dot2c_f32_bf16 v212, v209, v214
    v_dot2c_f32_bf16 v213, v209, v209
    v_dot2c_f32_bf16 v212, v210, v214
    v_dot2c_f32_bf16 v213, v210, v210
    v_dot2c_f32_bf16 v212, v211, v214
    v_dot2c_f32_bf16 v213, v211, v211
    s_nop 2
    v_permlane32_swap_b32 v212, v213
    v_add_f32 v212, v212, v213
    v_mov_b32 v213, v212
    s_nop 1
    v_permlane16_swap_b32 v212, v213
    v_add_f32 v212, v212, v213
    buffer_atomic_add_f32 v212, v30, s[8:11], 0 offen
    v_bfe_u32 v7, v0, 6, 1
    v_mul_u32_u24 v7, 4608, v7
    v_lshrrev_b32 v8, 1, v5
    v_add3_u32 v7, v7, v8, s30
    v_mov_b32 v8, 0
    ds_write2_b32 v7, v8, v8 offset0:0 offset1:1
    s_lshl_b32 s33, s23, 6
    s_add_u32 s33, s33, 4194304
    s_add_u32 s8, s4, 25296896
    s_addc_u32 s9, s5, 0
    s_mov_b32 s10, 16384
    s_mov_b32 s11, 0x20000
    s_add_u32 s12, s4, s33
    s_addc_u32 s13, s5, 0
    s_mov_b32 s14, 2080832
    s_mov_b32 s15, 0x20000
    s_lshl_b32 s33, s23, 8
    s_add_u32 s33, s33, 6291456
    s_add_u32 s16, s4, s33
    s_addc_u32 s17, s5, 0
    s_mov_b32 s18, 2031872
    s_mov_b32 s19, 0x20000
    s_cmp_lg_u32 s20, 0
    s_cbranch_scc1 PC_D6
    s_waitcnt vmcnt(2)
    s_mov_b32 s33, 0x40000
PC_L6:
    v_cmp_ne_u32 vcc, 16, v43
    s_cmp_eq_u64 vcc, 0
    s_cbranch_scc1 PC_D6
    s_sub_u32 s33, s33, 1
    s_cbranch_scc1 PC_D6
    s_sleep 1
    buffer_load_dword v43, v32, s[40:43], s79 offen sc1
    s_waitcnt vmcnt(0)
    s_branch PC_L6
PC_D6:
    s_waitcnt lgkmcnt(0)
    s_barrier
    s_mov_b32 s35, s98
    buffer_load_dwordx4 v[200:203], v25, s[84:87], s35 offen sc1
    s_add_u32 s35, s35, 65536
    buffer_load_dwordx4 v[204:207], v25, s[84:87], s35 offen sc1
    s_add_u32 s35, s35, 65536
    buffer_load_dwordx4 v[208:211], v25, s[84:87], s35 offen sc1
    s_add_u32 s35, s35, 65536
    buffer_load_dwordx4 v[212:215], v25, s[84:87], s35 offen sc1
    s_add_u32 s35, s35, 65536
    buffer_load_dwordx4 v[216:219], v25, s[84:87], s35 offen sc1
    s_add_u32 s35, s35, 65536
    buffer_load_dwordx4 v[220:223], v25, s[84:87], s35 offen sc1
    s_add_u32 s35, s35, 65536
    buffer_load_dwordx4 v[224:227], v25, s[84:87], s35 offen sc1
    s_add_u32 s35, s35, 65536
    buffer_load_dwordx4 v[228:231], v25, s[84:87], s35 offen sc1
    s_add_u32 s35, s35, 65536
    buffer_load_dwordx4 v[232:235], v25, s[84:87], s35 offen sc1
    s_add_u32 s35, s35, 65536
    buffer_load_dwordx4 v[236:239], v25, s[84:87], s35 offen sc1
    s_add_u32 s35, s35, 65536
    buffer_load_dwordx4 v[240:243], v25, s[84:87], s35 offen sc1
    s_add_u32 s35, s35, 65536
    buffer_load_dwordx4 v[244:247], v25, s[84:87], s35 offen sc1
    s_add_u32 s35, s35, 65536
    s_waitcnt vmcnt(11)
    v_mfma_f32_32x32x16_bf16 v[44:59], v[200:203], a[192:195], 0
    buffer_load_dwordx4 v[168:171], v25, s[84:87], s35 offen sc1
    s_add_u32 s35, s35, 65536
    v_mfma_f32_32x32x16_bf16 v[60:75], v[200:203], a[196:199], 0
    buffer_load_dwordx4 v[172:175], v25, s[84:87], s35 offen sc1
    s_add_u32 s35, s35, 65536
    s_barrier
    s_mov_b32 s3, 69632
    buffer_atomic_add v4, v2, s[40:43], s3 offen
    s_waitcnt vmcnt(13)
    v_mfma_f32_32x32x16_bf16 v[44:59], v[204:207], a[200:203], v[44:59]
    buffer_load_dwordx4 v[176:179], v25, s[84:87], s35 offen sc1
    s_add_u32 s35, s35, 65536
    v_mfma_f32_32x32x16_bf16 v[60:75], v[204:207], a[204:207], v[60:75]
    buffer_load_dwordx4 v[180:183], v25, s[84:87], s35 offen sc1
    s_add_u32 s35, s35, 65536
    s_waitcnt vmcnt(14)
    v_mfma_f32_32x32x16_bf16 v[44:59], v[208:211], a[208:211], v[44:59]
    buffer_load_dwordx4 v[184:187], v25, s[84:87], s35 offen sc1
    s_add_u32 s35, s35, 65536
    v_mfma_f32_32x32x16_bf16 v[60:75], v[208:211], a[212:215], v[60:75]
    buffer_load_dwordx4 v[188:191], v25, s[84:87], s35 offen sc1
    s_add_u32 s35, s35, 65536
    s_waitcnt vmcnt(15)
    v_mfma_f32_32x32x16_bf16 v[44:59], v[212:215], a[216:219], v[44:59]
    buffer_load_dwordx4 v[192:195], v25, s[84:87], s35 offen sc1
    s_add_u32 s35, s35, 65536
    v_mfma_f32_32x32x16_bf16 v[60:75], v[212:215], a[220:223], v[60:75]
    buffer_load_dwordx4 v[196:199], v25, s[84:87], s35 offen sc1
    s_waitcnt vmcnt(16)
    v_mfma_f32_32x32x16_bf16 v[44:59], v[216:219], a[224:227], v[44:59]
    buffer_load_dwordx4 v[248:251], v10, s[84:87], s98 offen sc1
    v_mfma_f32_32x32x16_bf16 v[60:75], v[216:219], a[228:231], v[60:75]
    buffer_load_dwordx4 v[252:255], v9, s[84:87], s98 offen sc1
    s_waitcnt vmcnt(17)
    v_mfma_f32_32x32x16_bf16 v[44:59], v[220:223], a[232:235], v[44:59]
    v_mfma_f32_32x32x16_bf16 v[60:75], v[220:223], a[236:239], v[60:75]
    s_waitcnt vmcnt(16)
    v_mfma_f32_32x32x16_bf16 v[44:59], v[224:227], a[240:243], v[44:59]
    v_mfma_f32_32x32x16_bf16 v[60:75], v[224:227], a[244:247], v[60:75]
    s_waitcnt vmcnt(15)
    v_mfma_f32_32x32x16_bf16 v[44:59], v[228:231], a[248:251], v[44:59]
    v_mfma_f32_32x32x16_bf16 v[60:75], v[228:231], a[252:255], v[60:75]
    s_waitcnt vmcnt(14)
    v_mfma_f32_32x32x16_bf16 v[44:59], v[232:235], a[0:3], v[44:59]
    buffer_load_dwordx4 a[184:187], v5, s[48:51], s71 offen offset:3072 sc1
    ds_read_b64 a[192:193], v39 offset:3776
    ds_read_b64 a[194:195], v39 offset:3784
    v_mfma_f32_32x32x16_bf16 v[60:75], v[232:235], a[4:7], v[60:75]
    ds_read_b64 a[196:197], v39 offset:3264
    ds_read_b64 a[198:199], v39 offset:3272
    s_waitcnt vmcnt(14)
    v_mfma_f32_32x32x16_bf16 v[44:59], v[236:239], a[8:11], v[44:59]
    buffer_load_dwordx4 a[188:191], v6, s[52:55], s71 offen offset:3072 sc1
    ds_read_b64 a[200:201], v39 offset:2752
    ds_read_b64 a[202:203], v39 offset:2760
    v_mfma_f32_32x32x16_bf16 v[60:75], v[236:239], a[12:15], v[60:75]
    ds_read_b64 a[204:205], v39 offset:2240
    ds_read_b64 a[206:207], v39 offset:2248
    s_waitcnt vmcnt(14)
    v_mfma_f32_32x32x16_bf16 v[44:59], v[240:243], a[16:19], v[44:59]
    buffer_load_dwordx4 a[0:3], v5, s[44:47], s68 offen offset:0 sc1
    ds_read_b64 a[208:209], v39 offset:3712
    ds_read_b64 a[210:211], v39 offset:3720
    v_mfma_f32_32x32x16_bf16 v[60:75], v[240:243], a[20:23], v[60:75]
    ds_read_b64 a[212:213], v39 offset:3200
    ds_read_b64 a[214:215], v39 offset:3208
    s_waitcnt vmcnt(14)
    v_mfma_f32_32x32x16_bf16 v[44:59], v[244:247], a[24:27], v[44:59]
    buffer_load_dwordx4 a[4:7], v5, s[48:51], s68 offen offset:0 sc1
    ds_read_b64 a[216:217], v39 offset:2688
    ds_read_b64 a[218:219], v39 offset:2696
    v_mfma_f32_32x32x16_bf16 v[60:75], v[244:247], a[28:31], v[60:75]
    ds_read_b64 a[220:221], v39 offset:2176
    ds_read_b64 a[222:223], v39 offset:2184
    s_waitcnt vmcnt(14)
    v_mfma_f32_32x32x16_bf16 v[44:59], v[168:171], a[32:35], v[44:59]
    buffer_load_dwordx4 a[8:11], v6, s[52:55], s68 offen offset:0 sc1
    ds_read_b64 a[224:225], v39 offset:3648
    ds_read_b64 a[226:227], v39 offset:3656
    v_mfma_f32_32x32x16_bf16 v[60:75], v[168:171], a[36:39], v[60:75]
    ds_read_b64 a[228:229], v39 offset:3136
    ds_read_b64 a[230:231], v39 offset:3144
    s_waitcnt vmcnt(14)
    v_mfma_f32_32x32x16_bf16 v[44:59], v[172:175], a[40:43], v[44:59]
    buffer_load_dwordx4 a[12:15], v5, s[44:47], s68 offen offset:1024 sc1
    ds_read_b64 a[232:233], v39 offset:2624
    ds_read_b64 a[234:235], v39 offset:2632
    v_mfma_f32_32x32x16_bf16 v[60:75], v[172:175], a[44:47], v[60:75]
    ds_read_b64 a[236:237], v39 offset:2112
    ds_read_b64 a[238:239], v39 offset:2120
    s_waitcnt vmcnt(13)
    v_mfma_f32_32x32x16_bf16 v[44:59], v[176:179], a[48:51], v[44:59]
    buffer_load_dwordx4 a[16:19], v5, s[48:51], s68 offen offset:1024 sc1
    ds_read_b64 a[240:241], v39 offset:3584
    ds_read_b64 a[242:243], v39 offset:3592
    v_mfma_f32_32x32x16_bf16 v[60:75], v[176:179], a[52:55], v[60:75]
    ds_read_b64 a[244:245], v39 offset:3072
    ds_read_b64 a[246:247], v39 offset:3080
    s_mov_b32 s3, 69632
    buffer_load_dword v43, v3, s[40:43], s3 offen sc1
    s_waitcnt vmcnt(14)
    v_mfma_f32_32x32x16_bf16 v[44:59], v[180:183], a[56:59], v[44:59]
    buffer_load_dwordx4 a[20:23], v6, s[52:55], s68 offen offset:1024 sc1
    ds_read_b64 a[248:249], v39 offset:2560
    ds_read_b64 a[250:251], v39 offset:2568
    v_mfma_f32_32x32x16_bf16 v[60:75], v[180:183], a[60:63], v[60:75]
    ds_read_b64 a[252:253], v39 offset:2048
    ds_read_b64 a[254:255], v39 offset:2056
    s_waitcnt vmcnt(14)
    v_mfma_f32_32x32x16_bf16 v[44:59], v[184:187], a[64:67], v[44:59]
    buffer_load_dwordx4 a[24:27], v5, s[44:47], s68 offen offset:2048 sc1
    v_mfma_f32_32x32x16_bf16 v[60:75], v[184:187], a[68:71], v[60:75]
    s_waitcnt vmcnt(14)
    v_mfma_f32_32x32x16_bf16 v[44:59], v[188:191], a[72:75], v[44:59]
    buffer_load_dwordx4 a[28:31], v5, s[48:51], s68 offen offset:2048 sc1
    v_mfma_f32_32x32x16_bf16 v[60:75], v[188:191], a[76:79], v[60:75]
    s_waitcnt vmcnt(14)
    v_mfma_f32_32x32x16_bf16 v[44:59], v[192:195], a[80:83], v[44:59]
    buffer_load_dwordx4 a[32:35], v6, s[52:55], s68 offen offset:2048 sc1
    v_mfma_f32_32x32x16_bf16 v[60:75], v[192:195], a[84:87], v[60:75]
    s_waitcnt vmcnt(14)
    v_mfma_f32_32x32x16_bf16 v[44:59], v[196:199], a[88:91], v[44:59]
    buffer_load_dwordx4 a[36:39], v5, s[44:47], s68 offen offset:3072 sc1
    v_mfma_f32_32x32x16_bf16 v[60:75], v[196:199], a[92:95], v[60:75]
    s_waitcnt vmcnt(14)
    v_mfma_f32_32x32x16_bf16 v[44:59], v[248:251], a[96:99], v[44:59]
    buffer_load_dwordx4 a[40:43], v5, s[48:51], s68 offen offset:3072 sc1
    v_mfma_f32_32x32x16_bf16 v[60:75], v[248:251], a[100:103], v[60:75]
    s_waitcnt vmcnt(14)
    v_mfma_f32_32x32x16_bf16 v[44:59], v[252:255], a[104:107], v[44:59]
    buffer_load_dwordx4 a[44:47], v6, s[52:55], s68 offen offset:3072 sc1
    v_mfma_f32_32x32x16_bf16 v[60:75], v[252:255], a[108:111], v[60:75]
    v_xor_b32 v201, 8192, v27
    v_xor_b32 v202, 16384, v27
    v_xor_b32 v203, 24576, v27
    s_nop 8
    ds_write_b128 v201, v[60:63] offset:2048
    ds_write_b128 v201, v[64:67] offset:3072
    ds_write_b128 v202, v[52:55] offset:4096
    ds_write_b128 v202, v[56:59] offset:5120
    ds_write_b128 v203, v[68:71] offset:6144
    ds_write_b128 v203, v[72:75] offset:7168
    v_lshlrev_b32 v224, 16, v116
    v_and_b32 v225, 0xffff0000, v116
    v_lshlrev_b32 v226, 16, v117
    v_and_b32 v227, 0xffff0000, v117
    v_lshlrev_b32 v228, 16, v118
    v_and_b32 v229, 0xffff0000, v118
    v_lshlrev_b32 v230, 16, v119
    v_and_b32 v231, 0xffff0000, v119
    v_pk_add_f32 v[44:45], v[44:45], v[224:225]
    v_pk_add_f32 v[46:47], v[46:47], v[226:227]
    v_pk_add_f32 v[48:49], v[48:49], v[228:229]
    v_pk_add_f32 v[50:51], v[50:51], v[230:231]
    s_mov_b32 s3, 69632
    s_cmp_lg_u32 s20, 0
    s_cbranch_scc1 PC_D7
    s_waitcnt vmcnt(7)
    s_mov_b32 s33, 0x40000
PC_L7:
    v_cmp_ne_u32 vcc, 16, v43
    s_cmp_eq_u64 vcc, 0
    s_cbranch_scc1 PC_D7
    s_sub_u32 s33, s33, 1
    s_cbranch_scc1 PC_D7
    s_sleep 1
    buffer_load_dword v43, v3, s[40:43], s3 offen sc1
    s_waitcnt vmcnt(0)
    s_branch PC_L7
PC_D7:
    s_waitcnt lgkmcnt(0)
    s_barrier
    ds_read_b128 v[200:203], v27 offset:2048
    ds_read_b128 v[204:207], v27 offset:3072
    ds_read_b128 v[208:211], v27 offset:4096
    ds_read_b128 v[212:215], v27 offset:5120
    ds_read_b128 v[216:219], v27 offset:6144
    ds_read_b128 v[220:223], v27 offset:7168
    buffer_load_dwordx4 v[84:87], v35, s[8:11], s68 offen sc1
    buffer_load_dwordx4 v[88:91], v35, s[8:11], s70 offen sc1
    buffer_load_dwordx2 v[92:93], v36, s[12:15], 0 offen offset:0 sc1
    buffer_load_dwordx2 v[94:95], v36, s[12:15], 0 offen offset:32 sc1
    buffer_load_dwordx4 a[48:51], v5, s[44:47], s69 offen offset:0 sc1
    buffer_load_dwordx4 a[52:55], v5, s[48:51], s69 offen offset:0 sc1
    buffer_load_dwordx4 a[56:59], v6, s[52:55], s69 offen offset:0 sc1
    buffer_load_dwordx4 a[60:63], v5, s[44:47], s69 offen offset:1024 sc1
    s_waitcnt lgkmcnt(4)
    v_pk_add_f32 v[44:45], v[44:45], v[200:201]
    v_pk_add_f32 v[46:47], v[46:47], v[202:203]
    v_pk_add_f32 v[48:49], v[48:49], v[204:205]
    v_pk_add_f32 v[50:51], v[50:51], v[206:207]
    s_waitcnt lgkmcnt(0)
    v_pk_add_f32 v[208:209], v[208:209], v[216:217]
    v_pk_add_f32 v[210:211], v[210:211], v[218:219]
    v_pk_add_f32 v[212:213], v[212:213], v[220:221]
    v_pk_add_f32 v[214:215], v[214:215], v[222:223]
    v_pk_add_f32 v[44:45], v[44:45], v[208:209]
    v_pk_add_f32 v[46:47], v[46:47], v[210:211]
    v_pk_add_f32 v[48:49], v[48:49], v[212:213]
    v_pk_add_f32 v[50:51], v[50:51], v[214:215]
    v_cvt_pk_bf16_f32 v116, v44, v45
    v_cvt_pk_bf16_f32 v117, v46, v47
    v_cvt_pk_bf16_f32 v118, v48, v49
    v_cvt_pk_bf16_f32 v119, v50, v51
    s_nop 0
    v_permlane32_swap_b32 v116, v118
    v_permlane32_swap_b32 v117, v119
    ds_write_b128 v28, v[116:119] offset:6144
    ds_read_b64_tr_b16 v[208:209], v29 offset:6144
    ds_read_b64_tr_b16 v[210:211], v29 offset:6336
    buffer_store_dwordx4 v[116:119], v34, s[88:91], s97 offen sc1
    v_mov_b32 v212, 0
    v_mov_b32 v213, 0
    v_mov_b32 v214, 0x3f803f80
    s_waitcnt lgkmcnt(0)
    v_dot2c_f32_bf16 v212, v208, v214
    v_dot2c_f32_bf16 v213, v208, v208
    v_dot2c_f32_bf16 v212, v209, v214
    v_dot2c_f32_bf16 v213, v209, v209
    v_dot2c_f32_bf16 v212, v210, v214
    v_dot2c_f32_bf16 v213, v210, v210
    v_dot2c_f32_bf16 v212, v211, v214
    v_dot2c_f32_bf16 v213, v211, v211
    s_nop 2
    v_permlane32_swap_b32 v212, v213
    v_add_f32 v212, v212, v213
    v_mov_b32 v213, v212
    s_nop 1
    v_permlane16_swap_b32 v212, v213
    v_add_f32 v212, v212, v213
    buffer_atomic_add_f32 v212, v30, s[8:11], s69 offen
    s_add_u32 s56, s4, 6291456
    s_addc_u32 s57, s5, 0
    s_mov_b32 s58, 2097152
    s_mov_b32 s59, 0x20000
    s_lshl_b32 s33, s24, 15
    s_add_u32 s33, s33, 27262976
    s_add_u32 s92, s4, s33
    s_addc_u32 s93, s5, 0
    s_mov_b32 s94, 65536
    s_mov_b32 s95, 0x20000
    s_add_u32 s84, s4, 27262976
    s_addc_u32 s85, s5, 0
    s_mov_b32 s86, 5636096
    s_mov_b32 s87, 0x20000
    s_lshl_b32 s78, s21, 8
    s_add_u32 s78, s78, 200704
    s_add_u32 s79, s78, 128
    s_mov_b32 s88, s6
    s_mov_b32 s89, s7
    v_mov_b32 v68, 0x3727c5ac
    s_waitcnt vmcnt(8)
    v_pk_mul_f32 v[84:85], v[84:85], s[76:77]
    v_pk_fma_f32 v[88:89], v[88:89], s[76:77], v[68:69] op_sel_hi:[1,1,0]
    v_pk_mul_f32 v[86:87], v[86:87], s[76:77]
    v_pk_fma_f32 v[90:91], v[90:91], s[76:77], v[68:69] op_sel_hi:[1,1,0]
    v_pk_fma_f32 v[88:89], v[84:85], v[84:85], v[88:89] neg_lo:[1,0,0] neg_hi:[1,0,0]
    v_pk_fma_f32 v[90:91], v[86:87], v[86:87], v[90:91] neg_lo:[1,0,0] neg_hi:[1,0,0]
    v_max_f32 v88, v68, v88
    v_max_f32 v89, v68, v89
    v_max_f32 v90, v68, v90
    v_max_f32 v91, v68, v91
    v_rsq_f32 v96, v88
    v_rsq_f32 v97, v89
    v_rsq_f32 v98, v90
    v_rsq_f32 v99, v91
    buffer_load_dwordx4 a[64:67], v5, s[48:51], s69 offen offset:1024 sc1
    s_waitcnt vmcnt(7)
    v_lshlrev_b32 v44, 16, v92
    v_and_b32 v45, 0xffff0000, v92
    v_lshlrev_b32 v46, 16, v93
    v_and_b32 v47, 0xffff0000, v93
    v_lshlrev_b32 v48, 16, v94
    v_and_b32 v49, 0xffff0000, v94
    v_lshlrev_b32 v50, 16, v95
    v_and_b32 v51, 0xffff0000, v95
    v_pk_mul_f32 v[80:81], v[84:85], v[96:97] neg_lo:[1,0] neg_hi:[1,0]
    v_pk_mul_f32 v[82:83], v[86:87], v[98:99] neg_lo:[1,0] neg_hi:[1,0]
    v_pk_fma_f32 v[60:61], v[44:45], v[96:97], v[80:81]
    v_pk_fma_f32 v[62:63], v[46:47], v[98:99], v[82:83]
    v_cvt_pk_bf16_f32 v76, v60, v61
    v_cvt_pk_bf16_f32 v77, v62, v63
    ds_write_b64 v37, v[76:77] offset:33792
    v_pk_fma_f32 v[64:65], v[48:49], v[96:97], v[80:81]
    v_pk_fma_f32 v[66:67], v[50:51], v[98:99], v[82:83]
    v_cvt_pk_bf16_f32 v78, v64, v65
    v_cvt_pk_bf16_f32 v79, v66, v67
    ds_write_b64 v37, v[78:79] offset:38400
    buffer_load_dwordx4 a[68:71], v6, s[52:55], s69 offen offset:1024 sc1
    v_pk_fma_f32 v[44:45], v[60:61], s[28:29], v[44:45] op_sel:[0,0,0] op_sel_hi:[1,0,1]
    v_pk_fma_f32 v[46:47], v[62:63], s[28:29], v[46:47] op_sel:[0,0,0] op_sel_hi:[1,0,1]
    v_pk_fma_f32 v[48:49], v[64:65], s[28:29], v[48:49] op_sel:[0,1,0] op_sel_hi:[1,1,1]
    v_pk_fma_f32 v[50:51], v[66:67], s[28:29], v[50:51] op_sel:[0,1,0] op_sel_hi:[1,1,1]
    s_waitcnt vmcnt(2)
    s_waitcnt lgkmcnt(0)
    s_barrier
    s_mov_b32 s3, 102400
    buffer_atomic_add v4, v2, s[40:43], s3 offen
    ds_read_b128 v[152:155], v40 offset:192
    ds_read_b128 v[156:159], v40 offset:704
    ds_read_b128 v[160:163], v40 offset:1216
    ds_read_b128 v[164:167], v40 offset:1728
    ds_read_b128 v[168:171], v40 offset:128
    ds_read_b128 v[172:175], v40 offset:640
    ds_read_b128 v[176:179], v40 offset:1152
    ds_read_b128 v[180:183], v40 offset:1664
    buffer_load_dwordx4 a[72:75], v5, s[44:47], s69 offen offset:2048 sc1
    buffer_load_dwordx4 a[76:79], v5, s[48:51], s69 offen offset:2048 sc1
    s_waitcnt lgkmcnt(7)
    v_mfma_f32_16x16x32_bf16 v[120:123], a[192:195], v[152:155], 0
    ds_read_b128 v[184:187], v40 offset:64
    ds_read_b128 v[188:191], v40 offset:576
    v_mfma_f32_16x16x32_bf16 v[124:127], a[196:199], v[152:155], 0
    ds_read_b128 v[192:195], v40 offset:1088
    ds_read_b128 v[196:199], v40 offset:1600
    v_mfma_f32_16x16x32_bf16 v[128:131], a[200:203], v[152:155], 0
    ds_read_b128 v[200:203], v40 offset:0
    ds_read_b128 v[204:207], v40 offset:512
    v_mfma_f32_16x16x32_bf16 v[132:135], a[204:207], v[152:155], 0
    ds_read_b128 v[208:211], v40 offset:1024
    ds_read_b128 v[212:215], v40 offset:1536
    s_waitcnt lgkmcnt(14)
    v_mfma_f32_16x16x32_bf16 v[124:127], a[192:195], v[156:159], v[124:127]
    ds_read_b64 v[216:217], v39 offset:1728
    ds_read_b64 v[218:219], v39 offset:1736
    v_mfma_f32_16x16x32_bf16 v[128:131], a[196:199], v[156:159], v[128:131]
    buffer_load_dwordx4 a[80:83], v6, s[52:55], s69 offen offset:2048 sc1
    v_mfma_f32_16x16x32_bf16 v[132:135], a[200:203], v[156:159], v[132:135]
    ds_read_b64 v[220:221], v39 offset:1216
    ds_read_b64 v[222:223], v39 offset:1224
    s_waitcnt lgkmcnt(14)
    v_mfma_f32_16x16x32_bf16 v[128:131], a[192:195], v[160:163], v[128:131]
    ds_read_b64 v[224:225], v39 offset:704
    ds_read_b64 v[226:227], v39 offset:712
    v_mfma_f32_16x16x32_bf16 v[132:135], a[196:199], v[160:163], v[132:135]
    ds_read_b64 v[228:229], v39 offset:192
    ds_read_b64 v[230:231], v39 offset:200
    v_mfma_f32_16x16x32_bf16 v[132:135], a[192:195], v[164:167], v[132:135]
    v_mfma_f32_16x16x32_bf16 v[120:123], a[208:211], v[168:171], v[120:123]
    v_mfma_f32_16x16x32_bf16 v[124:127], a[212:215], v[168:171], v[124:127]
    buffer_load_dwordx4 a[84:87], v5, s[44:47], s69 offen offset:3072 sc1
    v_mfma_f32_16x16x32_bf16 v[128:131], a[216:219], v[168:171], v[128:131]
    v_mfma_f32_16x16x32_bf16 v[132:135], a[220:223], v[168:171], v[132:135]
    v_mfma_f32_16x16x32_bf16 v[124:127], a[208:211], v[172:175], v[124:127]
    v_mfma_f32_16x16x32_bf16 v[128:131], a[212:215], v[172:175], v[128:131]
    v_mfma_f32_16x16x32_bf16 v[132:135], a[216:219], v[172:175], v[132:135]
    s_waitcnt lgkmcnt(14)
    v_mfma_f32_16x16x32_bf16 v[128:131], a[208:211], v[176:179], v[128:131]
    buffer_load_dwordx4 a[88:91], v5, s[48:51], s69 offen offset:3072 sc1
    v_mfma_f32_16x16x32_bf16 v[132:135], a[212:215], v[176:179], v[132:135]
    v_mfma_f32_16x16x32_bf16 v[132:135], a[208:211], v[180:183], v[132:135]
    v_mfma_f32_16x16x32_bf16 v[120:123], a[224:227], v[184:187], v[120:123]
    v_mfma_f32_16x16x32_bf16 v[124:127], a[228:231], v[184:187], v[124:127]
    v_mfma_f32_16x16x32_bf16 v[128:131], a[232:235], v[184:187], v[128:131]
    v_mfma_f32_16x16x32_bf16 v[132:135], a[236:239], v[184:187], v[132:135]
    buffer_load_dwordx4 a[92:95], v6, s[52:55], s69 offen offset:3072 sc1
    v_mfma_f32_16x16x32_bf16 v[124:127], a[224:227], v[188:191], v[124:127]
    v_mfma_f32_16x16x32_bf16 v[128:131], a[228:231], v[188:191], v[128:131]
    v_mfma_f32_16x16x32_bf16 v[132:135], a[232:235], v[188:191], v[132:135]
    s_waitcnt lgkmcnt(13)
    v_mfma_f32_16x16x32_bf16 v[128:131], a[224:227], v[192:195], v[128:131]
    v_mfma_f32_16x16x32_bf16 v[132:135], a[228:231], v[192:195], v[132:135]
    s_waitcnt lgkmcnt(12)
    v_mfma_f32_16x16x32_bf16 v[132:135], a[224:227], v[196:199], v[132:135]
    buffer_load_dwordx4 a[96:99], v5, s[44:47], s70 offen offset:0 sc1
    s_waitcnt lgkmcnt(11)
    v_mfma_f32_16x16x32_bf16 v[120:123], a[240:243], v[200:203], v[120:123]
    v_mfma_f32_16x16x32_bf16 v[124:127], a[244:247], v[200:203], v[124:127]
    v_mfma_f32_16x16x32_bf16 v[128:131], a[248:251], v[200:203], v[128:131]
    v_mfma_f32_16x16x32_bf16 v[132:135], a[252:255], v[200:203], v[132:135]
    s_waitcnt lgkmcnt(10)
    v_mfma_f32_16x16x32_bf16 v[124:127], a[240:243], v[204:207], v[124:127]
    v_mfma_f32_16x16x32_bf16 v[128:131], a[244:247], v[204:207], v[128:131]
    buffer_load_dwordx4 a[100:103], v5, s[48:51], s70 offen offset:0 sc1
    v_mfma_f32_16x16x32_bf16 v[132:135], a[248:251], v[204:207], v[132:135]
    s_waitcnt lgkmcnt(9)
    v_mfma_f32_16x16x32_bf16 v[128:131], a[240:243], v[208:211], v[128:131]
    v_mfma_f32_16x16x32_bf16 v[132:135], a[244:247], v[208:211], v[132:135]
    s_waitcnt lgkmcnt(8)
    v_mfma_f32_16x16x32_bf16 v[132:135], a[240:243], v[212:215], v[132:135]
    v_mfma_f32_16x16x32_bf16 v[136:139], a[196:199], v[164:167], 0
    v_mfma_f32_16x16x32_bf16 v[136:139], a[200:203], v[160:163], v[136:139]
    buffer_load_dwordx4 a[104:107], v6, s[52:55], s70 offen offset:0 sc1
    ds_write_b128 v41, v[120:123] offset:42496
    ds_write_b128 v41, v[124:127] offset:43776
    ds_write_b128 v41, v[128:131] offset:45056
    s_nop 1
    ds_write_b128 v41, v[132:135] offset:46336
    v_mfma_f32_16x16x32_bf16 v[140:143], a[200:203], v[164:167], 0
    v_mfma_f32_16x16x32_bf16 v[136:139], a[204:207], v[156:159], v[136:139]
    v_mfma_f32_16x16x32_bf16 v[140:143], a[204:207], v[160:163], v[140:143]
    v_mfma_f32_16x16x32_bf16 v[144:147], a[204:207], v[164:167], 0
    s_waitcnt lgkmcnt(0)
    s_barrier
    ds_read_b128 v[104:107], v42 offset:42496
    ds_read_b128 v[108:111], v42 offset:47616
    ds_read_b128 v[112:115], v42 offset:52736
    ds_read_b128 v[116:119], v42 offset:57856
    v_mfma_f32_16x16x32_bf16 v[136:139], a[212:215], v[180:183], v[136:139]
    v_mfma_f32_16x16x32_bf16 v[136:139], a[216:219], v[176:179], v[136:139]
    buffer_load_dwordx4 a[108:111], v5, s[44:47], s70 offen offset:1024 sc1
    v_mfma_f32_16x16x32_bf16 v[140:143], a[216:219], v[180:183], v[140:143]
    v_mfma_f32_16x16x32_bf16 v[136:139], a[220:223], v[172:175], v[136:139]
    s_waitcnt lgkmcnt(2)
    v_pk_add_f32 v[104:105], v[104:105], v[108:109]
    v_pk_add_f32 v[106:107], v[106:107], v[110:111]
    v_pk_add_f32 v[104:105], v[104:105], v[44:45]
    v_pk_add_f32 v[106:107], v[106:107], v[46:47]
    v_cvt_pk_bf16_f32 v108, v104, v105
    v_cvt_pk_bf16_f32 v109, v106, v107
    buffer_store_dwordx2 v[108:109], v38, s[16:19], 0 offen offset:0 sc1
    s_waitcnt lgkmcnt(0)
    v_pk_add_f32 v[112:113], v[112:113], v[116:117]
    v_pk_add_f32 v[114:115], v[114:115], v[118:119]
    v_pk_add_f32 v[112:113], v[112:113], v[48:49]
    v_pk_add_f32 v[114:115], v[114:115], v[50:51]
    v_cvt_pk_bf16_f32 v116, v112, v113
    v_cvt_pk_bf16_f32 v117, v114, v115
    buffer_store_dwordx2 v[116:117], v38, s[16:19], 0 offen offset:128 sc1
    v_mfma_f32_16x16x32_bf16 v[140:143], a[220:223], v[176:179], v[140:143]
    v_mfma_f32_16x16x32_bf16 v[144:147], a[220:223], v[180:183], v[144:147]
    v_mfma_f32_16x16x32_bf16 v[136:139], a[228:231], v[196:199], v[136:139]
    s_mov_b32 s3, 102400
    buffer_load_dword v43, v3, s[40:43], s3 offen sc1
    v_mfma_f32_16x16x32_bf16 v[136:139], a[232:235], v[192:195], v[136:139]
    v_mfma_f32_16x16x32_bf16 v[140:143], a[232:235], v[196:199], v[140:143]
    ds_read_b64 v[232:233], v39 offset:1664
    ds_read_b64 v[234:235], v39 offset:1672
    v_mfma_f32_16x16x32_bf16 v[136:139], a[236:239], v[188:191], v[136:139]
    ds_read_b64 v[236:237], v39 offset:1152
    ds_read_b64 v[238:239], v39 offset:1160
    v_mfma_f32_16x16x32_bf16 v[140:143], a[236:239], v[192:195], v[140:143]
    ds_read_b64 v[240:241], v39 offset:640
    ds_read_b64 v[242:243], v39 offset:648
    v_mfma_f32_16x16x32_bf16 v[144:147], a[236:239], v[196:199], v[144:147]
    ds_read_b64 v[244:245], v39 offset:128
    ds_read_b64 v[246:247], v39 offset:136
    v_mfma_f32_16x16x32_bf16 v[136:139], a[244:247], v[212:215], v[136:139]
    v_mfma_f32_16x16x32_bf16 v[136:139], a[248:251], v[208:211], v[136:139]
    v_mfma_f32_16x16x32_bf16 v[140:143], a[248:251], v[212:215], v[140:143]
    v_mfma_f32_16x16x32_bf16 v[136:139], a[252:255], v[204:207], v[136:139]
    v_mfma_f32_16x16x32_bf16 v[140:143], a[252:255], v[208:211], v[140:143]
    v_mfma_f32_16x16x32_bf16 v[144:147], a[252:255], v[212:215], v[144:147]
    v_mfma_f32_16x16x32_bf16 v[136:139], v[216:219], v[152:155], v[136:139]
    v_mfma_f32_16x16x32_bf16 v[140:143], v[216:219], v[156:159], v[140:143]
    v_mfma_f32_16x16x32_bf16 v[144:147], v[216:219], v[160:163], v[144:147]
    v_mfma_f32_16x16x32_bf16 v[148:151], v[216:219], v[164:167], 0
    v_mfma_f32_16x16x32_bf16 v[140:143], v[220:223], v[152:155], v[140:143]
    v_mfma_f32_16x16x32_bf16 v[144:147], v[220:223], v[156:159], v[144:147]
    v_mfma_f32_16x16x32_bf16 v[148:151], v[220:223], v[160:163], v[148:151]
    v_mfma_f32_16x16x32_bf16 v[144:147], v[224:227], v[152:155], v[144:147]
    s_waitcnt vmcnt(1)
    s_barrier
    s_mov_b32 s3, 135168
    buffer_atomic_add v4, v2, s[40:43], s3 offen
    v_mfma_f32_16x16x32_bf16 v[148:151], v[224:227], v[156:159], v[148:151]
    v_mfma_f32_16x16x32_bf16 v[148:151], v[228:231], v[152:155], v[148:151]
    s_waitcnt lgkmcnt(6)
    v_mfma_f32_16x16x32_bf16 v[136:139], v[232:235], v[168:171], v[136:139]
    ds_read_b64 v[216:217], v39 offset:1600
    ds_read_b64 v[218:219], v39 offset:1608
    v_mfma_f32_16x16x32_bf16 v[140:143], v[232:235], v[172:175], v[140:143]
    ds_read_b64 v[220:221], v39 offset:1088
    ds_read_b64 v[222:223], v39 offset:1096
    v_mfma_f32_16x16x32_bf16 v[144:147], v[232:235], v[176:179], v[144:147]
    ds_read_b64 v[224:225], v39 offset:576
    ds_read_b64 v[226:227], v39 offset:584
    v_mfma_f32_16x16x32_bf16 v[148:151], v[232:235], v[180:183], v[148:151]
    ds_read_b64 v[228:229], v39 offset:64
    ds_read_b64 v[230:231], v39 offset:72
    s_mov_b32 s3, 102400
    s_cmp_lg_u32 s20, 0
    s_cbranch_scc1 PC_D8
    s_waitcnt vmcnt(1)
    s_mov_b32 s33, 0x40000
PC_L8:
    v_cmp_ne_u32 vcc, 16, v43
    s_cmp_eq_u64 vcc, 0
    s_cbranch_scc1 PC_D8
    s_sub_u32 s33, s33, 1
    s_cbranch_scc1 PC_D8
    s_sleep 1
    buffer_load_dword v43, v3, s[40:43], s3 offen sc1
    s_waitcnt vmcnt(0)
    s_branch PC_L8
PC_D8:
    s_barrier
    buffer_load_dwordx4 v[84:87], v35, s[8:11], s69 offen sc1
    buffer_load_dwordx4 v[88:91], v35, s[8:11], s71 offen sc1
    buffer_load_dwordx2 v[92:93], v36, s[12:15], s97 offen offset:0 sc1
    buffer_load_dwordx2 v[94:95], v36, s[12:15], s97 offen offset:32 sc1
    s_waitcnt lgkmcnt(12)
    v_mfma_f32_16x16x32_bf16 v[140:143], v[236:239], v[168:171], v[140:143]
    v_mfma_f32_16x16x32_bf16 v[144:147], v[236:239], v[172:175], v[144:147]
    v_mfma_f32_16x16x32_bf16 v[148:151], v[236:239], v[176:179], v[148:151]
    s_waitcnt lgkmcnt(10)
    v_mfma_f32_16x16x32_bf16 v[144:147], v[240:243], v[168:171], v[144:147]
    v_mfma_f32_16x16x32_bf16 v[148:151], v[240:243], v[172:175], v[148:151]
    s_waitcnt lgkmcnt(8)
    v_mfma_f32_16x16x32_bf16 v[148:151], v[244:247], v[168:171], v[148:151]
    s_waitcnt lgkmcnt(6)
    v_mfma_f32_16x16x32_bf16 v[136:139], v[216:219], v[184:187], v[136:139]
    ds_read_b64 v[232:233], v39 offset:1536
    ds_read_b64 v[234:235], v39 offset:1544
    v_mfma_f32_16x16x32_bf16 v[140:143], v[216:219], v[188:191], v[140:143]
    ds_read_b64 v[236:237], v39 offset:1024
    ds_read_b64 v[238:239], v39 offset:1032
    v_mfma_f32_16x16x32_bf16 v[144:147], v[216:219], v[192:195], v[144:147]
    ds_read_b64 v[240:241], v39 offset:512
    ds_read_b64 v[242:243], v39 offset:520
    v_mfma_f32_16x16x32_bf16 v[148:151], v[216:219], v[196:199], v[148:151]
    ds_read_b64 v[244:245], v39 offset:0
    ds_read_b64 v[246:247], v39 offset:8
    s_waitcnt lgkmcnt(12)
    v_mfma_f32_16x16x32_bf16 v[140:143], v[220:223], v[184:187], v[140:143]
    v_mfma_f32_16x16x32_bf16 v[144:147], v[220:223], v[188:191], v[144:147]
    v_mfma_f32_16x16x32_bf16 v[148:151], v[220:223], v[192:195], v[148:151]
    s_waitcnt lgkmcnt(10)
    v_mfma_f32_16x16x32_bf16 v[144:147], v[224:227], v[184:187], v[144:147]
    v_mfma_f32_16x16x32_bf16 v[148:151], v[224:227], v[188:191], v[148:151]
    s_waitcnt lgkmcnt(8)
    v_mfma_f32_16x16x32_bf16 v[148:151], v[228:231], v[184:187], v[148:151]
    s_waitcnt lgkmcnt(0)
    s_waitcnt vmcnt(2)
    v_pk_mul_f32 v[84:85], v[84:85], s[76:77]
    v_pk_fma_f32 v[88:89], v[88:89], s[76:77], v[68:69] op_sel_hi:[1,1,0]
    v_pk_mul_f32 v[86:87], v[86:87], s[76:77]
    v_pk_fma_f32 v[90:91], v[90:91], s[76:77], v[68:69] op_sel_hi:[1,1,0]
    v_pk_fma_f32 v[88:89], v[84:85], v[84:85], v[88:89] neg_lo:[1,0,0] neg_hi:[1,0,0]
    v_pk_fma_f32 v[90:91], v[86:87], v[86:87], v[90:91] neg_lo:[1,0,0] neg_hi:[1,0,0]
    v_max_f32 v88, v68, v88
    v_max_f32 v89, v68, v89
    v_max_f32 v90, v68, v90
    v_max_f32 v91, v68, v91
    v_rsq_f32 v96, v88
    v_rsq_f32 v97, v89
    v_rsq_f32 v98, v90
    v_rsq_f32 v99, v91
    s_waitcnt vmcnt(0)
    v_lshlrev_b32 v52, 16, v92
    v_and_b32 v53, 0xffff0000, v92
    v_lshlrev_b32 v54, 16, v93
    v_and_b32 v55, 0xffff0000, v93
    v_lshlrev_b32 v56, 16, v94
    v_and_b32 v57, 0xffff0000, v94
    v_lshlrev_b32 v58, 16, v95
    v_and_b32 v59, 0xffff0000, v95
    v_pk_mul_f32 v[80:81], v[84:85], v[96:97] neg_lo:[1,0] neg_hi:[1,0]
    v_pk_mul_f32 v[82:83], v[86:87], v[98:99] neg_lo:[1,0] neg_hi:[1,0]
    v_pk_fma_f32 v[60:61], v[52:53], v[96:97], v[80:81]
    v_pk_fma_f32 v[62:63], v[54:55], v[98:99], v[82:83]
    v_cvt_pk_bf16_f32 v76, v60, v61
    v_cvt_pk_bf16_f32 v77, v62, v63
    ds_write_b64 v37, v[76:77] offset:35840
    v_pk_fma_f32 v[64:65], v[56:57], v[96:97], v[80:81]
    v_pk_fma_f32 v[66:67], v[58:59], v[98:99], v[82:83]
    v_cvt_pk_bf16_f32 v78, v64, v65
    v_cvt_pk_bf16_f32 v79, v66, v67
    ds_write_b64 v37, v[78:79] offset:40448
    v_pk_fma_f32 v[52:53], v[60:61], s[28:29], v[52:53] op_sel:[0,0,0] op_sel_hi:[1,0,1]
    v_pk_fma_f32 v[54:55], v[62:63], s[28:29], v[54:55] op_sel:[0,0,0] op_sel_hi:[1,0,1]
    v_pk_fma_f32 v[56:57], v[64:65], s[28:29], v[56:57] op_sel:[0,1,0] op_sel_hi:[1,1,1]
    v_pk_fma_f32 v[58:59], v[66:67], s[28:29], v[58:59] op_sel:[0,1,0] op_sel_hi:[1,1,1]
    s_getpc_b64 s[38:39]
PF9:
    v_lshlrev_b32 v7, 7, v0
    s_mov_b32 s3, M_END-PF9
    s_min_u32 s3, s3, 20480
    v_min_u32 v7, s3, v7
    global_load_dword v43, v7, s[38:39]
    s_waitcnt lgkmcnt(0)
    s_barrier
    ds_read_b128 v[152:155], v40 offset:2240
    ds_read_b128 v[156:159], v40 offset:2752
    ds_read_b128 v[160:163], v40 offset:3264
    ds_read_b128 v[164:167], v40 offset:3776
    ds_read_b128 v[168:171], v40 offset:2176
    ds_read_b128 v[172:175], v40 offset:2688
    ds_read_b128 v[176:179], v40 offset:3200
    ds_read_b128 v[180:183], v40 offset:3712
    s_mov_b32 s3, 135168
    buffer_load_dword v43, v3, s[40:43], s3 offen sc1
    v_mfma_f32_16x16x32_bf16 v[136:139], v[232:235], v[200:203], v[136:139]
    ds_read_b128 v[184:187], v40 offset:2112
    ds_read_b128 v[188:191], v40 offset:2624
    v_mfma_f32_16x16x32_bf16 v[140:143], v[232:235], v[204:207], v[140:143]
    ds_read_b128 v[192:195], v40 offset:3136
    ds_read_b128 v[196:199], v40 offset:3648
    v_mfma_f32_16x16x32_bf16 v[144:147], v[232:235], v[208:211], v[144:147]
    v_mfma_f32_16x16x32_bf16 v[148:151], v[232:235], v[212:215], v[148:151]
    v_mfma_f32_16x16x32_bf16 v[140:143], v[236:239], v[200:203], v[140:143]
    v_mfma_f32_16x16x32_bf16 v[144:147], v[236:239], v[204:207], v[144:147]
    v_mfma_f32_16x16x32_bf16 v[148:151], v[236:239], v[208:211], v[148:151]
    v_mfma_f32_16x16x32_bf16 v[144:147], v[240:243], v[200:203], v[144:147]
    v_mfma_f32_16x16x32_bf16 v[148:151], v[240:243], v[204:207], v[148:151]
    v_mfma_f32_16x16x32_bf16 v[148:151], v[244:247], v[200:203], v[148:151]
    s_waitcnt lgkmcnt(11)
    v_mfma_f32_16x16x32_bf16 v[136:139], a[192:195], v[152:155], v[136:139]
    ds_read_b128 v[200:203], v40 offset:2048
    ds_read_b128 v[204:207], v40 offset:2560
    v_mfma_f32_16x16x32_bf16 v[140:143], a[196:199], v[152:155], v[140:143]
    ds_read_b128 v[208:211], v40 offset:3072
    ds_read_b128 v[212:215], v40 offset:3584
    v_mfma_f32_16x16x32_bf16 v[144:147], a[200:203], v[152:155], v[144:147]
    s_lshl_b32 s37, s20, 12
    s_add_u32 m0, s37, 75264
    v_mfma_f32_16x16x32_bf16 v[148:151], a[204:207], v[152:155], v[148:151]
    s_lshl_b32 s34, s21, 16
    s_add_u32 s34, s34, s37
    s_waitcnt lgkmcnt(14)
    v_mfma_f32_16x16x32_bf16 v[140:143], a[192:195], v[156:159], v[140:143]
    s_lshl_b32 s33, s24, 15
    s_add_u32 s33, s33, 27328512
    v_mfma_f32_16x16x32_bf16 v[144:147], a[196:199], v[156:159], v[144:147]
    s_add_u32 s64, s4, s33
    s_addc_u32 s65, s5, 0
    s_cmp_eq_u32 s25, 3
    s_cselect_b32 s66, 32768, 0
    v_mfma_f32_16x16x32_bf16 v[148:151], a[200:203], v[156:159], v[148:151]
    s_mov_b32 s67, 0x20000
    s_waitcnt lgkmcnt(13)
    v_mfma_f32_16x16x32_bf16 v[144:147], a[192:195], v[160:163], v[144:147]
    v_mfma_f32_16x16x32_bf16 v[148:151], a[196:199], v[160:163], v[148:151]
    s_waitcnt lgkmcnt(12)
    v_mfma_f32_16x16x32_bf16 v[148:151], a[192:195], v[164:167], v[148:151]
    s_waitcnt lgkmcnt(11)
    v_mfma_f32_16x16x32_bf16 v[136:139], a[208:211], v[168:171], v[136:139]
    v_mfma_f32_16x16x32_bf16 v[140:143], a[212:215], v[168:171], v[140:143]
    v_mfma_f32_16x16x32_bf16 v[144:147], a[216:219], v[168:171], v[144:147]
    v_mfma_f32_16x16x32_bf16 v[148:151], a[220:223], v[168:171], v[148:151]
    s_waitcnt lgkmcnt(10)
    v_mfma_f32_16x16x32_bf16 v[140:143], a[208:211], v[172:175], v[140:143]
    v_mfma_f32_16x16x32_bf16 v[144:147], a[212:215], v[172:175], v[144:147]
    s_mov_b32 s3, 135168
    s_cmp_lg_u32 s20, 0
    s_cbranch_scc1 PC_D10
    s_waitcnt vmcnt(0)
    s_mov_b32 s33, 0x40000
PC_L10:
    v_cmp_ne_u32 vcc, 16, v43
    s_cmp_eq_u64 vcc, 0
    s_cbranch_scc1 PC_D10
    s_sub_u32 s33, s33, 1
    s_cbranch_scc1 PC_D10
    s_sleep 1
    buffer_load_dword v43, v3, s[40:43], s3 offen sc1
    s_waitcnt vmcnt(0)
    s_branch PC_L10
PC_D10:
    s_barrier
    v_mfma_f32_16x16x32_bf16 v[148:151], a[216:219], v[172:175], v[148:151]
    buffer_load_dwordx4 v11, s[56:59], s34 offen offset:0 sc1 lds
    buffer_load_dwordx4 v12, s[56:59], s34 offen offset:1024 sc1 lds
    s_waitcnt lgkmcnt(9)
    v_mfma_f32_16x16x32_bf16 v[144:147], a[208:211], v[176:179], v[144:147]
    buffer_load_dwordx4 v11, s[56:59], s34 offen offset:2048 sc1 lds
    buffer_load_dwordx4 v12, s[56:59], s34 offen offset:3072 sc1 lds
    v_mfma_f32_16x16x32_bf16 v[148:151], a[212:215], v[176:179], v[148:151]
    s_add_u32 m0, s37, 91648
    s_add_u32 s34, s34, 16384
    s_waitcnt lgkmcnt(8)
    v_mfma_f32_16x16x32_bf16 v[148:151], a[208:211], v[180:183], v[148:151]
    buffer_load_dwordx4 v11, s[56:59], s34 offen offset:0 sc1 lds
    buffer_load_dwordx4 v12, s[56:59], s34 offen offset:1024 sc1 lds
    s_waitcnt lgkmcnt(7)
    v_mfma_f32_16x16x32_bf16 v[136:139], a[224:227], v[184:187], v[136:139]
    buffer_load_dwordx4 v11, s[56:59], s34 offen offset:2048 sc1 lds
    buffer_load_dwordx4 v12, s[56:59], s34 offen offset:3072 sc1 lds
    v_mfma_f32_16x16x32_bf16 v[140:143], a[228:231], v[184:187], v[140:143]
    s_add_u32 m0, s37, 108032
    s_add_u32 s34, s34, 16384
    v_mfma_f32_16x16x32_bf16 v[144:147], a[232:235], v[184:187], v[144:147]
    v_mfma_f32_16x16x32_bf16 v[148:151], a[236:239], v[184:187], v[148:151]
    s_waitcnt lgkmcnt(6)
    v_mfma_f32_16x16x32_bf16 v[140:143], a[224:227], v[188:191], v[140:143]
    v_mfma_f32_16x16x32_bf16 v[144:147], a[228:231], v[188:191], v[144:147]
    v_mfma_f32_16x16x32_bf16 v[148:151], a[232:235], v[188:191], v[148:151]
    s_waitcnt lgkmcnt(5)
    v_mfma_f32_16x16x32_bf16 v[144:147], a[224:227], v[192:195], v[144:147]
    v_mfma_f32_16x16x32_bf16 v[148:151], a[228:231], v[192:195], v[148:151]
    s_waitcnt lgkmcnt(4)
    v_mfma_f32_16x16x32_bf16 v[148:151], a[224:227], v[196:199], v[148:151]
    s_waitcnt lgkmcnt(3)
    v_mfma_f32_16x16x32_bf16 v[136:139], a[240:243], v[200:203], v[136:139]
    v_mfma_f32_16x16x32_bf16 v[140:143], a[244:247], v[200:203], v[140:143]
    v_mfma_f32_16x16x32_bf16 v[144:147], a[248:251], v[200:203], v[144:147]
    v_mfma_f32_16x16x32_bf16 v[148:151], a[252:255], v[200:203], v[148:151]
    s_waitcnt lgkmcnt(2)
    v_mfma_f32_16x16x32_bf16 v[140:143], a[240:243], v[204:207], v[140:143]
    v_mfma_f32_16x16x32_bf16 v[144:147], a[244:247], v[204:207], v[144:147]
    v_mfma_f32_16x16x32_bf16 v[148:151], a[248:251], v[204:207], v[148:151]
    s_waitcnt lgkmcnt(1)
    v_mfma_f32_16x16x32_bf16 v[144:147], a[240:243], v[208:211], v[144:147]
    v_mfma_f32_16x16x32_bf16 v[148:151], a[244:247], v[208:211], v[148:151]
    s_waitcnt lgkmcnt(0)
    v_mfma_f32_16x16x32_bf16 v[148:151], a[240:243], v[212:215], v[148:151]
    ds_write_b128 v41, v[136:139] offset:42496
    ds_write_b128 v41, v[140:143] offset:43776
    s_nop 2
    ds_write_b128 v41, v[144:147] offset:45056
    s_nop 1
    ds_write_b128 v41, v[148:151] offset:46336
    s_waitcnt lgkmcnt(0)
    s_barrier
    ds_read_b128 v[104:107], v42 offset:42496
    ds_read_b128 v[108:111], v42 offset:47616
    ds_read_b128 v[112:115], v42 offset:52736
    ds_read_b128 v[116:119], v42 offset:57856
    s_waitcnt lgkmcnt(2)
    v_pk_add_f32 v[104:105], v[104:105], v[108:109]
    v_pk_add_f32 v[106:107], v[106:107], v[110:111]
    v_pk_add_f32 v[104:105], v[104:105], v[52:53]
    v_pk_add_f32 v[106:107], v[106:107], v[54:55]
    v_cvt_pk_bf16_f32 v108, v104, v105
    v_cvt_pk_bf16_f32 v109, v106, v107
    buffer_store_dwordx2 v[108:109], v38, s[16:19], s97 offen offset:0 sc1
    s_waitcnt lgkmcnt(0)
    v_pk_add_f32 v[112:113], v[112:113], v[116:117]
    v_pk_add_f32 v[114:115], v[114:115], v[118:119]
    v_pk_add_f32 v[112:113], v[112:113], v[56:57]
    v_pk_add_f32 v[114:115], v[114:115], v[58:59]
    v_cvt_pk_bf16_f32 v116, v112, v113
    v_cvt_pk_bf16_f32 v117, v114, v115
    buffer_store_dwordx2 v[116:117], v38, s[16:19], s97 offen offset:128 sc1
    s_waitcnt vmcnt(6)
    s_barrier
    ds_read_b64_tr_b16 v[168:169], v13 offset:0
    ds_read_b64_tr_b16 v[170:171], v13 offset:512
    ds_read_b64_tr_b16 v[172:173], v14 offset:0
    ds_read_b64_tr_b16 v[174:175], v14 offset:512
    ds_read_b64_tr_b16 v[176:177], v15 offset:0
    ds_read_b64_tr_b16 v[178:179], v15 offset:512
    ds_read_b64_tr_b16 v[180:181], v16 offset:0
    ds_read_b64_tr_b16 v[182:183], v16 offset:512
    s_waitcnt lgkmcnt(4)
    v_mfma_f32_16x16x32_bf16 v[108:111], v[168:171], v[168:171], 0
    ds_read_b64_tr_b16 v[184:185], v13 offset:4096
    buffer_load_dwordx4 v11, s[56:59], s34 offen offset:0 sc1 lds
    v_mfma_f32_16x16x32_bf16 v[200:203], a[0:3], v[168:171], 0
    ds_read_b64_tr_b16 v[186:187], v13 offset:4608
    s_mov_b32 s36, 0
    v_mfma_f32_16x16x32_bf16 v[204:207], a[4:7], v[168:171], 0
    ds_read_b64_tr_b16 v[188:189], v14 offset:4096
    s_mov_b32 s35, 0
    v_mfma_f32_16x16x32_bf16 v[208:211], a[8:11], v[168:171], 0
    ds_read_b64_tr_b16 v[190:191], v14 offset:4608
    s_mov_b32 s12, 0x22222222
    v_mfma_f32_16x16x32_bf16 v[212:215], a[0:3], v[172:175], 0
    ds_read_b64_tr_b16 v[192:193], v15 offset:4096
    buffer_load_dwordx4 v12, s[56:59], s34 offen offset:1024 sc1 lds
    v_mfma_f32_16x16x32_bf16 v[216:219], a[4:7], v[172:175], 0
    ds_read_b64_tr_b16 v[194:195], v15 offset:4608
    s_mov_b32 s13, 0x22222222
    v_mfma_f32_16x16x32_bf16 v[220:223], a[8:11], v[172:175], 0
    ds_read_b64_tr_b16 v[196:197], v16 offset:4096
    s_waitcnt lgkmcnt(7)
    v_mfma_f32_16x16x32_bf16 v[224:227], a[0:3], v[176:179], 0
    ds_read_b64_tr_b16 v[198:199], v16 offset:4608
    s_mov_b32 s14, 0x44444444
    v_mfma_f32_16x16x32_bf16 v[228:231], a[4:7], v[176:179], 0
    buffer_load_dwordx4 v11, s[56:59], s34 offen offset:2048 sc1 lds
    s_mov_b32 s15, 0x44444444
    v_mfma_f32_16x16x32_bf16 v[232:235], a[8:11], v[176:179], 0
    s_mov_b32 s16, 0x88888888
    s_mov_b32 s17, 0x88888888
    v_mfma_f32_16x16x32_bf16 v[236:239], a[0:3], v[180:183], 0
    s_mov_b32 s18, 0xf0000f
    s_mov_b32 s19, 0xf0000f00
    v_mfma_f32_16x16x32_bf16 v[240:243], a[4:7], v[180:183], 0
    v_mfma_f32_16x16x32_bf16 v[244:247], a[8:11], v[180:183], 0
    buffer_load_dwordx4 v12, s[56:59], s34 offen offset:3072 sc1 lds
    s_waitcnt lgkmcnt(4)
    v_mfma_f32_16x16x32_bf16 v[108:111], v[184:187], v[184:187], v[108:111]
    ds_read_b64_tr_b16 v[168:169], v13 offset:8192
    s_add_u32 m0, s37, 124416
    v_mfma_f32_16x16x32_bf16 v[200:203], a[12:15], v[184:187], v[200:203]
    ds_read_b64_tr_b16 v[170:171], v13 offset:8704
    s_add_u32 s34, s34, 16384
    v_mfma_f32_16x16x32_bf16 v[204:207], a[16:19], v[184:187], v[204:207]
    ds_read_b64_tr_b16 v[172:173], v14 offset:8192
    v_mfma_f32_16x16x32_bf16 v[208:211], a[20:23], v[184:187], v[208:211]
    ds_read_b64_tr_b16 v[174:175], v14 offset:8704
    buffer_load_dwordx4 v11, s[56:59], s34 offen offset:0 sc1 lds
    v_mfma_f32_16x16x32_bf16 v[212:215], a[12:15], v[188:191], v[212:215]
    ds_read_b64_tr_b16 v[176:177], v15 offset:8192
    v_mfma_f32_16x16x32_bf16 v[216:219], a[16:19], v[188:191], v[216:219]
    ds_read_b64_tr_b16 v[178:179], v15 offset:8704
    v_mfma_f32_16x16x32_bf16 v[220:223], a[20:23], v[188:191], v[220:223]
    ds_read_b64_tr_b16 v[180:181], v16 offset:8192
    s_waitcnt lgkmcnt(7)
    v_mfma_f32_16x16x32_bf16 v[224:227], a[12:15], v[192:195], v[224:227]
    ds_read_b64_tr_b16 v[182:183], v16 offset:8704
    buffer_load_dwordx4 v12, s[56:59], s34 offen offset:1024 sc1 lds
    v_mfma_f32_16x16x32_bf16 v[228:231], a[16:19], v[192:195], v[228:231]
    v_mfma_f32_16x16x32_bf16 v[232:235], a[20:23], v[192:195], v[232:235]
    v_mfma_f32_16x16x32_bf16 v[236:239], a[12:15], v[196:199], v[236:239]
    v_mfma_f32_16x16x32_bf16 v[240:243], a[16:19], v[196:199], v[240:243]
    buffer_load_dwordx4 v11, s[56:59], s34 offen offset:2048 sc1 lds
    v_mfma_f32_16x16x32_bf16 v[244:247], a[20:23], v[196:199], v[244:247]
    s_waitcnt lgkmcnt(4)
    v_mfma_f32_16x16x32_bf16 v[108:111], v[168:171], v[168:171], v[108:111]
    ds_read_b64_tr_b16 v[184:185], v13 offset:12288
    v_mfma_f32_16x16x32_bf16 v[200:203], a[24:27], v[168:171], v[200:203]
    ds_read_b64_tr_b16 v[186:187], v13 offset:12800
    v_mfma_f32_16x16x32_bf16 v[204:207], a[28:31], v[168:171], v[204:207]
    ds_read_b64_tr_b16 v[188:189], v14 offset:12288
    buffer_load_dwordx4 v12, s[56:59], s34 offen offset:3072 sc1 lds
    v_mfma_f32_16x16x32_bf16 v[208:211], a[32:35], v[168:171], v[208:211]
    ds_read_b64_tr_b16 v[190:191], v14 offset:12800
    s_add_u32 m0, s37, 33280
    v_mfma_f32_16x16x32_bf16 v[212:215], a[24:27], v[172:175], v[212:215]
    ds_read_b64_tr_b16 v[192:193], v15 offset:12288
    s_add_u32 s34, s34, 999424
    v_mfma_f32_16x16x32_bf16 v[216:219], a[28:31], v[172:175], v[216:219]
    ds_read_b64_tr_b16 v[194:195], v15 offset:12800
    v_mfma_f32_16x16x32_bf16 v[220:223], a[32:35], v[172:175], v[220:223]
    ds_read_b64_tr_b16 v[196:197], v16 offset:12288
    s_waitcnt lgkmcnt(7)
    v_mfma_f32_16x16x32_bf16 v[224:227], a[24:27], v[176:179], v[224:227]
    ds_read_b64_tr_b16 v[198:199], v16 offset:12800
    buffer_load_dwordx4 a[192:195], v23, s[72:75], s36 offen sc1
    v_mfma_f32_16x16x32_bf16 v[228:231], a[28:31], v[176:179], v[228:231]
    v_mfma_f32_16x16x32_bf16 v[232:235], a[32:35], v[176:179], v[232:235]
    v_mfma_f32_16x16x32_bf16 v[236:239], a[24:27], v[180:183], v[236:239]
    v_mfma_f32_16x16x32_bf16 v[240:243], a[28:31], v[180:183], v[240:243]
    buffer_load_dwordx4 a[196:199], v24, s[72:75], s36 offen sc1
    s_add_u32 s36, s36, 16384
    v_mfma_f32_16x16x32_bf16 v[244:247], a[32:35], v[180:183], v[244:247]
    s_waitcnt vmcnt(12)
    s_waitcnt vmcnt(10)
    s_barrier
    s_waitcnt lgkmcnt(4)
    v_mfma_f32_16x16x32_bf16 v[108:111], v[184:187], v[184:187], v[108:111]
    ds_read_b64_tr_b16 v[168:169], v13 offset:16384
    s_mov_b32 s3, 167936
    v_mfma_f32_16x16x32_bf16 v[200:203], a[36:39], v[184:187], v[200:203]
    ds_read_b64_tr_b16 v[170:171], v13 offset:16896
    buffer_atomic_add v4, v2, s[40:43], s3 offen
    v_mfma_f32_16x16x32_bf16 v[204:207], a[40:43], v[184:187], v[204:207]
    ds_read_b64_tr_b16 v[172:173], v14 offset:16384
    v_mfma_f32_16x16x32_bf16 v[208:211], a[44:47], v[184:187], v[208:211]
    ds_read_b64_tr_b16 v[174:175], v14 offset:16896
    buffer_load_dwordx4 a[200:203], v23, s[72:75], s36 offen sc1
    v_mfma_f32_16x16x32_bf16 v[212:215], a[36:39], v[188:191], v[212:215]
    ds_read_b64_tr_b16 v[176:177], v15 offset:16384
    v_mfma_f32_16x16x32_bf16 v[216:219], a[40:43], v[188:191], v[216:219]
    ds_read_b64_tr_b16 v[178:179], v15 offset:16896
    v_mfma_f32_16x16x32_bf16 v[220:223], a[44:47], v[188:191], v[220:223]
    ds_read_b64_tr_b16 v[180:181], v16 offset:16384
    s_waitcnt lgkmcnt(7)
    v_mfma_f32_16x16x32_bf16 v[224:227], a[36:39], v[192:195], v[224:227]
    ds_read_b64_tr_b16 v[182:183], v16 offset:16896
    buffer_load_dwordx4 a[204:207], v24, s[72:75], s36 offen sc1
    v_mfma_f32_16x16x32_bf16 v[228:231], a[40:43], v[192:195], v[228:231]
    s_add_u32 s36, s36, 16384
    v_mfma_f32_16x16x32_bf16 v[232:235], a[44:47], v[192:195], v[232:235]
    v_mfma_f32_16x16x32_bf16 v[236:239], a[36:39], v[196:199], v[236:239]
    v_mfma_f32_16x16x32_bf16 v[240:243], a[40:43], v[196:199], v[240:243]
    buffer_load_dwordx4 a[208:211], v23, s[72:75], s36 offen sc1
    v_mfma_f32_16x16x32_bf16 v[244:247], a[44:47], v[196:199], v[244:247]
    s_waitcnt lgkmcnt(4)
    v_mfma_f32_16x16x32_bf16 v[108:111], v[168:171], v[168:171], v[108:111]
    ds_read_b64_tr_b16 v[184:185], v13 offset:20480
    v_add_u32 v8, 145920, v35
    v_mfma_f32_16x16x32_bf16 v[200:203], a[48:51], v[168:171], v[200:203]
    ds_read_b64_tr_b16 v[186:187], v13 offset:20992
    ds_read_b128 v[44:47], v8 offset:0
    v_mfma_f32_16x16x32_bf16 v[204:207], a[52:55], v[168:171], v[204:207]
    ds_read_b64_tr_b16 v[188:189], v14 offset:20480
    buffer_load_dwordx4 a[212:215], v24, s[72:75], s36 offen sc1
    v_mfma_f32_16x16x32_bf16 v[208:211], a[56:59], v[168:171], v[208:211]
    ds_read_b64_tr_b16 v[190:191], v14 offset:20992
    s_add_u32 s36, s36, 16384
    v_mfma_f32_16x16x32_bf16 v[212:215], a[48:51], v[172:175], v[212:215]
    ds_read_b64_tr_b16 v[192:193], v15 offset:20480
    ds_read_b128 v[52:55], v8 offset:4096
    v_mfma_f32_16x16x32_bf16 v[216:219], a[52:55], v[172:175], v[216:219]
    ds_read_b64_tr_b16 v[194:195], v15 offset:20992
    ds_read_b128 v[60:63], v8 offset:8192
    v_mfma_f32_16x16x32_bf16 v[220:223], a[56:59], v[172:175], v[220:223]
    ds_read_b64_tr_b16 v[196:197], v16 offset:20480
    s_waitcnt lgkmcnt(10)
    v_mfma_f32_16x16x32_bf16 v[224:227], a[48:51], v[176:179], v[224:227]
    ds_read_b64_tr_b16 v[198:199], v16 offset:20992
    buffer_load_dwordx4 a[216:219], v23, s[72:75], s36 offen sc1
    v_mfma_f32_16x16x32_bf16 v[228:231], a[52:55], v[176:179], v[228:231]
    v_mfma_f32_16x16x32_bf16 v[232:235], a[56:59], v[176:179], v[232:235]
    v_mfma_f32_16x16x32_bf16 v[236:239], a[48:51], v[180:183], v[236:239]
    v_mfma_f32_16x16x32_bf16 v[240:243], a[52:55], v[180:183], v[240:243]
    buffer_load_dwordx4 a[220:223], v24, s[72:75], s36 offen sc1
    s_add_u32 s36, s36, 16384
    v_mfma_f32_16x16x32_bf16 v[244:247], a[56:59], v[180:183], v[244:247]
    s_waitcnt lgkmcnt(6)
    v_mfma_f32_16x16x32_bf16 v[108:111], v[184:187], v[184:187], v[108:111]
    ds_read_b64_tr_b16 v[168:169], v13 offset:24576
    v_mfma_f32_16x16x32_bf16 v[200:203], a[60:63], v[184:187], v[200:203]
    ds_read_b64_tr_b16 v[170:171], v13 offset:25088
    v_mfma_f32_16x16x32_bf16 v[204:207], a[64:67], v[184:187], v[204:207]
    ds_read_b64_tr_b16 v[172:173], v14 offset:24576
    buffer_load_dwordx4 a[224:227], v23, s[72:75], s36 offen sc1
    v_mfma_f32_16x16x32_bf16 v[208:211], a[68:71], v[184:187], v[208:211]
    ds_read_b64_tr_b16 v[174:175], v14 offset:25088
    v_mfma_f32_16x16x32_bf16 v[212:215], a[60:63], v[188:191], v[212:215]
    ds_read_b64_tr_b16 v[176:177], v15 offset:24576
    v_mfma_f32_16x16x32_bf16 v[216:219], a[64:67], v[188:191], v[216:219]
    ds_read_b64_tr_b16 v[178:179], v15 offset:25088
    v_mfma_f32_16x16x32_bf16 v[220:223], a[68:71], v[188:191], v[220:223]
    ds_read_b64_tr_b16 v[180:181], v16 offset:24576
    s_waitcnt lgkmcnt(7)
    v_mfma_f32_16x16x32_bf16 v[224:227], a[60:63], v[192:195], v[224:227]
    ds_read_b64_tr_b16 v[182:183], v16 offset:25088
    buffer_load_dwordx4 a[228:231], v24, s[72:75], s36 offen sc1
    v_mfma_f32_16x16x32_bf16 v[228:231], a[64:67], v[192:195], v[228:231]
    s_add_u32 s36, s36, 16384
    v_mfma_f32_16x16x32_bf16 v[232:235], a[68:71], v[192:195], v[232:235]
    v_mfma_f32_16x16x32_bf16 v[236:239], a[60:63], v[196:199], v[236:239]
    v_mfma_f32_16x16x32_bf16 v[240:243], a[64:67], v[196:199], v[240:243]
    buffer_load_dwordx4 a[232:235], v23, s[72:75], s36 offen sc1
    v_mfma_f32_16x16x32_bf16 v[244:247], a[68:71], v[196:199], v[244:247]
    s_waitcnt lgkmcnt(4)
    v_mfma_f32_16x16x32_bf16 v[108:111], v[168:171], v[168:171], v[108:111]
    ds_read_b64_tr_b16 v[184:185], v13 offset:28672
    v_mfma_f32_16x16x32_bf16 v[200:203], a[72:75], v[168:171], v[200:203]
    ds_read_b64_tr_b16 v[186:187], v13 offset:29184
    v_mfma_f32_16x16x32_bf16 v[204:207], a[76:79], v[168:171], v[204:207]
    ds_read_b64_tr_b16 v[188:189], v14 offset:28672
    buffer_load_dwordx4 a[236:239], v24, s[72:75], s36 offen sc1
    v_mfma_f32_16x16x32_bf16 v[208:211], a[80:83], v[168:171], v[208:211]
    ds_read_b64_tr_b16 v[190:191], v14 offset:29184
    s_add_u32 s36, s36, 16384
    v_mfma_f32_16x16x32_bf16 v[212:215], a[72:75], v[172:175], v[212:215]
    ds_read_b64_tr_b16 v[192:193], v15 offset:28672
    v_mfma_f32_16x16x32_bf16 v[216:219], a[76:79], v[172:175], v[216:219]
    ds_read_b64_tr_b16 v[194:195], v15 offset:29184
    v_mfma_f32_16x16x32_bf16 v[220:223], a[80:83], v[172:175], v[220:223]
    ds_read_b64_tr_b16 v[196:197], v16 offset:28672
    s_waitcnt lgkmcnt(7)
    v_mfma_f32_16x16x32_bf16 v[224:227], a[72:75], v[176:179], v[224:227]
    ds_read_b64_tr_b16 v[198:199], v16 offset:29184
    buffer_load_dwordx4 a[240:243], v23, s[72:75], s36 offen sc1
    v_mfma_f32_16x16x32_bf16 v[228:231], a[76:79], v[176:179], v[228:231]
    v_mfma_f32_16x16x32_bf16 v[232:235], a[80:83], v[176:179], v[232:235]
    v_mfma_f32_16x16x32_bf16 v[236:239], a[72:75], v[180:183], v[236:239]
    v_mfma_f32_16x16x32_bf16 v[240:243], a[76:79], v[180:183], v[240:243]
    buffer_load_dwordx4 a[244:247], v24, s[72:75], s36 offen sc1
    s_add_u32 s36, s36, 16384
    v_mfma_f32_16x16x32_bf16 v[244:247], a[80:83], v[180:183], v[244:247]
    s_waitcnt vmcnt(15)
    s_barrier
    s_waitcnt lgkmcnt(4)
    v_mfma_f32_16x16x32_bf16 v[108:111], v[184:187], v[184:187], v[108:111]
    ds_read_b64_tr_b16 v[168:169], v13 offset:32768
    v_mfma_f32_16x16x32_bf16 v[200:203], a[84:87], v[184:187], v[200:203]
    ds_read_b64_tr_b16 v[170:171], v13 offset:33280
    v_mfma_f32_16x16x32_bf16 v[204:207], a[88:91], v[184:187], v[204:207]
    ds_read_b64_tr_b16 v[172:173], v14 offset:32768
    buffer_load_dwordx4 a[248:251], v23, s[72:75], s36 offen sc1
    v_mfma_f32_16x16x32_bf16 v[208:211], a[92:95], v[184:187], v[208:211]
    ds_read_b64_tr_b16 v[174:175], v14 offset:33280
    v_mfma_f32_16x16x32_bf16 v[212:215], a[84:87], v[188:191], v[212:215]
    ds_read_b64_tr_b16 v[176:177], v15 offset:32768
    v_mfma_f32_16x16x32_bf16 v[216:219], a[88:91], v[188:191], v[216:219]
    ds_read_b64_tr_b16 v[178:179], v15 offset:33280
    v_mfma_f32_16x16x32_bf16 v[220:223], a[92:95], v[188:191], v[220:223]
    ds_read_b64_tr_b16 v[180:181], v16 offset:32768
    s_waitcnt lgkmcnt(7)
    v_mfma_f32_16x16x32_bf16 v[224:227], a[84:87], v[192:195], v[224:227]
    ds_read_b64_tr_b16 v[182:183], v16 offset:33280
    buffer_load_dwordx4 a[252:255], v24, s[72:75], s36 offen sc1
    v_mfma_f32_16x16x32_bf16 v[228:231], a[88:91], v[192:195], v[228:231]
    s_add_u32 s36, s36, 16384
    v_mfma_f32_16x16x32_bf16 v[232:235], a[92:95], v[192:195], v[232:235]
    v_mfma_f32_16x16x32_bf16 v[236:239], a[84:87], v[196:199], v[236:239]
    v_mfma_f32_16x16x32_bf16 v[240:243], a[88:91], v[196:199], v[240:243]
    v_mfma_f32_16x16x32_bf16 v[244:247], a[92:95], v[196:199], v[244:247]
    s_waitcnt lgkmcnt(4)
    v_mfma_f32_16x16x32_bf16 v[108:111], v[168:171], v[168:171], v[108:111]
    ds_read_b64_tr_b16 v[184:185], v13 offset:36864
    v_add_u32 v8, 75264, v26
    v_mfma_f32_16x16x32_bf16 v[200:203], a[96:99], v[168:171], v[200:203]
    ds_read_b64_tr_b16 v[186:187], v13 offset:37376
    ds_read2_b64 v[112:115], v8 offset0:0 offset1:2
    v_mfma_f32_16x16x32_bf16 v[204:207], a[100:103], v[168:171], v[204:207]
    ds_read_b64_tr_b16 v[188:189], v14 offset:36864
    v_mfma_f32_16x16x32_bf16 v[208:211], a[104:107], v[168:171], v[208:211]
    ds_read_b64_tr_b16 v[190:191], v14 offset:37376
    v_mfma_f32_16x16x32_bf16 v[212:215], a[96:99], v[172:175], v[212:215]
    ds_read_b64_tr_b16 v[192:193], v15 offset:36864
    v_mfma_f32_16x16x32_bf16 v[216:219], a[100:103], v[172:175], v[216:219]
    ds_read_b64_tr_b16 v[194:195], v15 offset:37376
    v_mfma_f32_16x16x32_bf16 v[220:223], a[104:107], v[172:175], v[220:223]
    ds_read_b64_tr_b16 v[196:197], v16 offset:36864
    s_waitcnt lgkmcnt(8)
    v_mfma_f32_16x16x32_bf16 v[224:227], a[96:99], v[176:179], v[224:227]
    ds_read_b64_tr_b16 v[198:199], v16 offset:37376
    v_mfma_f32_16x16x32_bf16 v[228:231], a[100:103], v[176:179], v[228:231]
    v_mfma_f32_16x16x32_bf16 v[232:235], a[104:107], v[176:179], v[232:235]
    v_mfma_f32_16x16x32_bf16 v[236:239], a[96:99], v[180:183], v[236:239]
    v_mfma_f32_16x16x32_bf16 v[240:243], a[100:103], v[180:183], v[240:243]
    v_mfma_f32_16x16x32_bf16 v[244:247], a[104:107], v[180:183], v[244:247]
    s_waitcnt lgkmcnt(4)
    v_mfma_f32_16x16x32_bf16 v[108:111], v[184:187], v[184:187], v[108:111]
    ds_read_b64_tr_b16 v[168:169], v13 offset:40960
    v_mfma_f32_16x16x32_bf16 v[200:203], a[108:111], v[184:187], v[200:203]
    ds_read_b64_tr_b16 v[170:171], v13 offset:41472
    v_mfma_f32_16x16x32_bf16 v[204:207], a[112:115], v[184:187], v[204:207]
    ds_read_b64_tr_b16 v[172:173], v14 offset:40960
    v_mfma_f32_16x16x32_bf16 v[208:211], a[116:119], v[184:187], v[208:211]
    ds_read_b64_tr_b16 v[174:175], v14 offset:41472
    v_mfma_f32_16x16x32_bf16 v[212:215], a[108:111], v[188:191], v[212:215]
    ds_read_b64_tr_b16 v[176:177], v15 offset:40960
    v_mfma_f32_16x16x32_bf16 v[216:219], a[112:115], v[188:191], v[216:219]
    ds_read_b64_tr_b16 v[178:179], v15 offset:41472
    v_mfma_f32_16x16x32_bf16 v[220:223], a[116:119], v[188:191], v[220:223]
    ds_read_b64_tr_b16 v[180:181], v16 offset:40960
    s_waitcnt lgkmcnt(7)
    v_mfma_f32_16x16x32_bf16 v[224:227], a[108:111], v[192:195], v[224:227]
    ds_read_b64_tr_b16 v[182:183], v16 offset:41472
    v_mfma_f32_16x16x32_bf16 v[228:231], a[112:115], v[192:195], v[228:231]
    ds_read_b64_tr_b16 v[120:121], v13 offset:61440
    v_mfma_f32_16x16x32_bf16 v[232:235], a[116:119], v[192:195], v[232:235]
    ds_read_b64_tr_b16 v[122:123], v13 offset:61952
    v_mfma_f32_16x16x32_bf16 v[236:239], a[108:111], v[196:199], v[236:239]
    ds_read_b64_tr_b16 v[124:125], v14 offset:61440
    v_mfma_f32_16x16x32_bf16 v[240:243], a[112:115], v[196:199], v[240:243]
    ds_read_b64_tr_b16 v[126:127], v14 offset:61952
    v_mfma_f32_16x16x32_bf16 v[244:247], a[116:119], v[196:199], v[244:247]
    s_waitcnt lgkmcnt(8)
    v_mfma_f32_16x16x32_bf16 v[108:111], v[168:171], v[168:171], v[108:111]
    ds_read_b64_tr_b16 v[184:185], v13 offset:45056
    v_mfma_f32_16x16x32_bf16 v[200:203], a[120:123], v[168:171], v[200:203]
    ds_read_b64_tr_b16 v[186:187], v13 offset:45568
    v_mfma_f32_16x16x32_bf16 v[204:207], a[124:127], v[168:171], v[204:207]
    ds_read_b64_tr_b16 v[188:189], v14 offset:45056
    v_mfma_f32_16x16x32_bf16 v[208:211], a[128:131], v[168:171], v[208:211]
    ds_read_b64_tr_b16 v[190:191], v14 offset:45568
    v_mfma_f32_16x16x32_bf16 v[212:215], a[120:123], v[172:175], v[212:215]
    ds_read_b64_tr_b16 v[192:193], v15 offset:45056
    v_mfma_f32_16x16x32_bf16 v[216:219], a[124:127], v[172:175], v[216:219]
    ds_read_b64_tr_b16 v[194:195], v15 offset:45568
    v_mfma_f32_16x16x32_bf16 v[220:223], a[128:131], v[172:175], v[220:223]
    ds_read_b64_tr_b16 v[196:197], v16 offset:45056
    s_waitcnt lgkmcnt(11)
    v_mfma_f32_16x16x32_bf16 v[224:227], a[120:123], v[176:179], v[224:227]
    ds_read_b64_tr_b16 v[198:199], v16 offset:45568
    v_mfma_f32_16x16x32_bf16 v[228:231], a[124:127], v[176:179], v[228:231]
    ds_read_b64_tr_b16 v[84:85], v13 offset:57344
    v_mfma_f32_16x16x32_bf16 v[232:235], a[128:131], v[176:179], v[232:235]
    ds_read_b64_tr_b16 v[86:87], v13 offset:57856
    v_mfma_f32_16x16x32_bf16 v[236:239], a[120:123], v[180:183], v[236:239]
    ds_read_b64_tr_b16 v[88:89], v14 offset:57344
    v_mfma_f32_16x16x32_bf16 v[240:243], a[124:127], v[180:183], v[240:243]
    ds_read_b64_tr_b16 v[90:91], v14 offset:57856
    v_mfma_f32_16x16x32_bf16 v[244:247], a[128:131], v[180:183], v[244:247]
    s_waitcnt lgkmcnt(8)
    v_mfma_f32_16x16x32_bf16 v[108:111], v[184:187], v[184:187], v[108:111]
    ds_read_b64_tr_b16 v[168:169], v13 offset:49152
    s_mov_b32 s3, 167936
    v_mfma_f32_16x16x32_bf16 v[200:203], a[132:135], v[184:187], v[200:203]
    ds_read_b64_tr_b16 v[170:171], v13 offset:49664
    buffer_load_dword v43, v3, s[40:43], s3 offen sc1
    v_mfma_f32_16x16x32_bf16 v[204:207], a[136:139], v[184:187], v[204:207]
    ds_read_b64_tr_b16 v[172:173], v14 offset:49152
    v_mfma_f32_16x16x32_bf16 v[208:211], a[140:143], v[184:187], v[208:211]
    ds_read_b64_tr_b16 v[174:175], v14 offset:49664
    v_mfma_f32_16x16x32_bf16 v[212:215], a[132:135], v[188:191], v[212:215]
    ds_read_b64_tr_b16 v[176:177], v15 offset:49152
    v_mfma_f32_16x16x32_bf16 v[216:219], a[136:139], v[188:191], v[216:219]
    ds_read_b64_tr_b16 v[178:179], v15 offset:49664
    v_mfma_f32_16x16x32_bf16 v[220:223], a[140:143], v[188:191], v[220:223]
    ds_read_b64_tr_b16 v[180:181], v16 offset:49152
    s_waitcnt lgkmcnt(11)
    v_mfma_f32_16x16x32_bf16 v[224:227], a[132:135], v[192:195], v[224:227]
    ds_read_b64_tr_b16 v[182:183], v16 offset:49664
    v_mfma_f32_16x16x32_bf16 v[228:231], a[136:139], v[192:195], v[228:231]
    ds_read_b64_tr_b16 v[92:93], v15 offset:57344
    v_mfma_f32_16x16x32_bf16 v[232:235], a[140:143], v[192:195], v[232:235]
    ds_read_b64_tr_b16 v[94:95], v15 offset:57856
    v_mfma_f32_16x16x32_bf16 v[236:239], a[132:135], v[196:199], v[236:239]
    ds_read_b64_tr_b16 v[96:97], v16 offset:57344
    v_mfma_f32_16x16x32_bf16 v[240:243], a[136:139], v[196:199], v[240:243]
    ds_read_b64_tr_b16 v[98:99], v16 offset:57856
    v_mfma_f32_16x16x32_bf16 v[244:247], a[140:143], v[196:199], v[244:247]
    s_waitcnt lgkmcnt(8)
    v_mfma_f32_16x16x32_bf16 v[108:111], v[168:171], v[168:171], v[108:111]
    ds_read_b64_tr_b16 v[184:185], v13 offset:53248
    v_mfma_f32_16x16x32_bf16 v[200:203], a[144:147], v[168:171], v[200:203]
    ds_read_b64_tr_b16 v[186:187], v13 offset:53760
    v_mfma_f32_16x16x32_bf16 v[204:207], a[148:151], v[168:171], v[204:207]
    ds_read_b64_tr_b16 v[188:189], v14 offset:53248
    v_mfma_f32_16x16x32_bf16 v[208:211], a[152:155], v[168:171], v[208:211]
    ds_read_b64_tr_b16 v[190:191], v14 offset:53760
    v_mfma_f32_16x16x32_bf16 v[212:215], a[144:147], v[172:175], v[212:215]
    ds_read_b64_tr_b16 v[192:193], v15 offset:53248
    v_mfma_f32_16x16x32_bf16 v[216:219], a[148:151], v[172:175], v[216:219]
    ds_read_b64_tr_b16 v[194:195], v15 offset:53760
    v_mfma_f32_16x16x32_bf16 v[220:223], a[152:155], v[172:175], v[220:223]
    ds_read_b64_tr_b16 v[196:197], v16 offset:53248
    s_waitcnt lgkmcnt(11)
    v_mfma_f32_16x16x32_bf16 v[224:227], a[144:147], v[176:179], v[224:227]
    ds_read_b64_tr_b16 v[198:199], v16 offset:53760
    v_mfma_f32_16x16x32_bf16 v[228:231], a[148:151], v[176:179], v[228:231]
    ds_read_b64_tr_b16 v[128:129], v15 offset:61440
    v_mfma_f32_16x16x32_bf16 v[232:235], a[152:155], v[176:179], v[232:235]
    ds_read_b64_tr_b16 v[130:131], v15 offset:61952
    v_mfma_f32_16x16x32_bf16 v[236:239], a[144:147], v[180:183], v[236:239]
    ds_read_b64_tr_b16 v[132:133], v16 offset:61440
    v_mfma_f32_16x16x32_bf16 v[240:243], a[148:151], v[180:183], v[240:243]
    ds_read_b64_tr_b16 v[134:135], v16 offset:61952
    v_mfma_f32_16x16x32_bf16 v[244:247], a[152:155], v[180:183], v[244:247]
    s_waitcnt lgkmcnt(8)
    v_mfma_f32_16x16x32_bf16 v[108:111], v[184:187], v[184:187], v[108:111]
    v_mfma_f32_16x16x32_bf16 v[208:211], a[164:167], v[184:187], v[208:211]
    v_mfma_f32_16x16x32_bf16 v[220:223], a[164:167], v[188:191], v[220:223]
    s_waitcnt lgkmcnt(4)
    v_mfma_f32_16x16x32_bf16 v[232:235], a[164:167], v[192:195], v[232:235]
    v_mfma_f32_16x16x32_bf16 v[244:247], a[164:167], v[196:199], v[244:247]
    v_mfma_f32_16x16x32_bf16 v[108:111], v[84:87], v[84:87], v[108:111]
    v_mfma_f32_16x16x32_bf16 v[208:211], a[176:179], v[84:87], v[208:211]
    v_mfma_f32_16x16x32_bf16 v[220:223], a[176:179], v[88:91], v[220:223]
    v_mfma_f32_16x16x32_bf16 v[232:235], a[176:179], v[92:95], v[232:235]
    v_mfma_f32_16x16x32_bf16 v[244:247], a[176:179], v[96:99], v[244:247]
    s_waitcnt lgkmcnt(0)
    v_mfma_f32_16x16x32_bf16 v[108:111], v[120:123], v[120:123], v[108:111]
    v_mfma_f32_16x16x32_bf16 v[208:211], a[188:191], v[120:123], v[208:211]
    v_mfma_f32_16x16x32_bf16 v[220:223], a[188:191], v[124:127], v[220:223]
    v_mfma_f32_16x16x32_bf16 v[232:235], a[188:191], v[128:131], v[232:235]
    v_mfma_f32_16x16x32_bf16 v[244:247], a[188:191], v[132:135], v[244:247]
    v_mfma_f32_16x16x32_bf16 v[200:203], a[156:159], v[184:187], v[200:203]
    v_mfma_f32_16x16x32_bf16 v[204:207], a[160:163], v[184:187], v[204:207]
    s_nop 1
    v_cndmask_b32 v102, v108, v109, s[12:13]
    v_cndmask_b32 v102, v102, v110, s[14:15]
    v_mfma_f32_16x16x32_bf16 v[212:215], a[156:159], v[188:191], v[212:215]
    v_cndmask_b32 v102, v102, v111, s[16:17]
    v_mfma_f32_16x16x32_bf16 v[216:219], a[160:163], v[188:191], v[216:219]
    s_mov_b64 exec, s[18:19]
    ds_write_b32 v17, v102 offset:0
    s_mov_b64 exec, s[100:101]
    ds_write_b32 v18, v208 offset:192
    ds_write_b32 v18, v220 offset:0
    ds_write_b32 v18, v232 offset:64
    ds_write_b32 v18, v244 offset:128
    s_mov_b64 exec, -1
    v_mfma_f32_16x16x32_bf16 v[224:227], a[156:159], v[192:195], v[224:227]
    v_mfma_f32_16x16x32_bf16 v[228:231], a[160:163], v[192:195], v[228:231]
    v_mfma_f32_16x16x32_bf16 v[236:239], a[156:159], v[196:199], v[236:239]
    v_mfma_f32_16x16x32_bf16 v[240:243], a[160:163], v[196:199], v[240:243]
    v_mfma_f32_16x16x32_bf16 v[200:203], a[168:171], v[84:87], v[200:203]
    v_mfma_f32_16x16x32_bf16 v[204:207], a[172:175], v[84:87], v[204:207]
    s_mov_b32 s3, 167936
    s_cmp_lg_u32 s20, 0
    s_cbranch_scc1 PC_D11
    s_waitcnt vmcnt(0)
    s_mov_b32 s33, 0x40000
PC_L11:
    v_cmp_ne_u32 vcc, 16, v43
    s_cmp_eq_u64 vcc, 0
    s_cbranch_scc1 PC_D11
    s_sub_u32 s33, s33, 1
    s_cbranch_scc1 PC_D11
    s_sleep 1
    buffer_load_dword v43, v3, s[40:43], s3 offen sc1
    s_waitcnt vmcnt(0)
    s_branch PC_L11
PC_D11:
    s_waitcnt lgkmcnt(0)
    s_barrier
    ds_read2_b32 v[100:101], v19 offset0:0 offset1:64
    buffer_load_dwordx4 v11, s[56:59], s34 offen offset:0 sc1 lds
    v_mfma_f32_16x16x32_bf16 v[212:215], a[168:171], v[88:91], v[212:215]
    v_mfma_f32_16x16x32_bf16 v[216:219], a[172:175], v[88:91], v[216:219]
    v_mfma_f32_16x16x32_bf16 v[224:227], a[168:171], v[92:95], v[224:227]
    v_mfma_f32_16x16x32_bf16 v[228:231], a[172:175], v[92:95], v[228:231]
    buffer_load_dwordx4 v12, s[56:59], s34 offen offset:1024 sc1 lds
    v_mfma_f32_16x16x32_bf16 v[236:239], a[168:171], v[96:99], v[236:239]
    s_waitcnt lgkmcnt(0)
    v_mfma_f32_16x16x32_bf16 v[240:243], a[172:175], v[96:99], v[240:243]
    v_mul_f32 v104, 0xbb000000, v100
    v_mul_f32 v101, s76, v101
    v_mfma_f32_16x16x32_bf16 v[200:203], a[180:183], v[120:123], v[200:203]
    v_fma_f32 v101, -v104, v104, v101
    v_max_f32 v101, 0, v101
    v_mfma_f32_16x16x32_bf16 v[204:207], a[184:187], v[120:123], v[204:207]
    v_add_f32 v107, 0x3727c5ac, v101
    buffer_load_dwordx4 v11, s[56:59], s34 offen offset:2048 sc1 lds
    v_mfma_f32_16x16x32_bf16 v[212:215], a[180:183], v[124:127], v[212:215]
    v_rsq_f32 v100, v107
    s_nop 0
    v_mul_f32 v105, 0xc0135761, v100
    v_mfma_f32_16x16x32_bf16 v[216:219], a[184:187], v[124:127], v[216:219]
    v_mul_f32 v101, v100, v100
    v_mul_f32 v100, 0xbdd2d3e8, v100
    v_mfma_f32_16x16x32_bf16 v[224:227], a[180:183], v[128:131], v[224:227]
    v_mul_f32 v106, v101, v100
    v_mfma_f32_16x16x32_bf16 v[228:231], a[184:187], v[128:131], v[228:231]
    ds_write_b128 v20, v[104:107]
    ds_read_b128 v[68:71], v21 offset:0
    ds_read_b128 v[72:75], v21 offset:256
    ds_read_b128 v[76:79], v21 offset:512
    ds_read_b128 v[80:83], v21 offset:768
    buffer_load_dwordx4 v12, s[56:59], s34 offen offset:3072 sc1 lds
    v_mfma_f32_16x16x32_bf16 v[236:239], a[180:183], v[132:135], v[236:239]
    s_add_u32 m0, s37, 49664
    s_add_u32 s34, s34, 16384
    v_mfma_f32_16x16x32_bf16 v[240:243], a[184:187], v[132:135], v[240:243]
    v_subrev_u32 v13, 41984, v13
    v_subrev_u32 v14, 41984, v14
    v_subrev_u32 v15, 41984, v15
    v_subrev_u32 v16, 41984, v16
    s_waitcnt lgkmcnt(0)
    v_pk_fma_f32 v[208:209], v[60:61], v[68:69], v[208:209] op_sel:[0,0,0] op_sel_hi:[1,0,1]
    v_pk_fma_f32 v[220:221], v[60:61], v[72:73], v[220:221] op_sel:[0,0,0] op_sel_hi:[1,0,1]
    buffer_load_dwordx4 v11, s[56:59], s34 offen offset:0 sc1 lds
    v_pk_fma_f32 v[210:211], v[62:63], v[68:69], v[210:211] op_sel:[0,0,0] op_sel_hi:[1,0,1]
    v_pk_fma_f32 v[222:223], v[62:63], v[72:73], v[222:223] op_sel:[0,0,0] op_sel_hi:[1,0,1]
    v_pk_mul_f32 v[96:97], v[208:209], v[208:209]
    v_pk_mul_f32 v[98:99], v[220:221], v[220:221]
    v_pk_mul_f32 v[210:211], v[210:211], v[208:209]
    v_pk_mul_f32 v[222:223], v[222:223], v[220:221]
    v_pk_fma_f32 v[96:97], v[96:97], v[70:71], v[68:69] op_sel:[0,0,1] op_sel_hi:[1,0,1]
    v_pk_fma_f32 v[98:99], v[98:99], v[74:75], v[72:73] op_sel:[0,0,1] op_sel_hi:[1,0,1]
    v_pk_mul_f32 v[96:97], v[96:97], v[208:209]
    v_pk_mul_f32 v[98:99], v[98:99], v[220:221]
    v_exp_f32 v96, v96
    v_exp_f32 v98, v98
    buffer_load_dwordx4 v12, s[56:59], s34 offen offset:1024 sc1 lds
    v_exp_f32 v97, v97
    v_exp_f32 v99, v99
    v_pk_fma_f32 v[96:97], v[96:97], v[70:71], v[70:71] op_sel:[0,1,1] op_sel_hi:[1,1,1]
    v_pk_fma_f32 v[98:99], v[98:99], v[74:75], v[74:75] op_sel:[0,1,1] op_sel_hi:[1,1,1]
    v_rcp_f32 v96, v96
    v_rcp_f32 v98, v98
    v_rcp_f32 v97, v97
    v_rcp_f32 v99, v99
    v_pk_mul_f32 v[210:211], v[210:211], v[96:97]
    v_pk_mul_f32 v[222:223], v[222:223], v[98:99]
    v_cvt_pk_bf16_f32 v92, v210, v211
    v_cvt_pk_bf16_f32 v93, v222, v223
    buffer_load_dwordx4 v11, s[56:59], s34 offen offset:2048 sc1 lds
    v_pk_fma_f32 v[232:233], v[60:61], v[76:77], v[232:233] op_sel:[0,0,0] op_sel_hi:[1,0,1]
    v_pk_fma_f32 v[244:245], v[60:61], v[80:81], v[244:245] op_sel:[0,0,0] op_sel_hi:[1,0,1]
    buffer_load_dwordx4 v12, s[56:59], s34 offen offset:3072 sc1 lds
    s_add_u32 m0, s37, 108032
    s_add_u32 s34, s34, 16384
    buffer_load_dwordx4 v11, s[56:59], s34 offen offset:0 sc1 lds
    v_pk_fma_f32 v[234:235], v[62:63], v[76:77], v[234:235] op_sel:[0,0,0] op_sel_hi:[1,0,1]
    v_pk_fma_f32 v[246:247], v[62:63], v[80:81], v[246:247] op_sel:[0,0,0] op_sel_hi:[1,0,1]
    v_pk_mul_f32 v[96:97], v[232:233], v[232:233]
    v_pk_mul_f32 v[98:99], v[244:245], v[244:245]
    v_pk_mul_f32 v[234:235], v[234:235], v[232:233]
    v_pk_mul_f32 v[246:247], v[246:247], v[244:245]
    v_pk_fma_f32 v[96:97], v[96:97], v[78:79], v[76:77] op_sel:[0,0,1] op_sel_hi:[1,0,1]
    v_pk_fma_f32 v[98:99], v[98:99], v[82:83], v[80:81] op_sel:[0,0,1] op_sel_hi:[1,0,1]
    v_pk_mul_f32 v[96:97], v[96:97], v[232:233]
    v_pk_mul_f32 v[98:99], v[98:99], v[244:245]
    v_exp_f32 v96, v96
    v_exp_f32 v98, v98
    buffer_load_dwordx4 v12, s[56:59], s34 offen offset:1024 sc1 lds
    v_exp_f32 v97, v97
    v_exp_f32 v99, v99
    v_pk_fma_f32 v[96:97], v[96:97], v[78:79], v[78:79] op_sel:[0,1,1] op_sel_hi:[1,1,1]
    v_pk_fma_f32 v[98:99], v[98:99], v[82:83], v[82:83] op_sel:[0,1,1] op_sel_hi:[1,1,1]
    v_rcp_f32 v96, v96
    v_rcp_f32 v98, v98
    v_rcp_f32 v97, v97
    v_rcp_f32 v99, v99
    v_pk_mul_f32 v[234:235], v[234:235], v[96:97]
    v_pk_mul_f32 v[246:247], v[246:247], v[98:99]
    v_cvt_pk_bf16_f32 v94, v234, v235
    v_cvt_pk_bf16_f32 v95, v246, v247
    buffer_load_dwordx4 v11, s[56:59], s34 offen offset:2048 sc1 lds
    v_permlane32_swap_b32 v92, v94
    v_permlane32_swap_b32 v93, v95
    s_nop 1
    v_permlane16_swap_b32 v92, v93
    v_permlane16_swap_b32 v94, v95
    buffer_store_dwordx4 v[92:95], v22, s[64:67], 0 offen sc1
    v_pk_fma_f32 v[200:201], v[44:45], v[68:69], v[200:201] op_sel:[0,0,0] op_sel_hi:[1,0,1]
    v_pk_fma_f32 v[212:213], v[44:45], v[72:73], v[212:213] op_sel:[0,0,0] op_sel_hi:[1,0,1]
    buffer_load_dwordx4 v12, s[56:59], s34 offen offset:3072 sc1 lds
    s_add_u32 m0, s37, 124416
    s_add_u32 s34, s34, 16384
    buffer_load_dwordx4 v11, s[56:59], s34 offen offset:0 sc1 lds
    v_pk_fma_f32 v[202:203], v[46:47], v[68:69], v[202:203] op_sel:[0,0,0] op_sel_hi:[1,0,1]
    v_pk_fma_f32 v[214:215], v[46:47], v[72:73], v[214:215] op_sel:[0,0,0] op_sel_hi:[1,0,1]
    v_pk_mul_f32 v[96:97], v[200:201], v[200:201]
    v_pk_mul_f32 v[98:99], v[212:213], v[212:213]
    v_pk_mul_f32 v[202:203], v[202:203], v[200:201]
    v_pk_mul_f32 v[214:215], v[214:215], v[212:213]
    v_pk_fma_f32 v[96:97], v[96:97], v[70:71], v[68:69] op_sel:[0,0,1] op_sel_hi:[1,0,1]
    v_pk_fma_f32 v[98:99], v[98:99], v[74:75], v[72:73] op_sel:[0,0,1] op_sel_hi:[1,0,1]
    v_pk_mul_f32 v[96:97], v[96:97], v[200:201]
    v_pk_mul_f32 v[98:99], v[98:99], v[212:213]
    v_exp_f32 v96, v96
    v_exp_f32 v98, v98
    v_exp_f32 v97, v97
    v_exp_f32 v99, v99
    v_pk_fma_f32 v[96:97], v[96:97], v[70:71], v[70:71] op_sel:[0,1,1] op_sel_hi:[1,1,1]
    v_pk_fma_f32 v[98:99], v[98:99], v[74:75], v[74:75] op_sel:[0,1,1] op_sel_hi:[1,1,1]
    v_rcp_f32 v96, v96
    v_rcp_f32 v98, v98
    v_rcp_f32 v97, v97
    v_rcp_f32 v99, v99
    v_pk_mul_f32 v[202:203], v[202:203], v[96:97]
    v_pk_mul_f32 v[214:215], v[214:215], v[98:99]
    v_cvt_pk_bf16_f32 v84, v202, v203
    v_cvt_pk_bf16_f32 v85, v214, v215
    v_pk_fma_f32 v[224:225], v[44:45], v[76:77], v[224:225] op_sel:[0,0,0] op_sel_hi:[1,0,1]
    v_pk_fma_f32 v[236:237], v[44:45], v[80:81], v[236:237] op_sel:[0,0,0] op_sel_hi:[1,0,1]
    v_pk_fma_f32 v[226:227], v[46:47], v[76:77], v[226:227] op_sel:[0,0,0] op_sel_hi:[1,0,1]
    v_pk_fma_f32 v[238:239], v[46:47], v[80:81], v[238:239] op_sel:[0,0,0] op_sel_hi:[1,0,1]
    v_pk_mul_f32 v[96:97], v[224:225], v[224:225]
    v_pk_mul_f32 v[98:99], v[236:237], v[236:237]
    v_pk_mul_f32 v[226:227], v[226:227], v[224:225]
    v_pk_mul_f32 v[238:239], v[238:239], v[236:237]
    v_pk_fma_f32 v[96:97], v[96:97], v[78:79], v[76:77] op_sel:[0,0,1] op_sel_hi:[1,0,1]
    v_pk_fma_f32 v[98:99], v[98:99], v[82:83], v[80:81] op_sel:[0,0,1] op_sel_hi:[1,0,1]
    v_pk_mul_f32 v[96:97], v[96:97], v[224:225]
    v_pk_mul_f32 v[98:99], v[98:99], v[236:237]
    v_exp_f32 v96, v96
    v_exp_f32 v98, v98
    v_exp_f32 v97, v97
    v_exp_f32 v99, v99
    v_pk_fma_f32 v[96:97], v[96:97], v[78:79], v[78:79] op_sel:[0,1,1] op_sel_hi:[1,1,1]
    v_pk_fma_f32 v[98:99], v[98:99], v[82:83], v[82:83] op_sel:[0,1,1] op_sel_hi:[1,1,1]
    v_rcp_f32 v96, v96
    v_rcp_f32 v98, v98
    v_rcp_f32 v97, v97
    v_rcp_f32 v99, v99
    v_pk_mul_f32 v[226:227], v[226:227], v[96:97]
    v_pk_mul_f32 v[238:239], v[238:239], v[98:99]
    v_cvt_pk_bf16_f32 v86, v226, v227
    v_cvt_pk_bf16_f32 v87, v238, v239
    s_nop 0
    v_permlane32_swap_b32 v84, v86
    v_permlane32_swap_b32 v85, v87
    s_nop 1
    v_permlane16_swap_b32 v84, v85
    v_permlane16_swap_b32 v86, v87
    buffer_store_dwordx4 v[84:87], v22, s[92:95], 0 offen sc1
    v_pk_fma_f32 v[204:205], v[52:53], v[68:69], v[204:205] op_sel:[0,0,0] op_sel_hi:[1,0,1]
    v_pk_fma_f32 v[216:217], v[52:53], v[72:73], v[216:217] op_sel:[0,0,0] op_sel_hi:[1,0,1]
    v_pk_fma_f32 v[206:207], v[54:55], v[68:69], v[206:207] op_sel:[0,0,0] op_sel_hi:[1,0,1]
    v_pk_fma_f32 v[218:219], v[54:55], v[72:73], v[218:219] op_sel:[0,0,0] op_sel_hi:[1,0,1]
    v_pk_mul_f32 v[96:97], v[204:205], v[204:205]
    v_pk_mul_f32 v[98:99], v[216:217], v[216:217]
    v_pk_mul_f32 v[206:207], v[206:207], v[204:205]
    v_pk_mul_f32 v[218:219], v[218:219], v[216:217]
    v_pk_fma_f32 v[96:97], v[96:97], v[70:71], v[68:69] op_sel:[0,0,1] op_sel_hi:[1,0,1]
    v_pk_fma_f32 v[98:99], v[98:99], v[74:75], v[72:73] op_sel:[0,0,1] op_sel_hi:[1,0,1]
    v_pk_mul_f32 v[96:97], v[96:97], v[204:205]
    v_pk_mul_f32 v[98:99], v[98:99], v[216:217]
    v_exp_f32 v96, v96
    v_exp_f32 v98, v98
    v_exp_f32 v97, v97
    v_exp_f32 v99, v99
    v_pk_fma_f32 v[96:97], v[96:97], v[70:71], v[70:71] op_sel:[0,1,1] op_sel_hi:[1,1,1]
    v_pk_fma_f32 v[98:99], v[98:99], v[74:75], v[74:75] op_sel:[0,1,1] op_sel_hi:[1,1,1]
    v_rcp_f32 v96, v96
    v_rcp_f32 v98, v98
    v_rcp_f32 v97, v97
    v_rcp_f32 v99, v99
    v_pk_mul_f32 v[206:207], v[206:207], v[96:97]
    v_pk_mul_f32 v[218:219], v[218:219], v[98:99]
    v_cvt_pk_bf16_f32 v88, v206, v207
    v_cvt_pk_bf16_f32 v89, v218, v219
    v_pk_fma_f32 v[228:229], v[52:53], v[76:77], v[228:229] op_sel:[0,0,0] op_sel_hi:[1,0,1]
    v_pk_fma_f32 v[240:241], v[52:53], v[80:81], v[240:241] op_sel:[0,0,0] op_sel_hi:[1,0,1]
    v_pk_fma_f32 v[230:231], v[54:55], v[76:77], v[230:231] op_sel:[0,0,0] op_sel_hi:[1,0,1]
    v_pk_fma_f32 v[242:243], v[54:55], v[80:81], v[242:243] op_sel:[0,0,0] op_sel_hi:[1,0,1]
    v_pk_mul_f32 v[96:97], v[228:229], v[228:229]
    v_pk_mul_f32 v[98:99], v[240:241], v[240:241]
    v_pk_mul_f32 v[230:231], v[230:231], v[228:229]
    v_pk_mul_f32 v[242:243], v[242:243], v[240:241]
    v_pk_fma_f32 v[96:97], v[96:97], v[78:79], v[76:77] op_sel:[0,0,1] op_sel_hi:[1,0,1]
    v_pk_fma_f32 v[98:99], v[98:99], v[82:83], v[80:81] op_sel:[0,0,1] op_sel_hi:[1,0,1]
    v_pk_mul_f32 v[96:97], v[96:97], v[228:229]
    v_pk_mul_f32 v[98:99], v[98:99], v[240:241]
    v_exp_f32 v96, v96
    v_exp_f32 v98, v98
    v_exp_f32 v97, v97
    v_exp_f32 v99, v99
    v_pk_fma_f32 v[96:97], v[96:97], v[78:79], v[78:79] op_sel:[0,1,1] op_sel_hi:[1,1,1]
    v_pk_fma_f32 v[98:99], v[98:99], v[82:83], v[82:83] op_sel:[0,1,1] op_sel_hi:[1,1,1]
    v_rcp_f32 v96, v96
    v_rcp_f32 v98, v98
    v_rcp_f32 v97, v97
    v_rcp_f32 v99, v99
    v_pk_mul_f32 v[230:231], v[230:231], v[96:97]
    v_pk_mul_f32 v[242:243], v[242:243], v[98:99]
    v_cvt_pk_bf16_f32 v90, v230, v231
    v_cvt_pk_bf16_f32 v91, v242, v243
    s_nop 0
    v_permlane32_swap_b32 v88, v90
    v_permlane32_swap_b32 v89, v91
    s_nop 1
    v_permlane16_swap_b32 v88, v89
    v_permlane16_swap_b32 v90, v91
    buffer_store_dwordx4 v[88:91], v22, s[92:95], s99 offen sc1
    s_waitcnt vmcnt(8)
    s_barrier
    ds_read_b64_tr_b16 v[168:169], v13 offset:0
    ds_read_b64_tr_b16 v[170:171], v13 offset:512
    ds_read_b64_tr_b16 v[172:173], v14 offset:0
    ds_read_b64_tr_b16 v[174:175], v14 offset:512
    ds_read_b64_tr_b16 v[176:177], v15 offset:0
    ds_read_b64_tr_b16 v[178:179], v15 offset:512
    ds_read_b64_tr_b16 v[180:181], v16 offset:0
    ds_read_b64_tr_b16 v[182:183], v16 offset:512
    s_waitcnt lgkmcnt(4)
    v_mfma_f32_16x16x32_bf16 v[108:111], v[168:171], v[168:171], 0
    ds_read_b64_tr_b16 v[184:185], v13 offset:4096
    v_mfma_f32_16x16x32_bf16 v[120:123], a[0:3], v[168:171], 0
    ds_read_b64_tr_b16 v[186:187], v13 offset:4608
    buffer_load_dwordx4 v12, s[56:59], s34 offen offset:1024 sc1 lds
    v_mfma_f32_16x16x32_bf16 v[124:127], a[4:7], v[168:171], 0
    ds_read_b64_tr_b16 v[188:189], v14 offset:4096
    v_mfma_f32_16x16x32_bf16 v[128:131], a[8:11], v[168:171], 0
    ds_read_b64_tr_b16 v[190:191], v14 offset:4608
    v_mfma_f32_16x16x32_bf16 v[132:135], a[0:3], v[172:175], 0
    ds_read_b64_tr_b16 v[192:193], v15 offset:4096
    v_mfma_f32_16x16x32_bf16 v[136:139], a[4:7], v[172:175], 0
    ds_read_b64_tr_b16 v[194:195], v15 offset:4608
    buffer_load_dwordx4 v11, s[56:59], s34 offen offset:2048 sc1 lds
    v_mfma_f32_16x16x32_bf16 v[140:143], a[8:11], v[172:175], 0
    ds_read_b64_tr_b16 v[196:197], v16 offset:4096
    s_waitcnt lgkmcnt(7)
    v_mfma_f32_16x16x32_bf16 v[144:147], a[0:3], v[176:179], 0
    ds_read_b64_tr_b16 v[198:199], v16 offset:4608
    v_mfma_f32_16x16x32_bf16 v[148:151], a[4:7], v[176:179], 0
    v_mfma_f32_16x16x32_bf16 v[152:155], a[8:11], v[176:179], 0
    buffer_load_dwordx4 v12, s[56:59], s34 offen offset:3072 sc1 lds
    v_mfma_f32_16x16x32_bf16 v[156:159], a[0:3], v[180:183], 0
    v_mfma_f32_16x16x32_bf16 v[160:163], a[4:7], v[180:183], 0
    v_mfma_f32_16x16x32_bf16 v[164:167], a[8:11], v[180:183], 0
    s_waitcnt lgkmcnt(4)
    v_mfma_f32_16x16x32_bf16 v[108:111], v[184:187], v[184:187], v[108:111]
    ds_read_b64_tr_b16 v[168:169], v13 offset:8192
    buffer_load_dwordx4 a[0:3], v23, s[72:75], s36 offen sc1
    v_mfma_f32_16x16x32_bf16 v[120:123], a[12:15], v[184:187], v[120:123]
    ds_read_b64_tr_b16 v[170:171], v13 offset:8704
    v_mfma_f32_16x16x32_bf16 v[124:127], a[16:19], v[184:187], v[124:127]
    ds_read_b64_tr_b16 v[172:173], v14 offset:8192
    v_mfma_f32_16x16x32_bf16 v[128:131], a[20:23], v[184:187], v[128:131]
    ds_read_b64_tr_b16 v[174:175], v14 offset:8704
    v_mfma_f32_16x16x32_bf16 v[132:135], a[12:15], v[188:191], v[132:135]
    ds_read_b64_tr_b16 v[176:177], v15 offset:8192
    buffer_load_dwordx4 a[4:7], v24, s[72:75], s36 offen sc1
    v_mfma_f32_16x16x32_bf16 v[136:139], a[16:19], v[188:191], v[136:139]
    ds_read_b64_tr_b16 v[178:179], v15 offset:8704
    s_add_u32 s36, s36, 16384
    v_mfma_f32_16x16x32_bf16 v[140:143], a[20:23], v[188:191], v[140:143]
    ds_read_b64_tr_b16 v[180:181], v16 offset:8192
    s_waitcnt lgkmcnt(7)
    v_mfma_f32_16x16x32_bf16 v[144:147], a[12:15], v[192:195], v[144:147]
    ds_read_b64_tr_b16 v[182:183], v16 offset:8704
    v_mfma_f32_16x16x32_bf16 v[148:151], a[16:19], v[192:195], v[148:151]
    buffer_load_dwordx4 a[8:11], v23, s[72:75], s36 offen sc1
    v_mfma_f32_16x16x32_bf16 v[152:155], a[20:23], v[192:195], v[152:155]
    v_mfma_f32_16x16x32_bf16 v[156:159], a[12:15], v[196:199], v[156:159]
    v_mfma_f32_16x16x32_bf16 v[160:163], a[16:19], v[196:199], v[160:163]
    v_mfma_f32_16x16x32_bf16 v[164:167], a[20:23], v[196:199], v[164:167]
    s_waitcnt lgkmcnt(4)
    v_mfma_f32_16x16x32_bf16 v[108:111], v[168:171], v[168:171], v[108:111]
    ds_read_b64_tr_b16 v[184:185], v13 offset:12288
    buffer_load_dwordx4 a[12:15], v24, s[72:75], s36 offen sc1
    v_mfma_f32_16x16x32_bf16 v[120:123], a[24:27], v[168:171], v[120:123]
    ds_read_b64_tr_b16 v[186:187], v13 offset:12800
    s_add_u32 s36, s36, 16384
    v_mfma_f32_16x16x32_bf16 v[124:127], a[28:31], v[168:171], v[124:127]
    ds_read_b64_tr_b16 v[188:189], v14 offset:12288
    v_mfma_f32_16x16x32_bf16 v[128:131], a[32:35], v[168:171], v[128:131]
    ds_read_b64_tr_b16 v[190:191], v14 offset:12800
    v_mfma_f32_16x16x32_bf16 v[132:135], a[24:27], v[172:175], v[132:135]
    ds_read_b64_tr_b16 v[192:193], v15 offset:12288
    buffer_load_dwordx4 a[16:19], v23, s[72:75], s36 offen sc1
    v_mfma_f32_16x16x32_bf16 v[136:139], a[28:31], v[172:175], v[136:139]
    ds_read_b64_tr_b16 v[194:195], v15 offset:12800
    v_mfma_f32_16x16x32_bf16 v[140:143], a[32:35], v[172:175], v[140:143]
    ds_read_b64_tr_b16 v[196:197], v16 offset:12288
    s_waitcnt lgkmcnt(7)
    v_mfma_f32_16x16x32_bf16 v[144:147], a[24:27], v[176:179], v[144:147]
    ds_read_b64_tr_b16 v[198:199], v16 offset:12800
    v_mfma_f32_16x16x32_bf16 v[148:151], a[28:31], v[176:179], v[148:151]
    buffer_load_dwordx4 a[20:23], v24, s[72:75], s36 offen sc1
    s_add_u32 s36, s36, 16384
    v_mfma_f32_16x16x32_bf16 v[152:155], a[32:35], v[176:179], v[152:155]
    v_mfma_f32_16x16x32_bf16 v[156:159], a[24:27], v[180:183], v[156:159]
    v_mfma_f32_16x16x32_bf16 v[160:163], a[28:31], v[180:183], v[160:163]
    v_mfma_f32_16x16x32_bf16 v[164:167], a[32:35], v[180:183], v[164:167]
    s_waitcnt lgkmcnt(4)
    v_mfma_f32_16x16x32_bf16 v[108:111], v[184:187], v[184:187], v[108:111]
    ds_read_b64_tr_b16 v[168:169], v13 offset:16384
    buffer_load_dwordx4 a[24:27], v23, s[72:75], s36 offen sc1
    v_mfma_f32_16x16x32_bf16 v[120:123], a[36:39], v[184:187], v[120:123]
    ds_read_b64_tr_b16 v[170:171], v13 offset:16896
    v_mfma_f32_16x16x32_bf16 v[124:127], a[40:43], v[184:187], v[124:127]
    ds_read_b64_tr_b16 v[172:173], v14 offset:16384
    v_mfma_f32_16x16x32_bf16 v[128:131], a[44:47], v[184:187], v[128:131]
    ds_read_b64_tr_b16 v[174:175], v14 offset:16896
    v_mfma_f32_16x16x32_bf16 v[132:135], a[36:39], v[188:191], v[132:135]
    ds_read_b64_tr_b16 v[176:177], v15 offset:16384
    buffer_load_dwordx4 a[28:31], v24, s[72:75], s36 offen sc1
    v_mfma_f32_16x16x32_bf16 v[136:139], a[40:43], v[188:191], v[136:139]
    ds_read_b64_tr_b16 v[178:179], v15 offset:16896
    s_add_u32 s36, s36, 16384
    v_mfma_f32_16x16x32_bf16 v[140:143], a[44:47], v[188:191], v[140:143]
    ds_read_b64_tr_b16 v[180:181], v16 offset:16384
    s_waitcnt lgkmcnt(7)
    v_mfma_f32_16x16x32_bf16 v[144:147], a[36:39], v[192:195], v[144:147]
    ds_read_b64_tr_b16 v[182:183], v16 offset:16896
    v_mfma_f32_16x16x32_bf16 v[148:151], a[40:43], v[192:195], v[148:151]
    buffer_load_dwordx4 a[32:35], v23, s[72:75], s36 offen sc1
    v_mfma_f32_16x16x32_bf16 v[152:155], a[44:47], v[192:195], v[152:155]
    v_mfma_f32_16x16x32_bf16 v[156:159], a[36:39], v[196:199], v[156:159]
    v_mfma_f32_16x16x32_bf16 v[160:163], a[40:43], v[196:199], v[160:163]
    v_mfma_f32_16x16x32_bf16 v[164:167], a[44:47], v[196:199], v[164:167]
    s_waitcnt vmcnt(9)
    s_barrier
    s_waitcnt lgkmcnt(4)
    v_mfma_f32_16x16x32_bf16 v[108:111], v[168:171], v[168:171], v[108:111]
    ds_read_b64_tr_b16 v[184:185], v13 offset:20480
    buffer_atomic_add v4, v33, s[40:43], s78 offen
    v_mfma_f32_16x16x32_bf16 v[120:123], a[48:51], v[168:171], v[120:123]
    ds_read_b64_tr_b16 v[186:187], v13 offset:20992
    v_mfma_f32_16x16x32_bf16 v[124:127], a[52:55], v[168:171], v[124:127]
    ds_read_b64_tr_b16 v[188:189], v14 offset:20480
    buffer_load_dwordx4 a[36:39], v24, s[72:75], s36 offen sc1
    v_mfma_f32_16x16x32_bf16 v[128:131], a[56:59], v[168:171], v[128:131]
    ds_read_b64_tr_b16 v[190:191], v14 offset:20992
    s_add_u32 s36, s36, 16384
    v_mfma_f32_16x16x32_bf16 v[132:135], a[48:51], v[172:175], v[132:135]
    ds_read_b64_tr_b16 v[192:193], v15 offset:20480
    v_mfma_f32_16x16x32_bf16 v[136:139], a[52:55], v[172:175], v[136:139]
    ds_read_b64_tr_b16 v[194:195], v15 offset:20992
    v_mfma_f32_16x16x32_bf16 v[140:143], a[56:59], v[172:175], v[140:143]
    ds_read_b64_tr_b16 v[196:197], v16 offset:20480
    s_waitcnt lgkmcnt(7)
    v_mfma_f32_16x16x32_bf16 v[144:147], a[48:51], v[176:179], v[144:147]
    ds_read_b64_tr_b16 v[198:199], v16 offset:20992
    buffer_load_dwordx4 a[40:43], v23, s[72:75], s36 offen sc1
    v_mfma_f32_16x16x32_bf16 v[148:151], a[52:55], v[176:179], v[148:151]
    v_mfma_f32_16x16x32_bf16 v[152:155], a[56:59], v[176:179], v[152:155]
    v_mfma_f32_16x16x32_bf16 v[156:159], a[48:51], v[180:183], v[156:159]
    v_mfma_f32_16x16x32_bf16 v[160:163], a[52:55], v[180:183], v[160:163]
    buffer_load_dwordx4 a[44:47], v24, s[72:75], s36 offen sc1
    s_add_u32 s36, s36, 16384
    v_mfma_f32_16x16x32_bf16 v[164:167], a[56:59], v[180:183], v[164:167]
    s_waitcnt lgkmcnt(4)
    v_mfma_f32_16x16x32_bf16 v[108:111], v[184:187], v[184:187], v[108:111]
    ds_read_b64_tr_b16 v[168:169], v13 offset:24576
    v_mfma_f32_16x16x32_bf16 v[120:123], a[60:63], v[184:187], v[120:123]
    ds_read_b64_tr_b16 v[170:171], v13 offset:25088
    v_mfma_f32_16x16x32_bf16 v[124:127], a[64:67], v[184:187], v[124:127]
    ds_read_b64_tr_b16 v[172:173], v14 offset:24576
    buffer_load_dwordx4 a[48:51], v23, s[72:75], s36 offen sc1
    v_mfma_f32_16x16x32_bf16 v[128:131], a[68:71], v[184:187], v[128:131]
    ds_read_b64_tr_b16 v[174:175], v14 offset:25088
    v_mfma_f32_16x16x32_bf16 v[132:135], a[60:63], v[188:191], v[132:135]
    ds_read_b64_tr_b16 v[176:177], v15 offset:24576
    v_mfma_f32_16x16x32_bf16 v[136:139], a[64:67], v[188:191], v[136:139]
    ds_read_b64_tr_b16 v[178:179], v15 offset:25088
    v_mfma_f32_16x16x32_bf16 v[140:143], a[68:71], v[188:191], v[140:143]
    ds_read_b64_tr_b16 v[180:181], v16 offset:24576
    s_waitcnt lgkmcnt(7)
    v_mfma_f32_16x16x32_bf16 v[144:147], a[60:63], v[192:195], v[144:147]
    ds_read_b64_tr_b16 v[182:183], v16 offset:25088
    buffer_load_dwordx4 a[52:55], v24, s[72:75], s36 offen sc1
    v_mfma_f32_16x16x32_bf16 v[148:151], a[64:67], v[192:195], v[148:151]
    s_add_u32 s36, s36, 16384
    v_mfma_f32_16x16x32_bf16 v[152:155], a[68:71], v[192:195], v[152:155]
    v_mfma_f32_16x16x32_bf16 v[156:159], a[60:63], v[196:199], v[156:159]
    v_mfma_f32_16x16x32_bf16 v[160:163], a[64:67], v[196:199], v[160:163]
    buffer_load_dwordx4 a[56:59], v23, s[72:75], s36 offen sc1
    v_mfma_f32_16x16x32_bf16 v[164:167], a[68:71], v[196:199], v[164:167]
    s_waitcnt lgkmcnt(4)
    v_mfma_f32_16x16x32_bf16 v[108:111], v[168:171], v[168:171], v[108:111]
    ds_read_b64_tr_b16 v[184:185], v13 offset:28672
    v_mfma_f32_16x16x32_bf16 v[120:123], a[72:75], v[168:171], v[120:123]
    ds_read_b64_tr_b16 v[186:187], v13 offset:29184
    v_mfma_f32_16x16x32_bf16 v[124:127], a[76:79], v[168:171], v[124:127]
    ds_read_b64_tr_b16 v[188:189], v14 offset:28672
    buffer_load_dwordx4 a[60:63], v24, s[72:75], s36 offen sc1
    v_mfma_f32_16x16x32_bf16 v[128:131], a[80:83], v[168:171], v[128:131]
    ds_read_b64_tr_b16 v[190:191], v14 offset:29184
    s_add_u32 s36, s36, 16384
    v_mfma_f32_16x16x32_bf16 v[132:135], a[72:75], v[172:175], v[132:135]
    ds_read_b64_tr_b16 v[192:193], v15 offset:28672
    v_mfma_f32_16x16x32_bf16 v[136:139], a[76:79], v[172:175], v[136:139]
    ds_read_b64_tr_b16 v[194:195], v15 offset:29184
    v_mfma_f32_16x16x32_bf16 v[140:143], a[80:83], v[172:175], v[140:143]
    ds_read_b64_tr_b16 v[196:197], v16 offset:28672
    s_waitcnt lgkmcnt(7)
    v_mfma_f32_16x16x32_bf16 v[144:147], a[72:75], v[176:179], v[144:147]
    ds_read_b64_tr_b16 v[198:199], v16 offset:29184
    buffer_load_dwordx4 a[64:67], v23, s[72:75], s36 offen sc1
    v_mfma_f32_16x16x32_bf16 v[148:151], a[76:79], v[176:179], v[148:151]
    v_mfma_f32_16x16x32_bf16 v[152:155], a[80:83], v[176:179], v[152:155]
    v_mfma_f32_16x16x32_bf16 v[156:159], a[72:75], v[180:183], v[156:159]
    v_mfma_f32_16x16x32_bf16 v[160:163], a[76:79], v[180:183], v[160:163]
    buffer_load_dwordx4 a[68:71], v24, s[72:75], s36 offen sc1
    s_add_u32 s36, s36, 16384
    v_mfma_f32_16x16x32_bf16 v[164:167], a[80:83], v[180:183], v[164:167]
    v_add_u32 v13, 41984, v13
    v_add_u32 v14, 41984, v14
    v_add_u32 v15, 41984, v15
    v_add_u32 v16, 41984, v16
    s_waitcnt lgkmcnt(4)
    v_mfma_f32_16x16x32_bf16 v[108:111], v[184:187], v[184:187], v[108:111]
    ds_read_b64_tr_b16 v[168:169], v13 offset:32768
    v_mfma_f32_16x16x32_bf16 v[120:123], a[84:87], v[184:187], v[120:123]
    ds_read_b64_tr_b16 v[170:171], v13 offset:33280
    v_mfma_f32_16x16x32_bf16 v[124:127], a[88:91], v[184:187], v[124:127]
    ds_read_b64_tr_b16 v[172:173], v14 offset:32768
    buffer_load_dwordx4 a[72:75], v23, s[72:75], s36 offen sc1
    v_mfma_f32_16x16x32_bf16 v[128:131], a[92:95], v[184:187], v[128:131]
    ds_read_b64_tr_b16 v[174:175], v14 offset:33280
    v_mfma_f32_16x16x32_bf16 v[132:135], a[84:87], v[188:191], v[132:135]
    ds_read_b64_tr_b16 v[176:177], v15 offset:32768
    v_mfma_f32_16x16x32_bf16 v[136:139], a[88:91], v[188:191], v[136:139]
    ds_read_b64_tr_b16 v[178:179], v15 offset:33280
    v_mfma_f32_16x16x32_bf16 v[140:143], a[92:95], v[188:191], v[140:143]
    ds_read_b64_tr_b16 v[180:181], v16 offset:32768
    s_waitcnt lgkmcnt(7)
    v_mfma_f32_16x16x32_bf16 v[144:147], a[84:87], v[192:195], v[144:147]
    ds_read_b64_tr_b16 v[182:183], v16 offset:33280
    buffer_load_dwordx4 a[76:79], v24, s[72:75], s36 offen sc1
    v_mfma_f32_16x16x32_bf16 v[148:151], a[88:91], v[192:195], v[148:151]
    s_add_u32 s36, s36, 16384
    v_mfma_f32_16x16x32_bf16 v[152:155], a[92:95], v[192:195], v[152:155]
    v_mfma_f32_16x16x32_bf16 v[156:159], a[84:87], v[196:199], v[156:159]
    v_mfma_f32_16x16x32_bf16 v[160:163], a[88:91], v[196:199], v[160:163]
    buffer_load_dwordx4 a[80:83], v23, s[72:75], s36 offen sc1
    v_mfma_f32_16x16x32_bf16 v[164:167], a[92:95], v[196:199], v[164:167]
    s_waitcnt lgkmcnt(4)
    v_mfma_f32_16x16x32_bf16 v[108:111], v[168:171], v[168:171], v[108:111]
    ds_read_b64_tr_b16 v[184:185], v13 offset:36864
    v_mfma_f32_16x16x32_bf16 v[120:123], a[96:99], v[168:171], v[120:123]
    ds_read_b64_tr_b16 v[186:187], v13 offset:37376
    v_mfma_f32_16x16x32_bf16 v[124:127], a[100:103], v[168:171], v[124:127]
    ds_read_b64_tr_b16 v[188:189], v14 offset:36864
    buffer_load_dwordx4 a[84:87], v24, s[72:75], s36 offen sc1
    v_mfma_f32_16x16x32_bf16 v[128:131], a[104:107], v[168:171], v[128:131]
    ds_read_b64_tr_b16 v[190:191], v14 offset:37376
    s_add_u32 s36, s36, 16384
    v_mfma_f32_16x16x32_bf16 v[132:135], a[96:99], v[172:175], v[132:135]
    ds_read_b64_tr_b16 v[192:193], v15 offset:36864
    v_mfma_f32_16x16x32_bf16 v[136:139], a[100:103], v[172:175], v[136:139]
    ds_read_b64_tr_b16 v[194:195], v15 offset:37376
    v_mfma_f32_16x16x32_bf16 v[140:143], a[104:107], v[172:175], v[140:143]
    ds_read_b64_tr_b16 v[196:197], v16 offset:36864
    s_waitcnt lgkmcnt(7)
    v_mfma_f32_16x16x32_bf16 v[144:147], a[96:99], v[176:179], v[144:147]
    ds_read_b64_tr_b16 v[198:199], v16 offset:37376
    buffer_load_dwordx4 a[88:91], v23, s[72:75], s36 offen sc1
    v_mfma_f32_16x16x32_bf16 v[148:151], a[100:103], v[176:179], v[148:151]
    v_mfma_f32_16x16x32_bf16 v[152:155], a[104:107], v[176:179], v[152:155]
    v_mfma_f32_16x16x32_bf16 v[156:159], a[96:99], v[180:183], v[156:159]
    v_mfma_f32_16x16x32_bf16 v[160:163], a[100:103], v[180:183], v[160:163]
    buffer_load_dwordx4 a[92:95], v24, s[72:75], s36 offen sc1
    v_mfma_f32_16x16x32_bf16 v[164:167], a[104:107], v[180:183], v[164:167]
    s_waitcnt lgkmcnt(4)
    v_mfma_f32_16x16x32_bf16 v[108:111], v[184:187], v[184:187], v[108:111]
    ds_read_b64_tr_b16 v[168:169], v13 offset:40960
    v_add_u32 v7, 327680, v23
    v_mfma_f32_16x16x32_bf16 v[120:123], a[108:111], v[184:187], v[120:123]
    ds_read_b64_tr_b16 v[170:171], v13 offset:41472
    v_mfma_f32_16x16x32_bf16 v[124:127], a[112:115], v[184:187], v[124:127]
    ds_read_b64_tr_b16 v[172:173], v14 offset:40960
    buffer_load_dwordx4 a[96:99], v7, s[72:75], 0 offen sc1
    v_mfma_f32_16x16x32_bf16 v[128:131], a[116:119], v[184:187], v[128:131]
    ds_read_b64_tr_b16 v[174:175], v14 offset:41472
    v_add_u32 v7, 327680, v24
    v_mfma_f32_16x16x32_bf16 v[132:135], a[108:111], v[188:191], v[132:135]
    ds_read_b64_tr_b16 v[176:177], v15 offset:40960
    v_mfma_f32_16x16x32_bf16 v[136:139], a[112:115], v[188:191], v[136:139]
    ds_read_b64_tr_b16 v[178:179], v15 offset:41472
    v_mfma_f32_16x16x32_bf16 v[140:143], a[116:119], v[188:191], v[140:143]
    ds_read_b64_tr_b16 v[180:181], v16 offset:40960
    s_waitcnt lgkmcnt(7)
    v_mfma_f32_16x16x32_bf16 v[144:147], a[108:111], v[192:195], v[144:147]
    ds_read_b64_tr_b16 v[182:183], v16 offset:41472
    buffer_load_dwordx4 a[100:103], v7, s[72:75], 0 offen sc1
    v_mfma_f32_16x16x32_bf16 v[148:151], a[112:115], v[192:195], v[148:151]
    ds_read_b64_tr_b16 v[232:233], v13 offset:61440
    v_add_u32 v7, 344064, v23
    v_mfma_f32_16x16x32_bf16 v[152:155], a[116:119], v[192:195], v[152:155]
    ds_read_b64_tr_b16 v[234:235], v13 offset:61952
    v_mfma_f32_16x16x32_bf16 v[156:159], a[108:111], v[196:199], v[156:159]
    ds_read_b64_tr_b16 v[236:237], v14 offset:61440
    v_mfma_f32_16x16x32_bf16 v[160:163], a[112:115], v[196:199], v[160:163]
    ds_read_b64_tr_b16 v[238:239], v14 offset:61952
    buffer_load_dwordx4 a[104:107], v7, s[72:75], 0 offen sc1
    v_mfma_f32_16x16x32_bf16 v[164:167], a[116:119], v[196:199], v[164:167]
    s_waitcnt lgkmcnt(8)
    v_mfma_f32_16x16x32_bf16 v[108:111], v[168:171], v[168:171], v[108:111]
    ds_read_b64_tr_b16 v[184:185], v13 offset:45056
    v_add_u32 v7, 344064, v24
    v_mfma_f32_16x16x32_bf16 v[120:123], a[120:123], v[168:171], v[120:123]
    ds_read_b64_tr_b16 v[186:187], v13 offset:45568
    v_mfma_f32_16x16x32_bf16 v[124:127], a[124:127], v[168:171], v[124:127]
    ds_read_b64_tr_b16 v[188:189], v14 offset:45056
    buffer_load_dwordx4 a[108:111], v7, s[72:75], 0 offen sc1
    v_mfma_f32_16x16x32_bf16 v[128:131], a[128:131], v[168:171], v[128:131]
    ds_read_b64_tr_b16 v[190:191], v14 offset:45568
    v_mfma_f32_16x16x32_bf16 v[132:135], a[120:123], v[172:175], v[132:135]
    ds_read_b64_tr_b16 v[192:193], v15 offset:45056
    v_mfma_f32_16x16x32_bf16 v[136:139], a[124:127], v[172:175], v[136:139]
    ds_read_b64_tr_b16 v[194:195], v15 offset:45568
    v_mfma_f32_16x16x32_bf16 v[140:143], a[128:131], v[172:175], v[140:143]
    ds_read_b64_tr_b16 v[196:197], v16 offset:45056
    s_waitcnt lgkmcnt(11)
    v_mfma_f32_16x16x32_bf16 v[144:147], a[120:123], v[176:179], v[144:147]
    ds_read_b64_tr_b16 v[198:199], v16 offset:45568
    v_mfma_f32_16x16x32_bf16 v[148:151], a[124:127], v[176:179], v[148:151]
    ds_read_b64_tr_b16 v[84:85], v13 offset:57344
    v_mfma_f32_16x16x32_bf16 v[152:155], a[128:131], v[176:179], v[152:155]
    ds_read_b64_tr_b16 v[86:87], v13 offset:57856
    v_mfma_f32_16x16x32_bf16 v[156:159], a[120:123], v[180:183], v[156:159]
    ds_read_b64_tr_b16 v[88:89], v14 offset:57344
    v_mfma_f32_16x16x32_bf16 v[160:163], a[124:127], v[180:183], v[160:163]
    ds_read_b64_tr_b16 v[90:91], v14 offset:57856
    v_mfma_f32_16x16x32_bf16 v[164:167], a[128:131], v[180:183], v[164:167]
    s_waitcnt lgkmcnt(8)
    v_mfma_f32_16x16x32_bf16 v[108:111], v[184:187], v[184:187], v[108:111]
    ds_read_b64_tr_b16 v[168:169], v13 offset:49152
    buffer_load_dword v43, v32, s[40:43], s78 offen sc1
    v_mfma_f32_16x16x32_bf16 v[120:123], a[132:135], v[184:187], v[120:123]
    ds_read_b64_tr_b16 v[170:171], v13 offset:49664
    v_mfma_f32_16x16x32_bf16 v[124:127], a[136:139], v[184:187], v[124:127]
    ds_read_b64_tr_b16 v[172:173], v14 offset:49152
    v_mfma_f32_16x16x32_bf16 v[128:131], a[140:143], v[184:187], v[128:131]
    ds_read_b64_tr_b16 v[174:175], v14 offset:49664
    v_mfma_f32_16x16x32_bf16 v[132:135], a[132:135], v[188:191], v[132:135]
    ds_read_b64_tr_b16 v[176:177], v15 offset:49152
    v_mfma_f32_16x16x32_bf16 v[136:139], a[136:139], v[188:191], v[136:139]
    ds_read_b64_tr_b16 v[178:179], v15 offset:49664
    v_mfma_f32_16x16x32_bf16 v[140:143], a[140:143], v[188:191], v[140:143]
    ds_read_b64_tr_b16 v[180:181], v16 offset:49152
    s_waitcnt lgkmcnt(11)
    v_mfma_f32_16x16x32_bf16 v[144:147], a[132:135], v[192:195], v[144:147]
    ds_read_b64_tr_b16 v[182:183], v16 offset:49664
    v_mfma_f32_16x16x32_bf16 v[148:151], a[136:139], v[192:195], v[148:151]
    ds_read_b64_tr_b16 v[92:93], v15 offset:57344
    v_mfma_f32_16x16x32_bf16 v[152:155], a[140:143], v[192:195], v[152:155]
    ds_read_b64_tr_b16 v[94:95], v15 offset:57856
    v_mfma_f32_16x16x32_bf16 v[156:159], a[132:135], v[196:199], v[156:159]
    ds_read_b64_tr_b16 v[96:97], v16 offset:57344
    v_mfma_f32_16x16x32_bf16 v[160:163], a[136:139], v[196:199], v[160:163]
    ds_read_b64_tr_b16 v[98:99], v16 offset:57856
    v_mfma_f32_16x16x32_bf16 v[164:167], a[140:143], v[196:199], v[164:167]
    s_waitcnt lgkmcnt(8)
    v_mfma_f32_16x16x32_bf16 v[108:111], v[168:171], v[168:171], v[108:111]
    ds_read_b64_tr_b16 v[184:185], v13 offset:53248
    v_mfma_f32_16x16x32_bf16 v[120:123], a[144:147], v[168:171], v[120:123]
    ds_read_b64_tr_b16 v[186:187], v13 offset:53760
    v_mfma_f32_16x16x32_bf16 v[124:127], a[148:151], v[168:171], v[124:127]
    ds_read_b64_tr_b16 v[188:189], v14 offset:53248
    v_mfma_f32_16x16x32_bf16 v[128:131], a[152:155], v[168:171], v[128:131]
    ds_read_b64_tr_b16 v[190:191], v14 offset:53760
    v_mfma_f32_16x16x32_bf16 v[132:135], a[144:147], v[172:175], v[132:135]
    ds_read_b64_tr_b16 v[192:193], v15 offset:53248
    v_mfma_f32_16x16x32_bf16 v[136:139], a[148:151], v[172:175], v[136:139]
    ds_read_b64_tr_b16 v[194:195], v15 offset:53760
    v_mfma_f32_16x16x32_bf16 v[140:143], a[152:155], v[172:175], v[140:143]
    ds_read_b64_tr_b16 v[196:197], v16 offset:53248
    s_waitcnt lgkmcnt(11)
    v_mfma_f32_16x16x32_bf16 v[144:147], a[144:147], v[176:179], v[144:147]
    ds_read_b64_tr_b16 v[198:199], v16 offset:53760
    v_mfma_f32_16x16x32_bf16 v[148:151], a[148:151], v[176:179], v[148:151]
    ds_read_b64_tr_b16 v[240:241], v15 offset:61440
    v_mfma_f32_16x16x32_bf16 v[152:155], a[152:155], v[176:179], v[152:155]
    ds_read_b64_tr_b16 v[242:243], v15 offset:61952
    v_mfma_f32_16x16x32_bf16 v[156:159], a[144:147], v[180:183], v[156:159]
    ds_read_b64_tr_b16 v[244:245], v16 offset:61440
    v_mfma_f32_16x16x32_bf16 v[160:163], a[148:151], v[180:183], v[160:163]
    ds_read_b64_tr_b16 v[246:247], v16 offset:61952
    v_mfma_f32_16x16x32_bf16 v[164:167], a[152:155], v[180:183], v[164:167]
    s_waitcnt lgkmcnt(8)
    v_mfma_f32_16x16x32_bf16 v[108:111], v[184:187], v[184:187], v[108:111]
    s_cmp_ge_u32 s22, 8
    s_cselect_b32 s26, 41984, 0
    v_mfma_f32_16x16x32_bf16 v[128:131], a[164:167], v[184:187], v[128:131]
    s_add_u32 s26, s26, 33280
    v_add_u32 v8, s26, v26
    v_mfma_f32_16x16x32_bf16 v[140:143], a[164:167], v[188:191], v[140:143]
    ds_read2_b64 v[116:119], v8 offset0:0 offset1:2
    s_waitcnt lgkmcnt(5)
    v_mfma_f32_16x16x32_bf16 v[152:155], a[164:167], v[192:195], v[152:155]
    v_mfma_f32_16x16x32_bf16 v[164:167], a[164:167], v[196:199], v[164:167]
    v_mfma_f32_16x16x32_bf16 v[108:111], v[84:87], v[84:87], v[108:111]
    v_mfma_f32_16x16x32_bf16 v[128:131], a[176:179], v[84:87], v[128:131]
    v_mfma_f32_16x16x32_bf16 v[140:143], a[176:179], v[88:91], v[140:143]
    v_mfma_f32_16x16x32_bf16 v[152:155], a[176:179], v[92:95], v[152:155]
    v_mfma_f32_16x16x32_bf16 v[164:167], a[176:179], v[96:99], v[164:167]
    s_waitcnt lgkmcnt(1)
    v_mfma_f32_16x16x32_bf16 v[108:111], v[232:235], v[232:235], v[108:111]
    v_mfma_f32_16x16x32_bf16 v[128:131], a[188:191], v[232:235], v[128:131]
    v_mfma_f32_16x16x32_bf16 v[140:143], a[188:191], v[236:239], v[140:143]
    v_mfma_f32_16x16x32_bf16 v[152:155], a[188:191], v[240:243], v[152:155]
    v_mfma_f32_16x16x32_bf16 v[164:167], a[188:191], v[244:247], v[164:167]
    v_mfma_f32_16x16x32_bf16 v[120:123], a[156:159], v[184:187], v[120:123]
    v_mfma_f32_16x16x32_bf16 v[124:127], a[160:163], v[184:187], v[124:127]
    s_nop 1
    v_cndmask_b32 v102, v108, v109, s[12:13]
    v_cndmask_b32 v102, v102, v110, s[14:15]
    v_mfma_f32_16x16x32_bf16 v[132:135], a[156:159], v[188:191], v[132:135]
    v_cndmask_b32 v102, v102, v111, s[16:17]
    v_mfma_f32_16x16x32_bf16 v[136:139], a[160:163], v[188:191], v[136:139]
    s_mov_b64 exec, s[18:19]
    ds_write_b32 v17, v102 offset:512
    s_mov_b64 exec, s[100:101]
    ds_write_b32 v18, v128 offset:704
    ds_write_b32 v18, v140 offset:512
    ds_write_b32 v18, v152 offset:576
    ds_write_b32 v18, v164 offset:640
    s_mov_b64 exec, -1
    v_mfma_f32_16x16x32_bf16 v[144:147], a[156:159], v[192:195], v[144:147]
    v_mfma_f32_16x16x32_bf16 v[148:151], a[160:163], v[192:195], v[148:151]
    v_mfma_f32_16x16x32_bf16 v[156:159], a[156:159], v[196:199], v[156:159]
    v_mfma_f32_16x16x32_bf16 v[160:163], a[160:163], v[196:199], v[160:163]
    v_mfma_f32_16x16x32_bf16 v[120:123], a[168:171], v[84:87], v[120:123]
    v_mfma_f32_16x16x32_bf16 v[124:127], a[172:175], v[84:87], v[124:127]
    s_cmp_lg_u32 s20, 0
    s_cbranch_scc1 PC_D12
    s_waitcnt vmcnt(0)
    s_mov_b32 s33, 0x40000
PC_L12:
    v_cmp_ne_u32 vcc, 16, v43
    s_cmp_eq_u64 vcc, 0
    s_cbranch_scc1 PC_D12
    s_sub_u32 s33, s33, 1
    s_cbranch_scc1 PC_D12
    s_sleep 1
    buffer_load_dword v43, v32, s[40:43], s78 offen sc1
    s_waitcnt vmcnt(0)
    s_branch PC_L12
PC_D12:
    s_waitcnt lgkmcnt(0)
    s_barrier
    ds_read2_b32 v[100:101], v19 offset0:128 offset1:192
    buffer_load_dwordx4 v[200:203], v25, s[84:87], s35 offen sc1
    v_mfma_f32_16x16x32_bf16 v[132:135], a[168:171], v[88:91], v[132:135]
    s_add_u32 s35, s35, 65536
    v_mfma_f32_16x16x32_bf16 v[136:139], a[172:175], v[88:91], v[136:139]
    v_mfma_f32_16x16x32_bf16 v[144:147], a[168:171], v[92:95], v[144:147]
    v_mfma_f32_16x16x32_bf16 v[148:151], a[172:175], v[92:95], v[148:151]
    buffer_load_dwordx4 v[204:207], v25, s[84:87], s35 offen sc1
    v_mfma_f32_16x16x32_bf16 v[156:159], a[168:171], v[96:99], v[156:159]
    s_waitcnt lgkmcnt(0)
    v_mfma_f32_16x16x32_bf16 v[160:163], a[172:175], v[96:99], v[160:163]
    v_mul_f32 v104, 0xbb000000, v100
    v_mul_f32 v101, s76, v101
    v_mfma_f32_16x16x32_bf16 v[120:123], a[180:183], v[232:235], v[120:123]
    v_fma_f32 v101, -v104, v104, v101
    v_max_f32 v101, 0, v101
    v_mfma_f32_16x16x32_bf16 v[124:127], a[184:187], v[232:235], v[124:127]
    v_add_f32 v107, 0x3727c5ac, v101
    s_add_u32 s35, s35, 65536
    v_mfma_f32_16x16x32_bf16 v[132:135], a[180:183], v[236:239], v[132:135]
    v_rsq_f32 v100, v107
    s_nop 0
    v_mul_f32 v105, 0xc0135761, v100
    v_mfma_f32_16x16x32_bf16 v[136:139], a[184:187], v[236:239], v[136:139]
    v_mul_f32 v101, v100, v100
    v_mul_f32 v100, 0xbdd2d3e8, v100
    v_mfma_f32_16x16x32_bf16 v[144:147], a[180:183], v[240:243], v[144:147]
    v_mul_f32 v106, v101, v100
    buffer_load_dwordx4 v[208:211], v25, s[84:87], s35 offen sc1
    v_mfma_f32_16x16x32_bf16 v[148:151], a[184:187], v[240:243], v[148:151]
    ds_write_b128 v20, v[104:107]
    ds_read_b128 v[68:71], v21 offset:0
    ds_read_b128 v[72:75], v21 offset:256
    ds_read_b128 v[76:79], v21 offset:512
    ds_read_b128 v[80:83], v21 offset:768
    s_add_u32 s35, s35, 65536
    v_mfma_f32_16x16x32_bf16 v[156:159], a[180:183], v[244:247], v[156:159]
    v_mfma_f32_16x16x32_bf16 v[160:163], a[184:187], v[244:247], v[160:163]
    s_waitcnt lgkmcnt(0)
    v_pk_fma_f32 v[128:129], v[60:61], v[68:69], v[128:129] op_sel:[0,0,0] op_sel_hi:[1,0,1]
    v_pk_fma_f32 v[140:141], v[60:61], v[72:73], v[140:141] op_sel:[0,0,0] op_sel_hi:[1,0,1]
    buffer_load_dwordx4 v[212:215], v25, s[84:87], s35 offen sc1
    v_pk_fma_f32 v[130:131], v[62:63], v[68:69], v[130:131] op_sel:[0,0,0] op_sel_hi:[1,0,1]
    v_pk_fma_f32 v[142:143], v[62:63], v[72:73], v[142:143] op_sel:[0,0,0] op_sel_hi:[1,0,1]
    v_pk_mul_f32 v[96:97], v[128:129], v[128:129]
    v_pk_mul_f32 v[98:99], v[140:141], v[140:141]
    v_pk_mul_f32 v[130:131], v[130:131], v[128:129]
    v_pk_mul_f32 v[142:143], v[142:143], v[140:141]
    v_pk_fma_f32 v[96:97], v[96:97], v[70:71], v[68:69] op_sel:[0,0,1] op_sel_hi:[1,0,1]
    v_pk_fma_f32 v[98:99], v[98:99], v[74:75], v[72:73] op_sel:[0,0,1] op_sel_hi:[1,0,1]
    v_pk_mul_f32 v[96:97], v[96:97], v[128:129]
    v_pk_mul_f32 v[98:99], v[98:99], v[140:141]
    v_exp_f32 v96, v96
    v_exp_f32 v98, v98
    v_exp_f32 v97, v97
    v_exp_f32 v99, v99
    v_pk_fma_f32 v[96:97], v[96:97], v[70:71], v[70:71] op_sel:[0,1,1] op_sel_hi:[1,1,1]
    v_pk_fma_f32 v[98:99], v[98:99], v[74:75], v[74:75] op_sel:[0,1,1] op_sel_hi:[1,1,1]
    v_rcp_f32 v96, v96
    v_rcp_f32 v98, v98
    s_add_u32 s35, s35, 65536
    buffer_load_dwordx4 v[216:219], v25, s[84:87], s35 offen sc1
    v_rcp_f32 v97, v97
    v_rcp_f32 v99, v99
    v_pk_mul_f32 v[130:131], v[130:131], v[96:97]
    v_pk_mul_f32 v[142:143], v[142:143], v[98:99]
    v_cvt_pk_bf16_f32 v92, v130, v131
    v_cvt_pk_bf16_f32 v93, v142, v143
    v_pk_fma_f32 v[152:153], v[60:61], v[76:77], v[152:153] op_sel:[0,0,0] op_sel_hi:[1,0,1]
    v_pk_fma_f32 v[164:165], v[60:61], v[80:81], v[164:165] op_sel:[0,0,0] op_sel_hi:[1,0,1]
    s_add_u32 s35, s35, 65536
    buffer_load_dwordx4 v[220:223], v25, s[84:87], s35 offen sc1
    v_pk_fma_f32 v[154:155], v[62:63], v[76:77], v[154:155] op_sel:[0,0,0] op_sel_hi:[1,0,1]
    v_pk_fma_f32 v[166:167], v[62:63], v[80:81], v[166:167] op_sel:[0,0,0] op_sel_hi:[1,0,1]
    v_pk_mul_f32 v[96:97], v[152:153], v[152:153]
    v_pk_mul_f32 v[98:99], v[164:165], v[164:165]
    v_pk_mul_f32 v[154:155], v[154:155], v[152:153]
    v_pk_mul_f32 v[166:167], v[166:167], v[164:165]
    v_pk_fma_f32 v[96:97], v[96:97], v[78:79], v[76:77] op_sel:[0,0,1] op_sel_hi:[1,0,1]
    v_pk_fma_f32 v[98:99], v[98:99], v[82:83], v[80:81] op_sel:[0,0,1] op_sel_hi:[1,0,1]
    v_pk_mul_f32 v[96:97], v[96:97], v[152:153]
    v_pk_mul_f32 v[98:99], v[98:99], v[164:165]
    v_exp_f32 v96, v96
    v_exp_f32 v98, v98
    v_exp_f32 v97, v97
    v_exp_f32 v99, v99
    v_pk_fma_f32 v[96:97], v[96:97], v[78:79], v[78:79] op_sel:[0,1,1] op_sel_hi:[1,1,1]
    v_pk_fma_f32 v[98:99], v[98:99], v[82:83], v[82:83] op_sel:[0,1,1] op_sel_hi:[1,1,1]
    v_rcp_f32 v96, v96
    v_rcp_f32 v98, v98
    s_add_u32 s35, s35, 65536
    buffer_load_dwordx4 v[224:227], v25, s[84:87], s35 offen sc1
    v_rcp_f32 v97, v97
    v_rcp_f32 v99, v99
    v_pk_mul_f32 v[154:155], v[154:155], v[96:97]
    v_pk_mul_f32 v[166:167], v[166:167], v[98:99]
    v_cvt_pk_bf16_f32 v94, v154, v155
    v_cvt_pk_bf16_f32 v95, v166, v167
    s_nop 0
    v_permlane32_swap_b32 v92, v94
    v_permlane32_swap_b32 v93, v95
    s_nop 1
    v_permlane16_swap_b32 v92, v93
    v_permlane16_swap_b32 v94, v95
    buffer_store_dwordx4 v[92:95], v22, s[64:67], s98 offen sc1
    v_pk_fma_f32 v[120:121], v[44:45], v[68:69], v[120:121] op_sel:[0,0,0] op_sel_hi:[1,0,1]
    v_pk_fma_f32 v[132:133], v[44:45], v[72:73], v[132:133] op_sel:[0,0,0] op_sel_hi:[1,0,1]
    s_add_u32 s35, s35, 65536
    buffer_load_dwordx4 v[228:231], v25, s[84:87], s35 offen sc1
    v_pk_fma_f32 v[122:123], v[46:47], v[68:69], v[122:123] op_sel:[0,0,0] op_sel_hi:[1,0,1]
    v_pk_fma_f32 v[134:135], v[46:47], v[72:73], v[134:135] op_sel:[0,0,0] op_sel_hi:[1,0,1]
    v_pk_mul_f32 v[96:97], v[120:121], v[120:121]
    v_pk_mul_f32 v[98:99], v[132:133], v[132:133]
    v_pk_mul_f32 v[122:123], v[122:123], v[120:121]
    v_pk_mul_f32 v[134:135], v[134:135], v[132:133]
    v_pk_fma_f32 v[96:97], v[96:97], v[70:71], v[68:69] op_sel:[0,0,1] op_sel_hi:[1,0,1]
    v_pk_fma_f32 v[98:99], v[98:99], v[74:75], v[72:73] op_sel:[0,0,1] op_sel_hi:[1,0,1]
    v_pk_mul_f32 v[96:97], v[96:97], v[120:121]
    v_pk_mul_f32 v[98:99], v[98:99], v[132:133]
    v_exp_f32 v96, v96
    v_exp_f32 v98, v98
    v_exp_f32 v97, v97
    v_exp_f32 v99, v99
    v_pk_fma_f32 v[96:97], v[96:97], v[70:71], v[70:71] op_sel:[0,1,1] op_sel_hi:[1,1,1]
    v_pk_fma_f32 v[98:99], v[98:99], v[74:75], v[74:75] op_sel:[0,1,1] op_sel_hi:[1,1,1]
    v_rcp_f32 v96, v96
    v_rcp_f32 v98, v98
    s_add_u32 s35, s35, 65536
    buffer_load_dwordx4 v[232:235], v25, s[84:87], s35 offen sc1
    v_rcp_f32 v97, v97
    v_rcp_f32 v99, v99
    v_pk_mul_f32 v[122:123], v[122:123], v[96:97]
    v_pk_mul_f32 v[134:135], v[134:135], v[98:99]
    v_cvt_pk_bf16_f32 v84, v122, v123
    v_cvt_pk_bf16_f32 v85, v134, v135
    v_pk_fma_f32 v[144:145], v[44:45], v[76:77], v[144:145] op_sel:[0,0,0] op_sel_hi:[1,0,1]
    v_pk_fma_f32 v[156:157], v[44:45], v[80:81], v[156:157] op_sel:[0,0,0] op_sel_hi:[1,0,1]
    s_add_u32 s35, s35, 65536
    buffer_load_dwordx4 v[236:239], v25, s[84:87], s35 offen sc1
    v_pk_fma_f32 v[146:147], v[46:47], v[76:77], v[146:147] op_sel:[0,0,0] op_sel_hi:[1,0,1]
    v_pk_fma_f32 v[158:159], v[46:47], v[80:81], v[158:159] op_sel:[0,0,0] op_sel_hi:[1,0,1]
    v_pk_mul_f32 v[96:97], v[144:145], v[144:145]
    v_pk_mul_f32 v[98:99], v[156:157], v[156:157]
    v_pk_mul_f32 v[146:147], v[146:147], v[144:145]
    v_pk_mul_f32 v[158:159], v[158:159], v[156:157]
    v_pk_fma_f32 v[96:97], v[96:97], v[78:79], v[76:77] op_sel:[0,0,1] op_sel_hi:[1,0,1]
    v_pk_fma_f32 v[98:99], v[98:99], v[82:83], v[80:81] op_sel:[0,0,1] op_sel_hi:[1,0,1]
    v_pk_mul_f32 v[96:97], v[96:97], v[144:145]
    v_pk_mul_f32 v[98:99], v[98:99], v[156:157]
    v_exp_f32 v96, v96
    v_exp_f32 v98, v98
    v_exp_f32 v97, v97
    v_exp_f32 v99, v99
    v_pk_fma_f32 v[96:97], v[96:97], v[78:79], v[78:79] op_sel:[0,1,1] op_sel_hi:[1,1,1]
    v_pk_fma_f32 v[98:99], v[98:99], v[82:83], v[82:83] op_sel:[0,1,1] op_sel_hi:[1,1,1]
    v_rcp_f32 v96, v96
    v_rcp_f32 v98, v98
    s_add_u32 s35, s35, 65536
    buffer_load_dwordx4 v[240:243], v25, s[84:87], s35 offen sc1
    v_rcp_f32 v97, v97
    v_rcp_f32 v99, v99
    v_pk_mul_f32 v[146:147], v[146:147], v[96:97]
    v_pk_mul_f32 v[158:159], v[158:159], v[98:99]
    v_cvt_pk_bf16_f32 v86, v146, v147
    v_cvt_pk_bf16_f32 v87, v158, v159
    s_nop 0
    v_permlane32_swap_b32 v84, v86
    v_permlane32_swap_b32 v85, v87
    s_nop 1
    v_permlane16_swap_b32 v84, v85
    v_permlane16_swap_b32 v86, v87
    buffer_store_dwordx4 v[84:87], v22, s[92:95], s98 offen sc1
    v_pk_fma_f32 v[124:125], v[52:53], v[68:69], v[124:125] op_sel:[0,0,0] op_sel_hi:[1,0,1]
    v_pk_fma_f32 v[136:137], v[52:53], v[72:73], v[136:137] op_sel:[0,0,0] op_sel_hi:[1,0,1]
    s_add_u32 s35, s35, 65536
    buffer_load_dwordx4 v[244:247], v25, s[84:87], s35 offen sc1
    v_pk_fma_f32 v[126:127], v[54:55], v[68:69], v[126:127] op_sel:[0,0,0] op_sel_hi:[1,0,1]
    v_pk_fma_f32 v[138:139], v[54:55], v[72:73], v[138:139] op_sel:[0,0,0] op_sel_hi:[1,0,1]
    v_pk_mul_f32 v[96:97], v[124:125], v[124:125]
    v_pk_mul_f32 v[98:99], v[136:137], v[136:137]
    v_pk_mul_f32 v[126:127], v[126:127], v[124:125]
    v_pk_mul_f32 v[138:139], v[138:139], v[136:137]
    v_pk_fma_f32 v[96:97], v[96:97], v[70:71], v[68:69] op_sel:[0,0,1] op_sel_hi:[1,0,1]
    v_pk_fma_f32 v[98:99], v[98:99], v[74:75], v[72:73] op_sel:[0,0,1] op_sel_hi:[1,0,1]
    v_pk_mul_f32 v[96:97], v[96:97], v[124:125]
    v_pk_mul_f32 v[98:99], v[98:99], v[136:137]
    v_exp_f32 v96, v96
    v_exp_f32 v98, v98
    v_exp_f32 v97, v97
    v_exp_f32 v99, v99
    v_pk_fma_f32 v[96:97], v[96:97], v[70:71], v[70:71] op_sel:[0,1,1] op_sel_hi:[1,1,1]
    v_pk_fma_f32 v[98:99], v[98:99], v[74:75], v[74:75] op_sel:[0,1,1] op_sel_hi:[1,1,1]
    v_rcp_f32 v96, v96
    v_rcp_f32 v98, v98
    s_add_u32 s35, s35, 65536
    buffer_load_dwordx4 v[168:171], v25, s[84:87], s35 offen sc1
    v_rcp_f32 v97, v97
    v_rcp_f32 v99, v99
    v_pk_mul_f32 v[126:127], v[126:127], v[96:97]
    v_pk_mul_f32 v[138:139], v[138:139], v[98:99]
    v_cvt_pk_bf16_f32 v88, v126, v127
    v_cvt_pk_bf16_f32 v89, v138, v139
    v_pk_fma_f32 v[148:149], v[52:53], v[76:77], v[148:149] op_sel:[0,0,0] op_sel_hi:[1,0,1]
    v_pk_fma_f32 v[160:161], v[52:53], v[80:81], v[160:161] op_sel:[0,0,0] op_sel_hi:[1,0,1]
    s_add_u32 s35, s35, 65536
    buffer_load_dwordx4 v[172:175], v25, s[84:87], s35 offen sc1
    v_pk_fma_f32 v[150:151], v[54:55], v[76:77], v[150:151] op_sel:[0,0,0] op_sel_hi:[1,0,1]
    v_pk_fma_f32 v[162:163], v[54:55], v[80:81], v[162:163] op_sel:[0,0,0] op_sel_hi:[1,0,1]
    v_pk_mul_f32 v[96:97], v[148:149], v[148:149]
    v_pk_mul_f32 v[98:99], v[160:161], v[160:161]
    v_pk_mul_f32 v[150:151], v[150:151], v[148:149]
    v_pk_mul_f32 v[162:163], v[162:163], v[160:161]
    v_pk_fma_f32 v[96:97], v[96:97], v[78:79], v[76:77] op_sel:[0,0,1] op_sel_hi:[1,0,1]
    v_pk_fma_f32 v[98:99], v[98:99], v[82:83], v[80:81] op_sel:[0,0,1] op_sel_hi:[1,0,1]
    v_pk_mul_f32 v[96:97], v[96:97], v[148:149]
    v_pk_mul_f32 v[98:99], v[98:99], v[160:161]
    v_exp_f32 v96, v96
    v_exp_f32 v98, v98
    v_exp_f32 v97, v97
    v_exp_f32 v99, v99
    v_pk_fma_f32 v[96:97], v[96:97], v[78:79], v[78:79] op_sel:[0,1,1] op_sel_hi:[1,1,1]
    v_pk_fma_f32 v[98:99], v[98:99], v[82:83], v[82:83] op_sel:[0,1,1] op_sel_hi:[1,1,1]
    v_rcp_f32 v96, v96
    v_rcp_f32 v98, v98
    s_add_u32 s35, s35, 65536
    buffer_load_dwordx4 v[176:179], v25, s[84:87], s35 offen sc1
    v_rcp_f32 v97, v97
    v_rcp_f32 v99, v99
    v_pk_mul_f32 v[150:151], v[150:151], v[96:97]
    v_pk_mul_f32 v[162:163], v[162:163], v[98:99]
    v_cvt_pk_bf16_f32 v90, v150, v151
    v_cvt_pk_bf16_f32 v91, v162, v163
    s_nop 0
    v_permlane32_swap_b32 v88, v90
    v_permlane32_swap_b32 v89, v91
    s_nop 1
    v_permlane16_swap_b32 v88, v89
    v_permlane16_swap_b32 v90, v91
    buffer_store_dwordx4 v[88:91], v22, s[92:95], s96 offen sc1
    s_waitcnt vmcnt(17)
    v_mfma_f32_32x32x16_bf16 v[120:135], v[200:203], a[192:195], 0
    s_add_u32 s35, s35, 65536
    buffer_load_dwordx4 v[180:183], v25, s[84:87], s35 offen sc1
    v_mfma_f32_32x32x16_bf16 v[136:151], v[200:203], a[196:199], 0
    s_add_u32 s35, s35, 65536
    buffer_load_dwordx4 v[184:187], v25, s[84:87], s35 offen sc1
    s_waitcnt vmcnt(18)
    v_mfma_f32_32x32x16_bf16 v[120:135], v[204:207], a[200:203], v[120:135]
    s_add_u32 s35, s35, 65536
    buffer_load_dwordx4 v[188:191], v25, s[84:87], s35 offen sc1
    v_mfma_f32_32x32x16_bf16 v[136:151], v[204:207], a[204:207], v[136:151]
    s_add_u32 s35, s35, 65536
    buffer_load_dwordx4 v[192:195], v25, s[84:87], s35 offen sc1
    s_waitcnt vmcnt(19)
    v_mfma_f32_32x32x16_bf16 v[120:135], v[208:211], a[208:211], v[120:135]
    s_add_u32 s35, s35, 65536
    buffer_load_dwordx4 v[196:199], v25, s[84:87], s35 offen sc1
    v_mfma_f32_32x32x16_bf16 v[136:151], v[208:211], a[212:215], v[136:151]
    v_add_u32 v10, 1310720, v25
    buffer_load_dwordx4 v[248:251], v10, s[84:87], 0 offen sc1
    s_waitcnt vmcnt(20)
    v_mfma_f32_32x32x16_bf16 v[120:135], v[212:215], a[216:219], v[120:135]
    v_add_u32 v9, 1376256, v25
    buffer_load_dwordx4 v[252:255], v9, s[84:87], 0 offen sc1
    v_mfma_f32_32x32x16_bf16 v[136:151], v[212:215], a[220:223], v[136:151]
    s_waitcnt vmcnt(20)
    v_mfma_f32_32x32x16_bf16 v[120:135], v[216:219], a[224:227], v[120:135]
    v_mfma_f32_32x32x16_bf16 v[136:151], v[216:219], a[228:231], v[136:151]
    s_waitcnt vmcnt(19)
    v_mfma_f32_32x32x16_bf16 v[120:135], v[220:223], a[232:235], v[120:135]
    v_mfma_f32_32x32x16_bf16 v[136:151], v[220:223], a[236:239], v[136:151]
    s_waitcnt vmcnt(18)
    v_mfma_f32_32x32x16_bf16 v[120:135], v[224:227], a[240:243], v[120:135]
    v_mfma_f32_32x32x16_bf16 v[136:151], v[224:227], a[244:247], v[136:151]
    s_waitcnt vmcnt(16)
    v_mfma_f32_32x32x16_bf16 v[120:135], v[228:231], a[248:251], v[120:135]
    v_mfma_f32_32x32x16_bf16 v[136:151], v[228:231], a[252:255], v[136:151]
    s_waitcnt vmcnt(15)
    v_mfma_f32_32x32x16_bf16 v[120:135], v[232:235], a[0:3], v[120:135]
    v_mfma_f32_32x32x16_bf16 v[136:151], v[232:235], a[4:7], v[136:151]
    s_waitcnt vmcnt(14)
    v_mfma_f32_32x32x16_bf16 v[120:135], v[236:239], a[8:11], v[120:135]
    v_mfma_f32_32x32x16_bf16 v[136:151], v[236:239], a[12:15], v[136:151]
    s_waitcnt vmcnt(13)
    v_mfma_f32_32x32x16_bf16 v[120:135], v[240:243], a[16:19], v[120:135]
    v_mfma_f32_32x32x16_bf16 v[136:151], v[240:243], a[20:23], v[136:151]
    s_waitcnt vmcnt(7)
    s_barrier
    buffer_atomic_add v4, v33, s[40:43], s79 offen
    v_mfma_f32_32x32x16_bf16 v[120:135], v[244:247], a[24:27], v[120:135]
    v_mfma_f32_32x32x16_bf16 v[136:151], v[244:247], a[28:31], v[136:151]
    v_mfma_f32_32x32x16_bf16 v[120:135], v[168:171], a[32:35], v[120:135]
    v_mfma_f32_32x32x16_bf16 v[136:151], v[168:171], a[36:39], v[136:151]
    v_mfma_f32_32x32x16_bf16 v[120:135], v[172:175], a[40:43], v[120:135]
    v_mfma_f32_32x32x16_bf16 v[136:151], v[172:175], a[44:47], v[136:151]
    v_mfma_f32_32x32x16_bf16 v[120:135], v[176:179], a[48:51], v[120:135]
    v_mfma_f32_32x32x16_bf16 v[136:151], v[176:179], a[52:55], v[136:151]
    s_waitcnt vmcnt(7)
    v_mfma_f32_32x32x16_bf16 v[120:135], v[180:183], a[56:59], v[120:135]
    v_mfma_f32_32x32x16_bf16 v[136:151], v[180:183], a[60:63], v[136:151]
    s_waitcnt vmcnt(6)
    v_mfma_f32_32x32x16_bf16 v[120:135], v[184:187], a[64:67], v[120:135]
    v_mfma_f32_32x32x16_bf16 v[136:151], v[184:187], a[68:71], v[136:151]
    s_waitcnt vmcnt(5)
    v_mfma_f32_32x32x16_bf16 v[120:135], v[188:191], a[72:75], v[120:135]
    v_mfma_f32_32x32x16_bf16 v[136:151], v[188:191], a[76:79], v[136:151]
    s_waitcnt vmcnt(4)
    v_mfma_f32_32x32x16_bf16 v[120:135], v[192:195], a[80:83], v[120:135]
    v_mfma_f32_32x32x16_bf16 v[136:151], v[192:195], a[84:87], v[136:151]
    s_waitcnt vmcnt(3)
    v_mfma_f32_32x32x16_bf16 v[120:135], v[196:199], a[88:91], v[120:135]
    v_mfma_f32_32x32x16_bf16 v[136:151], v[196:199], a[92:95], v[136:151]
    s_waitcnt vmcnt(2)
    v_mfma_f32_32x32x16_bf16 v[120:135], v[248:251], a[96:99], v[120:135]
    v_mfma_f32_32x32x16_bf16 v[136:151], v[248:251], a[100:103], v[136:151]
    s_waitcnt vmcnt(1)
    v_mfma_f32_32x32x16_bf16 v[120:135], v[252:255], a[104:107], v[120:135]
    v_mfma_f32_32x32x16_bf16 v[136:151], v[252:255], a[108:111], v[136:151]
    v_xor_b32 v201, 8192, v27
    v_xor_b32 v202, 16384, v27
    v_xor_b32 v203, 24576, v27
    s_nop 8
    ds_write_b128 v201, v[136:139] offset:2048
    ds_write_b128 v201, v[140:143] offset:3072
    ds_write_b128 v202, v[128:131] offset:4096
    ds_write_b128 v202, v[132:135] offset:5120
    ds_write_b128 v203, v[144:147] offset:6144
    ds_write_b128 v203, v[148:151] offset:7168
    v_lshlrev_b32 v224, 16, v112
    v_and_b32 v225, 0xffff0000, v112
    v_lshlrev_b32 v226, 16, v113
    v_and_b32 v227, 0xffff0000, v113
    v_lshlrev_b32 v228, 16, v114
    v_and_b32 v229, 0xffff0000, v114
    v_lshlrev_b32 v230, 16, v115
    v_and_b32 v231, 0xffff0000, v115
    v_pk_add_f32 v[120:121], v[120:121], v[224:225]
    v_pk_add_f32 v[122:123], v[122:123], v[226:227]
    v_pk_add_f32 v[124:125], v[124:125], v[228:229]
    v_pk_add_f32 v[126:127], v[126:127], v[230:231]
    s_waitcnt lgkmcnt(0)
    s_barrier
    ds_read_b128 v[200:203], v27 offset:2048
    ds_read_b128 v[204:207], v27 offset:3072
    ds_read_b128 v[208:211], v27 offset:4096
    ds_read_b128 v[212:215], v27 offset:5120
    ds_read_b128 v[216:219], v27 offset:6144
    ds_read_b128 v[220:223], v27 offset:7168
    buffer_load_dword v43, v32, s[40:43], s79 offen sc1
    s_waitcnt lgkmcnt(4)
    v_pk_add_f32 v[120:121], v[120:121], v[200:201]
    v_pk_add_f32 v[122:123], v[122:123], v[202:203]
    v_pk_add_f32 v[124:125], v[124:125], v[204:205]
    v_pk_add_f32 v[126:127], v[126:127], v[206:207]
    s_waitcnt lgkmcnt(0)
    v_pk_add_f32 v[208:209], v[208:209], v[216:217]
    v_pk_add_f32 v[210:211], v[210:211], v[218:219]
    v_pk_add_f32 v[212:213], v[212:213], v[220:221]
    v_pk_add_f32 v[214:215], v[214:215], v[222:223]
    v_pk_add_f32 v[120:121], v[120:121], v[208:209]
    v_pk_add_f32 v[122:123], v[122:123], v[210:211]
    v_pk_add_f32 v[124:125], v[124:125], v[212:213]
    v_pk_add_f32 v[126:127], v[126:127], v[214:215]
    v_cvt_pk_bf16_f32 v112, v120, v121
    v_cvt_pk_bf16_f32 v113, v122, v123
    v_cvt_pk_bf16_f32 v114, v124, v125
    v_cvt_pk_bf16_f32 v115, v126, v127
    s_nop 0
    v_permlane32_swap_b32 v112, v114
    v_permlane32_swap_b32 v113, v115
    ds_write_b128 v28, v[112:115] offset:0
    ds_read_b64_tr_b16 v[208:209], v29 offset:0
    ds_read_b64_tr_b16 v[210:211], v29 offset:192
    s_waitcnt lgkmcnt(0)
    buffer_store_dwordx4 v[208:211], v31, s[88:91], 0 offen nt
    s_cmp_lg_u32 s20, 0
    s_cbranch_scc1 PC_D13
    s_waitcnt vmcnt(1)
    s_mov_b32 s33, 0x40000
PC_L13:
    v_cmp_ne_u32 vcc, 16, v43
    s_cmp_eq_u64 vcc, 0
    s_cbranch_scc1 PC_D13
    s_sub_u32 s33, s33, 1
    s_cbranch_scc1 PC_D13
    s_sleep 1
    buffer_load_dword v43, v32, s[40:43], s79 offen sc1
    s_waitcnt vmcnt(0)
    s_branch PC_L13
PC_D13:
    s_waitcnt lgkmcnt(0)
    s_barrier
    s_mov_b32 s35, s98
    buffer_load_dwordx4 v[200:203], v25, s[84:87], s35 offen sc1
    s_add_u32 s35, s35, 65536
    buffer_load_dwordx4 v[204:207], v25, s[84:87], s35 offen sc1
    s_add_u32 s35, s35, 65536
    buffer_load_dwordx4 v[208:211], v25, s[84:87], s35 offen sc1
    s_add_u32 s35, s35, 65536
    buffer_load_dwordx4 v[212:215], v25, s[84:87], s35 offen sc1
    s_add_u32 s35, s35, 65536
    buffer_load_dwordx4 v[216:219], v25, s[84:87], s35 offen sc1
    s_add_u32 s35, s35, 65536
    buffer_load_dwordx4 v[220:223], v25, s[84:87], s35 offen sc1
    s_add_u32 s35, s35, 65536
    buffer_load_dwordx4 v[224:227], v25, s[84:87], s35 offen sc1
    s_add_u32 s35, s35, 65536
    buffer_load_dwordx4 v[228:231], v25, s[84:87], s35 offen sc1
    s_add_u32 s35, s35, 65536
    buffer_load_dwordx4 v[232:235], v25, s[84:87], s35 offen sc1
    s_add_u32 s35, s35, 65536
    buffer_load_dwordx4 v[236:239], v25, s[84:87], s35 offen sc1
    s_add_u32 s35, s35, 65536
    buffer_load_dwordx4 v[240:243], v25, s[84:87], s35 offen sc1
    s_add_u32 s35, s35, 65536
    buffer_load_dwordx4 v[244:247], v25, s[84:87], s35 offen sc1
    s_add_u32 s35, s35, 65536
    s_waitcnt vmcnt(11)
    v_mfma_f32_32x32x16_bf16 v[44:59], v[200:203], a[192:195], 0
    buffer_load_dwordx4 v[168:171], v25, s[84:87], s35 offen sc1
    s_add_u32 s35, s35, 65536
    v_mfma_f32_32x32x16_bf16 v[60:75], v[200:203], a[196:199], 0
    buffer_load_dwordx4 v[172:175], v25, s[84:87], s35 offen sc1
    s_add_u32 s35, s35, 65536
    s_waitcnt vmcnt(12)
    v_mfma_f32_32x32x16_bf16 v[44:59], v[204:207], a[200:203], v[44:59]
    buffer_load_dwordx4 v[176:179], v25, s[84:87], s35 offen sc1
    s_add_u32 s35, s35, 65536
    v_mfma_f32_32x32x16_bf16 v[60:75], v[204:207], a[204:207], v[60:75]
    buffer_load_dwordx4 v[180:183], v25, s[84:87], s35 offen sc1
    s_add_u32 s35, s35, 65536
    s_waitcnt vmcnt(13)
    v_mfma_f32_32x32x16_bf16 v[44:59], v[208:211], a[208:211], v[44:59]
    buffer_load_dwordx4 v[184:187], v25, s[84:87], s35 offen sc1
    s_add_u32 s35, s35, 65536
    v_mfma_f32_32x32x16_bf16 v[60:75], v[208:211], a[212:215], v[60:75]
    buffer_load_dwordx4 v[188:191], v25, s[84:87], s35 offen sc1
    s_add_u32 s35, s35, 65536
    s_waitcnt vmcnt(14)
    v_mfma_f32_32x32x16_bf16 v[44:59], v[212:215], a[216:219], v[44:59]
    buffer_load_dwordx4 v[192:195], v25, s[84:87], s35 offen sc1
    s_add_u32 s35, s35, 65536
    v_mfma_f32_32x32x16_bf16 v[60:75], v[212:215], a[220:223], v[60:75]
    buffer_load_dwordx4 v[196:199], v25, s[84:87], s35 offen sc1
    s_waitcnt vmcnt(15)
    v_mfma_f32_32x32x16_bf16 v[44:59], v[216:219], a[224:227], v[44:59]
    buffer_load_dwordx4 v[248:251], v10, s[84:87], s98 offen sc1
    v_mfma_f32_32x32x16_bf16 v[60:75], v[216:219], a[228:231], v[60:75]
    buffer_load_dwordx4 v[252:255], v9, s[84:87], s98 offen sc1
    s_waitcnt vmcnt(16)
    v_mfma_f32_32x32x16_bf16 v[44:59], v[220:223], a[232:235], v[44:59]
    v_mfma_f32_32x32x16_bf16 v[60:75], v[220:223], a[236:239], v[60:75]
    s_waitcnt vmcnt(15)
    v_mfma_f32_32x32x16_bf16 v[44:59], v[224:227], a[240:243], v[44:59]
    v_mfma_f32_32x32x16_bf16 v[60:75], v[224:227], a[244:247], v[60:75]
    s_waitcnt vmcnt(14)
    v_mfma_f32_32x32x16_bf16 v[44:59], v[228:231], a[248:251], v[44:59]
    v_mfma_f32_32x32x16_bf16 v[60:75], v[228:231], a[252:255], v[60:75]
    s_waitcnt vmcnt(13)
    v_mfma_f32_32x32x16_bf16 v[44:59], v[232:235], a[0:3], v[44:59]
    v_mfma_f32_32x32x16_bf16 v[60:75], v[232:235], a[4:7], v[60:75]
    s_waitcnt vmcnt(12)
    v_mfma_f32_32x32x16_bf16 v[44:59], v[236:239], a[8:11], v[44:59]
    v_mfma_f32_32x32x16_bf16 v[60:75], v[236:239], a[12:15], v[60:75]
    s_waitcnt vmcnt(11)
    v_mfma_f32_32x32x16_bf16 v[44:59], v[240:243], a[16:19], v[44:59]
    v_mfma_f32_32x32x16_bf16 v[60:75], v[240:243], a[20:23], v[60:75]
    s_waitcnt vmcnt(10)
    v_mfma_f32_32x32x16_bf16 v[44:59], v[244:247], a[24:27], v[44:59]
    v_mfma_f32_32x32x16_bf16 v[60:75], v[244:247], a[28:31], v[60:75]
    s_waitcnt vmcnt(9)
    v_mfma_f32_32x32x16_bf16 v[44:59], v[168:171], a[32:35], v[44:59]
    v_mfma_f32_32x32x16_bf16 v[60:75], v[168:171], a[36:39], v[60:75]
    s_waitcnt vmcnt(8)
    v_mfma_f32_32x32x16_bf16 v[44:59], v[172:175], a[40:43], v[44:59]
    v_mfma_f32_32x32x16_bf16 v[60:75], v[172:175], a[44:47], v[60:75]
    s_waitcnt vmcnt(7)
    v_mfma_f32_32x32x16_bf16 v[44:59], v[176:179], a[48:51], v[44:59]
    v_mfma_f32_32x32x16_bf16 v[60:75], v[176:179], a[52:55], v[60:75]
    s_waitcnt vmcnt(6)
    v_mfma_f32_32x32x16_bf16 v[44:59], v[180:183], a[56:59], v[44:59]
    v_mfma_f32_32x32x16_bf16 v[60:75], v[180:183], a[60:63], v[60:75]
    s_waitcnt vmcnt(5)
    v_mfma_f32_32x32x16_bf16 v[44:59], v[184:187], a[64:67], v[44:59]
    v_mfma_f32_32x32x16_bf16 v[60:75], v[184:187], a[68:71], v[60:75]
    s_waitcnt vmcnt(4)
    v_mfma_f32_32x32x16_bf16 v[44:59], v[188:191], a[72:75], v[44:59]
    v_mfma_f32_32x32x16_bf16 v[60:75], v[188:191], a[76:79], v[60:75]
    s_waitcnt vmcnt(3)
    v_mfma_f32_32x32x16_bf16 v[44:59], v[192:195], a[80:83], v[44:59]
    v_mfma_f32_32x32x16_bf16 v[60:75], v[192:195], a[84:87], v[60:75]
    s_waitcnt vmcnt(2)
    v_mfma_f32_32x32x16_bf16 v[44:59], v[196:199], a[88:91], v[44:59]
    v_mfma_f32_32x32x16_bf16 v[60:75], v[196:199], a[92:95], v[60:75]
    s_waitcnt vmcnt(1)
    v_mfma_f32_32x32x16_bf16 v[44:59], v[248:251], a[96:99], v[44:59]
    v_mfma_f32_32x32x16_bf16 v[60:75], v[248:251], a[100:103], v[60:75]
    s_waitcnt vmcnt(0)
    v_mfma_f32_32x32x16_bf16 v[44:59], v[252:255], a[104:107], v[44:59]
    v_mfma_f32_32x32x16_bf16 v[60:75], v[252:255], a[108:111], v[60:75]
    v_xor_b32 v201, 8192, v27
    v_xor_b32 v202, 16384, v27
    v_xor_b32 v203, 24576, v27
    s_nop 8
    ds_write_b128 v201, v[60:63] offset:2048
    ds_write_b128 v201, v[64:67] offset:3072
    ds_write_b128 v202, v[52:55] offset:4096
    ds_write_b128 v202, v[56:59] offset:5120
    ds_write_b128 v203, v[68:71] offset:6144
    ds_write_b128 v203, v[72:75] offset:7168
    v_lshlrev_b32 v224, 16, v116
    v_and_b32 v225, 0xffff0000, v116
    v_lshlrev_b32 v226, 16, v117
    v_and_b32 v227, 0xffff0000, v117
    v_lshlrev_b32 v228, 16, v118
    v_and_b32 v229, 0xffff0000, v118
    v_lshlrev_b32 v230, 16, v119
    v_and_b32 v231, 0xffff0000, v119
    v_pk_add_f32 v[44:45], v[44:45], v[224:225]
    v_pk_add_f32 v[46:47], v[46:47], v[226:227]
    v_pk_add_f32 v[48:49], v[48:49], v[228:229]
    v_pk_add_f32 v[50:51], v[50:51], v[230:231]
    s_waitcnt lgkmcnt(0)
    s_barrier
    ds_read_b128 v[200:203], v27 offset:2048
    ds_read_b128 v[204:207], v27 offset:3072
    ds_read_b128 v[208:211], v27 offset:4096
    ds_read_b128 v[212:215], v27 offset:5120
    ds_read_b128 v[216:219], v27 offset:6144
    ds_read_b128 v[220:223], v27 offset:7168
    s_waitcnt lgkmcnt(4)
    v_pk_add_f32 v[44:45], v[44:45], v[200:201]
    v_pk_add_f32 v[46:47], v[46:47], v[202:203]
    v_pk_add_f32 v[48:49], v[48:49], v[204:205]
    v_pk_add_f32 v[50:51], v[50:51], v[206:207]
    s_waitcnt lgkmcnt(0)
    v_pk_add_f32 v[208:209], v[208:209], v[216:217]
    v_pk_add_f32 v[210:211], v[210:211], v[218:219]
    v_pk_add_f32 v[212:213], v[212:213], v[220:221]
    v_pk_add_f32 v[214:215], v[214:215], v[222:223]
    v_pk_add_f32 v[44:45], v[44:45], v[208:209]
    v_pk_add_f32 v[46:47], v[46:47], v[210:211]
    v_pk_add_f32 v[48:49], v[48:49], v[212:213]
    v_pk_add_f32 v[50:51], v[50:51], v[214:215]
    v_cvt_pk_bf16_f32 v116, v44, v45
    v_cvt_pk_bf16_f32 v117, v46, v47
    v_cvt_pk_bf16_f32 v118, v48, v49
    v_cvt_pk_bf16_f32 v119, v50, v51
    s_nop 0
    v_permlane32_swap_b32 v116, v118
    v_permlane32_swap_b32 v117, v119
    ds_write_b128 v28, v[116:119] offset:6144
    ds_read_b64_tr_b16 v[208:209], v29 offset:6144
    ds_read_b64_tr_b16 v[210:211], v29 offset:6336
    s_waitcnt lgkmcnt(0)
    buffer_store_dwordx4 v[208:211], v31, s[88:91], s97 offen nt
M_END:
    s_endpgm
.section .rodata,"a"
.p2align 6
.amdhsa_kernel interleave_layers__ssm_conv_s4d__glu_gated_geglu__prompt_kernel
  .amdhsa_next_free_vgpr 512
  .amdhsa_next_free_sgpr 102
  .amdhsa_accum_offset 256
  .amdhsa_group_segment_fixed_size 0
  .amdhsa_kernarg_size 112
  .amdhsa_user_sgpr_count 2
  .amdhsa_user_sgpr_kernarg_segment_ptr 1
  .amdhsa_system_sgpr_workgroup_id_x 1
  .amdhsa_float_denorm_mode_32 3
.end_amdhsa_kernel
```
